```python
import torch

def _softmax(x, axis=-1):
    return torch.softmax(x, dim=axis)

def _gelu(x):
    return torch.nn.functional.gelu(x, approximate='tanh')

def _silu(x):
    return torch.nn.functional.silu(x)

def _sigmoid(x):
    return torch.sigmoid(x)

def _layernorm(x, axis=-1, eps=1e-05):
    m = x.mean(dim=axis, keepdim=True)
    v = x.var(dim=axis, keepdim=True, unbiased=False)
    return (x - m) / torch.sqrt(v + eps)

def _scatter_add(tgt, idx, src, axis=0):
    return tgt.clone().index_add_(axis, idx, src)

def _segment_sum(src, seg, n):
    out = torch.zeros((n,) + src.shape[1:], dtype=src.dtype)
    return out.index_add_(0, seg, src)

def _pad(x, pw):
    flat = tuple((v for pair in reversed(pw) for v in pair))
    return torch.nn.functional.pad(x, flat)
kernel_name = 'parallel_sum__spectral_fnet__mixer_gmlp__prompt'

def setup_inputs():

    _w = lambda a: (lambda t: t.to(torch.bfloat16) if t.is_floating_point() else t)(torch.as_tensor(a))

    def _A_setup():
        B, S, D = (1, 2048, 512)
        ns = torch.arange(S)[:, None] * torch.arange(S)[None, :]
        nd = torch.arange(D)[:, None] * torch.arange(D)[None, :]
        Ws_re = torch.cos(-2.0 * torch.pi * ns / S).to(float)
        Ws_im = torch.sin(-2.0 * torch.pi * ns / S).to(float)
        Wd_re = torch.cos(-2.0 * torch.pi * nd / D).to(float)
        Wd_im = torch.sin(-2.0 * torch.pi * nd / D).to(float)
        return {'x': _w((lambda *s: torch.randn(*s, dtype=torch.bfloat16) * 0.05)(B, S, D)), 'dft_seq_re': _w(Ws_re), 'dft_seq_im': _w(Ws_im), 'dft_hid_re': _w(Wd_re), 'dft_hid_im': _w(Wd_im)}
    _A_in = _A_setup()

    def _B_setup():
        B, S, D, F = (1, 2048, 512, 1792)
        Fh = F // 2
        return {'x': _w((lambda *s: torch.randn(*s, dtype=torch.bfloat16) * 0.05)(B, S, D)), 'w_in': _w((lambda *s: torch.randn(*s, dtype=torch.bfloat16) * 0.8)(D, 2 * Fh)), 'w_sp': _w(0.01 * (lambda *s: torch.randn(*s, dtype=torch.bfloat16) * 0.8)(S, S)), 'b_sp': _w(1.0 + 0.01 * (lambda *s: torch.randn(*s, dtype=torch.bfloat16) * 0.8)(S)), 'w_out': _w((lambda *s: torch.randn(*s, dtype=torch.bfloat16) * 0.8)(Fh, D))}
    _B_in = _B_setup()
    return {'A_x': _A_in['x'], 'A_dft_seq_re': _A_in['dft_seq_re'], 'A_dft_seq_im': _A_in['dft_seq_im'], 'A_dft_hid_re': _A_in['dft_hid_re'], 'A_dft_hid_im': _A_in['dft_hid_im'], 'B_x': _B_in['x'], 'B_w_in': _B_in['w_in'], 'B_w_sp': _B_in['w_sp'], 'B_b_sp': _B_in['b_sp'], 'B_w_out': _B_in['w_out']}

def reference(A_x, A_dft_seq_re, A_dft_seq_im, A_dft_hid_re, A_dft_hid_im, B_x, B_w_in, B_w_sp, B_b_sp, B_w_out):

    def _A_ref(x, dft_seq_re, dft_seq_im, dft_hid_re, dft_hid_im):
        a = torch.einsum('bsd,ed->bse', x, dft_hid_re)
        b = torch.einsum('bsd,ed->bse', x, dft_hid_im)
        y = torch.einsum('ts,bse->bte', dft_seq_re, a) - torch.einsum('ts,bse->bte', dft_seq_im, b)
        return y

    def _B_ref(x, w_in, w_sp, b_sp, w_out):
        B, S, D = x.shape
        F = w_in.shape[-1]
        Fh = F // 2
        z = _gelu(torch.einsum('bsd,df->bsf', x, w_in))
        z1 = z[..., :Fh].clone()
        z2 = _layernorm(z[..., Fh:], axis=-1)
        g = torch.einsum('ts,bsf->btf', w_sp, z2) + b_sp[None, :, None]
        return torch.einsum('bsf,fd->bsd', z1 * g, w_out)
    x = A_x
    xn = _layernorm(x, axis=-1)
    return x + _A_ref(xn, A_dft_seq_re, A_dft_seq_im, A_dft_hid_re, A_dft_hid_im) + _B_ref(xn, B_w_in, B_w_sp, B_b_sp, B_w_out)
```

```asm
; @launch grid=(256,1,1) block=(512,1,1) lds=163840
.amdgcn_target "amdgcn-amd-amdhsa--gfx950"
.text
.globl parallel_sum__spectral_fnet__mixer_gmlp__prompt_kernel
.p2align 8
.type parallel_sum__spectral_fnet__mixer_gmlp__prompt_kernel,@function
parallel_sum__spectral_fnet__mixer_gmlp__prompt_kernel:
    s_cmp_ge_u32 s2, 256
    s_cbranch_scc1 L_exit
    s_load_dwordx2 s[4:5], s[0:1], 0
    s_load_dwordx4 s[8:11], s[0:1], 24
    s_load_dwordx2 s[6:7], s[0:1], 48
    s_load_dwordx4 s[12:15], s[0:1], 88
    v_lshrrev_b32 v2, 6, v0
    v_and_b32 v1, 63, v0
    s_lshr_b32 s3, s2, 5
    v_readfirstlane_b32 s19, v2
    s_and_b32 s60, s2, 1
    s_lshl_b32 s60, s60, 3
    s_add_u32 s60, s60, s3
    s_bfe_u32 s61, s2, 0x20001
    s_lshl_b32 s61, s61, 2
    s_bfe_u32 s3, s2, 0x20003
    s_add_u32 s61, s61, s3
    s_cmp_ge_u32 s61, 14
    s_cselect_b32 s64, 1, 0
    s_cmp_ge_u32 s61, 7
    s_cselect_b32 s62, 1, 0
    s_cselect_b32 s63, 7, 0
    s_sub_u32 s63, s61, s63
    s_mul_i32 s63, s63, 3
    s_cmp_eq_u32 s61, 14
    s_cselect_b32 s62, 0, s62
    s_cmp_eq_u32 s64, 1
    s_cselect_b32 s63, 21, s63
    v_lshlrev_b32 v14, 4, v1
    s_getreg_b32 s52, hwreg(HW_REG_XCC_ID, 0, 3)
    s_and_b32 s3, s52, 1
    s_mul_i32 s3, s3, 3
    s_add_u32 s52, s52, s3
    s_and_b32 s52, s52, 7
    s_cmp_lt_u32 s19, 4
    s_cbranch_scc1 L_comp
    s_sub_u32 s67, s19, 4
    s_getpc_b64 s[44:45]
L_pc0:
    s_and_b32 s45, s45, 0xffff
    s_mov_b32 s46, L_end-L_pc0
    s_mov_b32 s47, 0x00020000
    s_lshr_b32 s3, s2, 3
    s_lshl_b32 s3, s3, 13
    s_cmp_eq_u32 s67, 3
    s_cselect_b32 s68, s3, 0x100000
    v_lshlrev_b32 v13, 7, v1
    buffer_load_dword v15, v13, s[44:47], s68 offen
    v_lshrrev_b32 v4, 3, v1
    s_lshl_b32 s3, s67, 3
    v_add_u32 v4, s3, v4
    v_and_b32 v5, 7, v1
    v_lshrrev_b32 v6, 4, v1
    s_and_b32 s3, s67, 1
    s_lshl_b32 s3, s3, 2
    s_and_b32 s18, s67, 2
    s_or_b32 s3, s3, s18
    v_xor_b32 v6, s3, v6
    v_xor_b32 v6, v6, v5
    v_lshlrev_b32 v6, 4, v6
    v_lshl_add_u32 v2, v4, 10, v6
    v_bfe_u32 v6, v1, 4, 1
    s_and_b32 s3, s67, 1
    s_lshl_b32 s3, s3, 1
    v_or_b32 v6, s3, v6
    v_lshlrev_b32 v6, 1, v6
    v_xor_b32 v6, v6, v5
    v_lshlrev_b32 v6, 4, v6
    v_mul_u32_u24 v3, 3584, v4
    v_add_u32 v3, v3, v6
    s_lshl_b32 s48, s60, 17
    s_lshl_b32 s49, s63, 14
    s_lshl_b32 s50, s61, 7
    s_lshl_b32 s51, s67, 10
    s_lshl_b32 s3, s52, 7
    s_add_u32 s48, s48, s3
    s_add_u32 s49, s49, s3
    s_mul_i32 s3, s52, 229376
    s_add_u32 s50, s50, s3
    s_mov_b32 s53, 128
    s_mov_b32 s54, 229376
    v_bfe_u32 v6, v1, 4, 1
    s_lshl_b32 s3, s67, 1
    v_or_b32 v6, s3, v6
    v_xor_b32 v6, v6, v5
    v_lshlrev_b32 v6, 4, v6
    v_lshrrev_b32 v9, 3, v1
    v_lshl_add_u32 v9, v9, 10, v6
    s_lshl_b32 s3, s67, 12
    v_add_u32 v9, s3, v9
    s_lshl_b32 s90, s67, 9
    s_cmp_eq_u32 s64, 1
    s_cselect_b64 vcc, -1, 0
    v_cndmask_b32 v3, v3, v2, vcc
    s_cselect_b32 s50, s49, s50
    s_cselect_b32 s54, 128, s54
    s_mov_b32 s55, 4293361664
    s_cselect_b32 s55, 4294966400, s55
    s_cselect_b32 s84, 0, 1792
    s_mov_b32 s85, 116480
    s_cselect_b32 s85, 32768, s85
    s_cselect_b32 s86, 65536, 0
    s_mov_b32 s87, 114688
    s_cselect_b32 s87, 98304, s87
    s_cselect_b32 s3, 131072, 0
    s_add_u32 s49, s49, s3
    s_waitcnt lgkmcnt(0)
    s_mov_b32 s20, s4
    s_and_b32 s21, s5, 0xffff
    s_mov_b32 s22, 2097152
    s_mov_b32 s23, 0x00020000
    s_cmp_eq_u32 s62, 1
    s_cselect_b64 s[16:17], s[10:11], s[8:9]
    s_mov_b32 s24, s16
    s_and_b32 s25, s17, 0xffff
    s_mov_b32 s26, 524288
    s_mov_b32 s27, 0x00020000
    s_cmp_eq_u32 s64, 1
    s_cselect_b64 s[6:7], s[16:17], s[6:7]
    s_mov_b32 s28, s6
    s_and_b32 s29, s7, 0xffff
    s_mov_b32 s30, 1835008
    s_mov_b32 s31, 0x00020000
    s_cmp_eq_u32 s64, 1
    s_cselect_b32 s30, 524288, s30
    s_mov_b32 s32, s14
    s_and_b32 s33, s15, 0xffff
    s_mov_b32 s34, 58720256
    s_mov_b32 s35, 0x00020000
    s_mov_b32 s36, s12
    s_and_b32 s37, s13, 0xffff
    s_mov_b32 s38, 256
    s_mov_b32 s39, 0x00020000
    s_load_dwordx4 s[12:15], s[0:1], 8
    s_load_dwordx4 s[56:59], s[0:1], 56
    s_load_dwordx2 s[94:95], s[0:1], 72
    s_load_dwordx2 s[96:97], s[0:1], 80
L_ld0:
    s_add_u32 m0, s51, 0
    s_add_u32 s3, s48, 0
    buffer_load_dwordx4 v2, s[20:23], s3 offen  lds
    s_add_u32 m0, s51, 65536
    s_add_u32 s3, s50, s84
    buffer_load_dwordx4 v3, s[28:31], s3 offen  lds
    s_add_u32 m0, s51, 4096
    s_add_u32 s3, s48, 32768
    buffer_load_dwordx4 v2, s[20:23], s3 offen  lds
    s_add_u32 m0, s51, 69632
    s_add_u32 s3, s50, s85
    buffer_load_dwordx4 v3, s[28:31], s3 offen  lds
    s_add_u32 m0, s51, 8192
    s_add_u32 s3, s48, 65536
    buffer_load_dwordx4 v2, s[20:23], s3 offen  lds
    s_add_u32 m0, s51, 73728
    s_add_u32 s3, s50, s86
    buffer_load_dwordx4 v3, s[28:31], s3 offen  lds
    s_add_u32 m0, s51, 12288
    s_add_u32 s3, s48, 98304
    buffer_load_dwordx4 v2, s[20:23], s3 offen  lds
    s_add_u32 m0, s51, 77824
    s_add_u32 s3, s50, s87
    buffer_load_dwordx4 v3, s[28:31], s3 offen  lds
    s_add_u32 m0, s51, 131072
    s_add_u32 s3, s49, 0
    buffer_load_dwordx4 v2, s[24:27], s3 offen  lds
    s_add_u32 m0, s90, 135168
    s_add_u32 s3, s49, 32768
    s_mov_b32 exec_hi, 0
    buffer_load_dwordx4 v9, s[24:27], s3 offen  lds
    s_mov_b32 exec_hi, -1
    s_add_u32 s52, s52, 1
    s_cmp_eq_u32 s52, 8
    s_cselect_b32 s52, 0, s52
    s_cselect_b32 s3, 4294966400, s53
    s_cselect_b32 s18, s55, s54
    s_add_u32 s48, s48, s3
    s_add_u32 s49, s49, s3
    s_add_u32 s50, s50, s18
    s_add_u32 m0, s51, 16384
    s_add_u32 s3, s48, 0
    buffer_load_dwordx4 v2, s[20:23], s3 offen  lds
    s_add_u32 m0, s51, 81920
    s_add_u32 s3, s50, s84
    buffer_load_dwordx4 v3, s[28:31], s3 offen  lds
    s_add_u32 m0, s51, 20480
    s_add_u32 s3, s48, 32768
    buffer_load_dwordx4 v2, s[20:23], s3 offen  lds
    s_add_u32 m0, s51, 86016
    s_add_u32 s3, s50, s85
    buffer_load_dwordx4 v3, s[28:31], s3 offen  lds
    s_add_u32 m0, s51, 24576
    s_add_u32 s3, s48, 65536
    buffer_load_dwordx4 v2, s[20:23], s3 offen  lds
    s_add_u32 m0, s51, 90112
    s_add_u32 s3, s50, s86
    buffer_load_dwordx4 v3, s[28:31], s3 offen  lds
    s_add_u32 m0, s51, 28672
    s_add_u32 s3, s48, 98304
    buffer_load_dwordx4 v2, s[20:23], s3 offen  lds
    s_add_u32 m0, s51, 94208
    s_add_u32 s3, s50, s87
    buffer_load_dwordx4 v3, s[28:31], s3 offen  lds
    s_add_u32 m0, s51, 137216
    s_add_u32 s3, s49, 0
    buffer_load_dwordx4 v2, s[24:27], s3 offen  lds
    s_add_u32 m0, s90, 141312
    s_add_u32 s3, s49, 32768
    s_mov_b32 exec_hi, 0
    buffer_load_dwordx4 v9, s[24:27], s3 offen  lds
    s_mov_b32 exec_hi, -1
    s_add_u32 s52, s52, 1
    s_cmp_eq_u32 s52, 8
    s_cselect_b32 s52, 0, s52
    s_cselect_b32 s3, 4294966400, s53
    s_cselect_b32 s18, s55, s54
    s_add_u32 s48, s48, s3
    s_add_u32 s49, s49, s3
    s_add_u32 s50, s50, s18
    v_lshlrev_b32 v8, 2, v1
    s_lshl_b32 s69, s62, 5
    s_add_u32 s69, s69, s63
    s_lshl_b32 s69, s69, 6
    s_add_u32 s69, s69, s90
    s_add_u32 s69, s69, 15360
    s_lshl_b32 s18, s60, 9
    s_lshl_b32 s3, s67, 13
    s_add_u32 s18, s18, s3
    s_cmp_ge_u32 s67, 2
    s_cselect_b32 s69, s69, s18
    s_add_u32 s69, s69, 28835840
    v_lshrrev_b32 v6, 4, v1
    s_and_b32 s3, s67, 1
    s_lshl_b32 s3, s3, 2
    v_or_b32 v7, s3, v6
    v_xor_b32 v7, v7, v5
    v_lshlrev_b32 v7, 4, v7
    v_lshl_add_u32 v7, v4, 12, v7
    s_waitcnt lgkmcnt(0)
    s_waitcnt vmcnt(10)
    s_barrier
    s_add_u32 m0, s51, 32768
    s_add_u32 s3, s48, 0
    buffer_load_dwordx4 v2, s[20:23], s3 offen  lds
    s_add_u32 m0, s51, 98304
    s_add_u32 s3, s50, s84
    buffer_load_dwordx4 v3, s[28:31], s3 offen  lds
    s_add_u32 m0, s51, 36864
    s_add_u32 s3, s48, 32768
    buffer_load_dwordx4 v2, s[20:23], s3 offen  lds
    s_add_u32 m0, s51, 102400
    s_add_u32 s3, s50, s85
    buffer_load_dwordx4 v3, s[28:31], s3 offen  lds
    s_add_u32 m0, s51, 40960
    s_add_u32 s3, s48, 65536
    buffer_load_dwordx4 v2, s[20:23], s3 offen  lds
    s_add_u32 m0, s51, 106496
    s_add_u32 s3, s50, s86
    buffer_load_dwordx4 v3, s[28:31], s3 offen  lds
    s_add_u32 m0, s51, 45056
    s_add_u32 s3, s48, 98304
    buffer_load_dwordx4 v2, s[20:23], s3 offen  lds
    s_add_u32 m0, s51, 110592
    s_add_u32 s3, s50, s87
    buffer_load_dwordx4 v3, s[28:31], s3 offen  lds
    s_add_u32 m0, s51, 143360
    s_add_u32 s3, s49, 0
    buffer_load_dwordx4 v2, s[24:27], s3 offen  lds
    s_add_u32 m0, s90, 147456
    s_add_u32 s3, s49, 32768
    s_mov_b32 exec_hi, 0
    buffer_load_dwordx4 v9, s[24:27], s3 offen  lds
    s_mov_b32 exec_hi, -1
    s_add_u32 s52, s52, 1
    s_cmp_eq_u32 s52, 8
    s_cselect_b32 s52, 0, s52
    s_cselect_b32 s3, 4294966400, s53
    s_cselect_b32 s18, s55, s54
    s_add_u32 s48, s48, s3
    s_add_u32 s49, s49, s3
    s_add_u32 s50, s50, s18
    s_waitcnt vmcnt(10)
    s_barrier
    s_add_u32 m0, s51, 49152
    s_add_u32 s3, s48, 0
    buffer_load_dwordx4 v2, s[20:23], s3 offen  lds
    s_add_u32 m0, s51, 114688
    s_add_u32 s3, s50, s84
    buffer_load_dwordx4 v3, s[28:31], s3 offen  lds
    s_add_u32 m0, s51, 53248
    s_add_u32 s3, s48, 32768
    buffer_load_dwordx4 v2, s[20:23], s3 offen  lds
    s_add_u32 m0, s51, 118784
    s_add_u32 s3, s50, s85
    buffer_load_dwordx4 v3, s[28:31], s3 offen  lds
    s_add_u32 m0, s51, 57344
    s_add_u32 s3, s48, 65536
    buffer_load_dwordx4 v2, s[20:23], s3 offen  lds
    s_add_u32 m0, s51, 122880
    s_add_u32 s3, s50, s86
    buffer_load_dwordx4 v3, s[28:31], s3 offen  lds
    s_add_u32 m0, s51, 61440
    s_add_u32 s3, s48, 98304
    buffer_load_dwordx4 v2, s[20:23], s3 offen  lds
    s_add_u32 m0, s51, 126976
    s_add_u32 s3, s50, s87
    buffer_load_dwordx4 v3, s[28:31], s3 offen  lds
    s_add_u32 m0, s51, 149504
    s_add_u32 s3, s49, 0
    buffer_load_dwordx4 v2, s[24:27], s3 offen  lds
    s_add_u32 m0, s90, 153600
    s_add_u32 s3, s49, 32768
    s_mov_b32 exec_hi, 0
    buffer_load_dwordx4 v9, s[24:27], s3 offen  lds
    s_mov_b32 exec_hi, -1
    s_add_u32 s52, s52, 1
    s_cmp_eq_u32 s52, 8
    s_cselect_b32 s52, 0, s52
    s_cselect_b32 s3, 4294966400, s53
    s_cselect_b32 s18, s55, s54
    s_add_u32 s48, s48, s3
    s_add_u32 s49, s49, s3
    s_add_u32 s50, s50, s18
    s_waitcnt vmcnt(10)
    s_barrier
    s_add_u32 m0, s51, 0
    s_add_u32 s3, s48, 0
    buffer_load_dwordx4 v2, s[20:23], s3 offen  lds
    s_add_u32 m0, s51, 65536
    s_add_u32 s3, s50, s84
    buffer_load_dwordx4 v3, s[28:31], s3 offen  lds
    s_add_u32 m0, s51, 4096
    s_add_u32 s3, s48, 32768
    buffer_load_dwordx4 v2, s[20:23], s3 offen  lds
    s_add_u32 m0, s51, 69632
    s_add_u32 s3, s50, s85
    buffer_load_dwordx4 v3, s[28:31], s3 offen  lds
    s_add_u32 m0, s51, 8192
    s_add_u32 s3, s48, 65536
    buffer_load_dwordx4 v2, s[20:23], s3 offen  lds
    s_add_u32 m0, s51, 73728
    s_add_u32 s3, s50, s86
    buffer_load_dwordx4 v3, s[28:31], s3 offen  lds
    s_add_u32 m0, s51, 12288
    s_add_u32 s3, s48, 98304
    buffer_load_dwordx4 v2, s[20:23], s3 offen  lds
    s_add_u32 m0, s51, 77824
    s_add_u32 s3, s50, s87
    buffer_load_dwordx4 v3, s[28:31], s3 offen  lds
    s_add_u32 m0, s51, 131072
    s_add_u32 s3, s49, 0
    buffer_load_dwordx4 v2, s[24:27], s3 offen  lds
    s_add_u32 m0, s90, 135168
    s_add_u32 s3, s49, 32768
    s_mov_b32 exec_hi, 0
    buffer_load_dwordx4 v9, s[24:27], s3 offen  lds
    s_mov_b32 exec_hi, -1
    s_add_u32 s52, s52, 1
    s_cmp_eq_u32 s52, 8
    s_cselect_b32 s52, 0, s52
    s_cselect_b32 s3, 4294966400, s53
    s_cselect_b32 s18, s55, s54
    s_add_u32 s48, s48, s3
    s_add_u32 s49, s49, s3
    s_add_u32 s50, s50, s18
    s_waitcnt vmcnt(10)
    s_barrier
    s_add_u32 m0, s51, 16384
    s_add_u32 s3, s48, 0
    buffer_load_dwordx4 v2, s[20:23], s3 offen  lds
    s_add_u32 m0, s51, 81920
    s_add_u32 s3, s50, s84
    buffer_load_dwordx4 v3, s[28:31], s3 offen  lds
    s_add_u32 m0, s51, 20480
    s_add_u32 s3, s48, 32768
    buffer_load_dwordx4 v2, s[20:23], s3 offen  lds
    s_add_u32 m0, s51, 86016
    s_add_u32 s3, s50, s85
    buffer_load_dwordx4 v3, s[28:31], s3 offen  lds
    s_add_u32 m0, s51, 24576
    s_add_u32 s3, s48, 65536
    buffer_load_dwordx4 v2, s[20:23], s3 offen  lds
    s_add_u32 m0, s51, 90112
    s_add_u32 s3, s50, s86
    buffer_load_dwordx4 v3, s[28:31], s3 offen  lds
    s_add_u32 m0, s51, 28672
    s_add_u32 s3, s48, 98304
    buffer_load_dwordx4 v2, s[20:23], s3 offen  lds
    s_add_u32 m0, s51, 94208
    s_add_u32 s3, s50, s87
    buffer_load_dwordx4 v3, s[28:31], s3 offen  lds
    s_add_u32 m0, s51, 137216
    s_add_u32 s3, s49, 0
    buffer_load_dwordx4 v2, s[24:27], s3 offen  lds
    s_add_u32 m0, s90, 141312
    s_add_u32 s3, s49, 32768
    s_mov_b32 exec_hi, 0
    buffer_load_dwordx4 v9, s[24:27], s3 offen  lds
    s_mov_b32 exec_hi, -1
    s_add_u32 s52, s52, 1
    s_cmp_eq_u32 s52, 8
    s_cselect_b32 s52, 0, s52
    s_cselect_b32 s3, 4294966400, s53
    s_cselect_b32 s18, s55, s54
    s_add_u32 s48, s48, s3
    s_add_u32 s49, s49, s3
    s_add_u32 s50, s50, s18
    s_waitcnt vmcnt(10)
    s_barrier
    s_add_u32 m0, s51, 32768
    s_add_u32 s3, s48, 0
    buffer_load_dwordx4 v2, s[20:23], s3 offen  lds
    s_add_u32 m0, s51, 98304
    s_add_u32 s3, s50, s84
    buffer_load_dwordx4 v3, s[28:31], s3 offen  lds
    s_add_u32 m0, s51, 36864
    s_add_u32 s3, s48, 32768
    buffer_load_dwordx4 v2, s[20:23], s3 offen  lds
    s_add_u32 m0, s51, 102400
    s_add_u32 s3, s50, s85
    buffer_load_dwordx4 v3, s[28:31], s3 offen  lds
    s_add_u32 m0, s51, 40960
    s_add_u32 s3, s48, 65536
    buffer_load_dwordx4 v2, s[20:23], s3 offen  lds
    s_add_u32 m0, s51, 106496
    s_add_u32 s3, s50, s86
    buffer_load_dwordx4 v3, s[28:31], s3 offen  lds
    s_add_u32 m0, s51, 45056
    s_add_u32 s3, s48, 98304
    buffer_load_dwordx4 v2, s[20:23], s3 offen  lds
    s_add_u32 m0, s51, 110592
    s_add_u32 s3, s50, s87
    buffer_load_dwordx4 v3, s[28:31], s3 offen  lds
    s_add_u32 m0, s51, 143360
    s_add_u32 s3, s49, 0
    buffer_load_dwordx4 v2, s[24:27], s3 offen  lds
    s_add_u32 m0, s90, 147456
    s_add_u32 s3, s49, 32768
    s_mov_b32 exec_hi, 0
    buffer_load_dwordx4 v9, s[24:27], s3 offen  lds
    s_mov_b32 exec_hi, -1
    s_add_u32 s52, s52, 1
    s_cmp_eq_u32 s52, 8
    s_cselect_b32 s52, 0, s52
    s_cselect_b32 s3, 4294966400, s53
    s_cselect_b32 s18, s55, s54
    s_add_u32 s48, s48, s3
    s_add_u32 s49, s49, s3
    s_add_u32 s50, s50, s18
    s_waitcnt vmcnt(10)
    s_barrier
    s_add_u32 m0, s51, 49152
    s_add_u32 s3, s48, 0
    buffer_load_dwordx4 v2, s[20:23], s3 offen  lds
    s_add_u32 m0, s51, 114688
    s_add_u32 s3, s50, s84
    buffer_load_dwordx4 v3, s[28:31], s3 offen  lds
    s_add_u32 m0, s51, 53248
    s_add_u32 s3, s48, 32768
    buffer_load_dwordx4 v2, s[20:23], s3 offen  lds
    s_add_u32 m0, s51, 118784
    s_add_u32 s3, s50, s85
    buffer_load_dwordx4 v3, s[28:31], s3 offen  lds
    s_add_u32 m0, s51, 57344
    s_add_u32 s3, s48, 65536
    buffer_load_dwordx4 v2, s[20:23], s3 offen  lds
    s_add_u32 m0, s51, 122880
    s_add_u32 s3, s50, s86
    buffer_load_dwordx4 v3, s[28:31], s3 offen  lds
    s_add_u32 m0, s51, 61440
    s_add_u32 s3, s48, 98304
    buffer_load_dwordx4 v2, s[20:23], s3 offen  lds
    s_add_u32 m0, s51, 126976
    s_add_u32 s3, s50, s87
    buffer_load_dwordx4 v3, s[28:31], s3 offen  lds
    s_add_u32 m0, s51, 149504
    s_add_u32 s3, s49, 0
    buffer_load_dwordx4 v2, s[24:27], s3 offen  lds
    s_add_u32 m0, s90, 153600
    s_add_u32 s3, s49, 32768
    s_mov_b32 exec_hi, 0
    buffer_load_dwordx4 v9, s[24:27], s3 offen  lds
    s_mov_b32 exec_hi, -1
    s_waitcnt vmcnt(10)
    s_barrier
    s_lshl_b32 s3, s67, 9
    s_add_u32 m0, s3, 155648
    buffer_load_dword v8, s[32:35], s69 offen sc1 lds
    s_add_u32 s69, s69, 256
    s_add_u32 m0, s3, 155904
    buffer_load_dword v8, s[32:35], s69 offen sc1 lds
    s_add_u32 s69, s69, 256
    v_mov_b32 v12, 158208
    ds_read_b32 v13, v12
    s_waitcnt lgkmcnt(0)
    v_readfirstlane_b32 s66, v13
    s_nop 0
    s_and_b32 s66, s66, 255
    s_mov_b32 s36, s58
    s_and_b32 s37, s59, 0xffff
    s_mov_b32 s38, 4096
    s_mov_b32 s39, 0x00020000
    s_and_b32 s87, s66, 31
    s_and_b32 s58, s66, 0x2f
    s_xor_b32 s58, s58, 0x20
    s_and_b32 s3, s66, 0x10
    s_lshl2_add_u32 s58, s3, s58
    s_and_b32 s3, s66, 0x40
    s_lshl1_add_u32 s58, s3, s58
    s_cmp_lt_u32 s66, 128
    s_cbranch_scc1 L_prm_1
    s_mul_i32 s3, s87, 37
    s_lshr_b32 s3, s3, 8
    s_mul_i32 s18, s3, 25
    s_add_u32 s58, s18, s87
    s_add_u32 s58, s58, 16
    s_bitcmp1_b32 s66, 5
    s_cselect_b32 s3, 0, 7
    s_add_u32 s58, s58, s3
    s_bitcmp1_b32 s66, 6
    s_cselect_b32 s3, 128, 0
    s_add_u32 s58, s58, s3
    s_lshl_b32 s18, s87, 5
    s_add_u32 s3, s3, s18
    s_add_u32 s3, s3, 4294966430
    s_bitcmp1_b32 s66, 5
    s_cselect_b32 s18, 0, 1
    s_add_u32 s3, s3, s18
    s_cmp_ge_u32 s87, 28
    s_cselect_b32 s58, s3, s58
L_prm_1:
    s_bfe_u32 s65, s58, 0x10005
    s_and_b32 s87, s58, 31
    s_bfe_u32 s84, s58, 0x10006
    s_lshr_b32 s85, s58, 7
    s_lshr_b32 s3, s87, 2
    s_lshl2_add_u32 s85, s85, s3
    s_and_b32 s86, s87, 3
    s_cmp_lt_u32 s87, 16
    s_cbranch_scc1 L_dec_2
    s_cmp_ge_u32 s87, 23
    s_cselect_b32 s3, 1, 0
    s_cselect_b32 s18, 23, 16
    s_lshr_b32 s85, s58, 5
    s_mov_b32 s65, s3
    s_sub_u32 s86, s87, s18
    s_and_b32 s3, s58, 1
    s_cmp_ge_u32 s87, 30
    s_cselect_b32 s84, 3, 2
    s_cselect_b32 s86, 7, s86
    s_cselect_b32 s65, s3, s65
L_dec_2:
    s_lshl_b32 s3, s67, 8
    s_add_u32 m0, s3, 159744
    s_lshl_b32 s18, s85, 9
    s_add_u32 s3, s3, s18
    buffer_load_dword v8, s[36:39], s3 offen lds
    s_cmp_eq_u32 s84, 0
    s_cselect_b64 s[12:13], s[12:13], s[14:15]
    s_cmp_ge_u32 s84, 2
    s_cselect_b64 s[12:13], s[56:57], s[12:13]
    s_mov_b32 s24, s12
    s_and_b32 s25, s13, 0xffff
    s_mov_b32 s26, 8388608
    s_mov_b32 s27, 0x00020000
    s_lshl_b32 s48, s85, 20
    s_lshl_b32 s3, s65, 11
    s_add_u32 s48, s48, s3
    s_add_u32 s52, s85, s86
    s_mul_i32 s52, s52, 128
    s_mul_i32 s3, s86, 128
    s_cmp_ge_u32 s84, 2
    s_cselect_b32 s52, s3, s52
    s_mov_b32 s55, 384
    s_cselect_b32 s55, 896, s55
    s_add_u32 s18, s52, 0
    s_and_b32 s18, s18, s55
    s_add_u32 s18, s18, s48
    s_add_u32 m0, s51, 0
    s_add_u32 s3, s18, 0
    buffer_load_dwordx4 v7, s[24:27], s3 offen  lds
    s_add_u32 m0, s51, 4096
    s_add_u32 s3, s18, 131072
    buffer_load_dwordx4 v7, s[24:27], s3 offen  lds
    s_add_u32 m0, s51, 8192
    s_add_u32 s3, s18, 262144
    buffer_load_dwordx4 v7, s[24:27], s3 offen  lds
    s_add_u32 m0, s51, 12288
    s_add_u32 s3, s18, 393216
    buffer_load_dwordx4 v7, s[24:27], s3 offen  lds
    s_add_u32 m0, s51, 65536
    s_add_u32 s3, s18, 524288
    buffer_load_dwordx4 v7, s[24:27], s3 offen  lds
    s_add_u32 m0, s51, 69632
    s_add_u32 s3, s18, 655360
    buffer_load_dwordx4 v7, s[24:27], s3 offen  lds
    s_add_u32 m0, s51, 73728
    s_add_u32 s3, s18, 786432
    buffer_load_dwordx4 v7, s[24:27], s3 offen  lds
    s_add_u32 m0, s51, 77824
    s_add_u32 s3, s18, 917504
    buffer_load_dwordx4 v7, s[24:27], s3 offen  lds
    s_waitcnt vmcnt(11)
    s_barrier
    s_waitcnt vmcnt(8)
    s_barrier
    s_add_u32 s18, s52, 128
    s_and_b32 s18, s18, s55
    s_add_u32 s18, s18, s48
    s_add_u32 m0, s51, 16384
    s_add_u32 s3, s18, 0
    buffer_load_dwordx4 v7, s[24:27], s3 offen  lds
    s_add_u32 m0, s51, 20480
    s_add_u32 s3, s18, 131072
    buffer_load_dwordx4 v7, s[24:27], s3 offen  lds
    s_add_u32 m0, s51, 24576
    s_add_u32 s3, s18, 262144
    buffer_load_dwordx4 v7, s[24:27], s3 offen  lds
    s_add_u32 m0, s51, 28672
    s_add_u32 s3, s18, 393216
    buffer_load_dwordx4 v7, s[24:27], s3 offen  lds
    s_add_u32 m0, s51, 81920
    s_add_u32 s3, s18, 524288
    buffer_load_dwordx4 v7, s[24:27], s3 offen  lds
    s_add_u32 m0, s51, 86016
    s_add_u32 s3, s18, 655360
    buffer_load_dwordx4 v7, s[24:27], s3 offen  lds
    s_add_u32 m0, s51, 90112
    s_add_u32 s3, s18, 786432
    buffer_load_dwordx4 v7, s[24:27], s3 offen  lds
    s_add_u32 m0, s51, 94208
    s_add_u32 s3, s18, 917504
    buffer_load_dwordx4 v7, s[24:27], s3 offen  lds
L_ld_p2:
    s_mov_b32 s40, s96
    s_and_b32 s41, s97, 0xffff
    s_mov_b32 s42, 2097152
    s_mov_b32 s43, 0x00020000
    s_mul_i32 s18, s67, 7
    s_and_b32 s3, s66, 3
    s_mul_i32 s59, s3, 224
    s_add_u32 s59, s59, s18
    s_lshl_b32 s59, s59, 10
    s_add_u32 s59, s59, 27262976
    v_add_u32 v15, 4096, v14
    s_setprio 2
    s_mov_b32 s49, 2097152
    s_cmp_eq_u32 s84, 1
    s_cselect_b32 s49, 4194304, s49
    s_cmp_eq_u32 s84, 2
    s_cselect_b32 s49, 14680064, s49
    s_lshl1_add_u32 s3, s86, s65
    s_lshl_b32 s3, s3, 18
    s_add_u32 s49, s49, s3
    s_add_u32 s49, s49, s51
    s_mul_i32 s50, s85, 448
    s_lshl2_add_u32 s50, s86, s50
    s_lshl_b32 s50, s50, 10
    s_add_u32 s50, s50, s51
    s_add_u32 s50, s50, 6291456
    v_mov_b32 v8, 158212
    v_add_u32 v12, 4, v8
    s_cmp_eq_u32 s84, 3
    s_cbranch_scc1 L_spare
    s_mov_b32 s18, 2097152
    v_and_b32 v9, 7, v1
    s_lshl_b32 s3, s65, 3
    v_add_u32 v9, s3, v9
    v_lshrrev_b32 v10, 3, v1
    s_mov_b32 s57, 28573696
    s_cmp_eq_u32 s84, 2
    s_cbranch_scc1 L_f1g
    s_lshl_b32 s3, s86, 2
    s_lshr_b32 s91, 0x7520, s3
    s_and_b32 s91, s91, 15
    v_add_u32 v10, s91, v10
    s_lshr_b32 s91, 0x1343, s3
    s_and_b32 s91, s91, 15
    s_lshl_b32 s91, s91, 3
    s_bfm_b64 s[92:93], s91, 0
    s_mov_b32 s91, s92
    s_mul_i32 s3, s84, 7
    v_cmp_eq_u32 vcc, 7, v10
    v_add_u32 v10, s3, v10
    s_add_u32 s3, s84, 14
    v_mov_b32 v13, s3
    v_cndmask_b32 v10, v10, v13, vcc
    s_branch L_f1x
L_f1g:
    v_bfe_u32 v13, v1, 1, 1
    v_cmp_gt_u32 vcc, 16, v1
    s_lshl_b32 s3, s86, 2
    s_lshr_b32 s91, 0xb9dce673, s3
    s_and_b32 s91, s91, 15
    s_mul_i32 s91, s91, 0x101
    v_cndmask_b32 v10, v13, v10, vcc
    s_lshl_b32 s3, s86, 1
    v_add_u32 v10, s3, v10
    v_and_b32 v13, 1, v1
    s_lshl_b32 s3, s85, 1
    v_add_u32 v13, s3, v13
    v_cndmask_b32 v9, v13, v9, vcc
L_f1x:
    v_lshl_add_u32 v9, v9, 4, v10
    v_lshlrev_b32 v9, 8, v9
    v_mov_b32 v13, v9
    s_cmp_eq_u32 s67, 0
    s_cbranch_scc0 L_lw1
    s_cmp_eq_u32 s84, 2
    s_cbranch_scc1 L_lo0
L_ya0:
    ds_read_b32 v10, v12 offset:4
    s_sub_u32 s18, s18, 1
    s_waitcnt lgkmcnt(0)
    v_readfirstlane_b32 s3, v10
    s_cmp_ge_u32 s3, 8
    s_cbranch_scc1 L_ya1
    s_sleep 1
    s_cmp_gt_i32 s18, 0
    s_cbranch_scc1 L_ya0
L_ya1:
    s_mov_b32 s18, 131072
    s_mov_b32 exec_lo, s91
    s_mov_b32 exec_hi, 0
L_yp0:
    buffer_load_dwordx4 v[16:19], v9, s[32:35], s57 offen offset:128 sc1
    s_waitcnt vmcnt(0)
    v_min_u32 v10, v16, v17
    v_min3_u32 v10, v10, v18, v19
    v_cmp_eq_u32 vcc, 0, v10
    s_sub_u32 s18, s18, 1
    s_cmp_eq_u64 vcc, 0
    s_cbranch_scc1 L_yp1
    s_sleep 2
    s_cmp_gt_i32 s18, 0
    s_cbranch_scc1 L_yp0
L_yp1:
    s_mov_b64 exec, -1
    s_mov_b32 s18, 2097152
    s_branch L_lp1
L_lo0:
    ds_read_b32 v10, v12
    s_sub_u32 s18, s18, 1
    s_waitcnt lgkmcnt(0)
    v_readfirstlane_b32 s3, v10
    s_cmp_eq_u32 s3, 4
    s_cbranch_scc1 L_lo1
    s_sleep 1
    s_cmp_gt_i32 s18, 0
    s_cbranch_scc1 L_lo0
L_lo1:
    s_mov_b32 s18, 131072
    s_mov_b32 exec_lo, s91
    s_mov_b32 exec_hi, 0
L_lp0:
    buffer_load_dword v10, v9, s[32:35], s57 offen sc1
    s_waitcnt vmcnt(0)
    v_cmp_eq_u32 vcc, 0, v10
    s_sub_u32 s18, s18, 1
    s_cmp_eq_u64 vcc, 0
    s_cbranch_scc1 L_lp1
    s_sleep 2
    s_cmp_gt_i32 s18, 0
    s_cbranch_scc1 L_lp0
L_lp1:
    s_mov_b64 exec, -1
    v_mov_b32 v10, 2
    ds_write_b32 v8, v10
    s_branch L_lgo
L_lw1:
    ds_read_b32 v10, v8
    s_sub_u32 s18, s18, 1
    s_waitcnt lgkmcnt(0)
    v_readfirstlane_b32 s3, v10
    s_cmp_eq_u32 s3, 2
    s_cbranch_scc1 L_lgo
    s_sleep 1
    s_cmp_gt_i32 s18, 0
    s_cbranch_scc1 L_lw1
L_lgo:
    v_and_b32 v12, 0x330, v14
    v_bfe_u32 v9, v1, 2, 1
    v_lshl_add_u32 v12, v9, 7, v12
    v_bfe_u32 v9, v1, 3, 1
    v_lshl_add_u32 v12, v9, 12, v12
    v_add_u32 v12, s51, v12
    v_add_u32 v9, 65536, v12
    s_cmp_eq_u32 s84, 2
    s_cbranch_scc1 L_lg
    s_add_u32 s18, s52, 0
    s_and_b32 s18, s18, s55
    s_lshl_b32 s18, s18, 7
    s_add_u32 s18, s18, s49
    s_add_u32 m0, s51, 49152
    s_add_u32 s3, s18, 0
    buffer_load_dwordx4 v14, s[32:35], s3 offen  lds
    s_add_u32 m0, s51, 53248
    s_add_u32 s3, s18, 4096
    buffer_load_dwordx4 v14, s[32:35], s3 offen  lds
    s_add_u32 m0, s51, 57344
    s_add_u32 s3, s18, 8192
    buffer_load_dwordx4 v14, s[32:35], s3 offen  lds
    s_add_u32 m0, s51, 61440
    s_add_u32 s3, s18, 12288
    buffer_load_dwordx4 v14, s[32:35], s3 offen  lds
    s_add_u32 s18, s52, 128
    s_and_b32 s18, s18, s55
    s_lshl_b32 s18, s18, 7
    s_add_u32 s18, s18, s49
    s_add_u32 m0, s51, 114688
    s_add_u32 s3, s18, 0
    buffer_load_dwordx4 v14, s[32:35], s3 offen  lds
    s_add_u32 m0, s51, 118784
    s_add_u32 s3, s18, 4096
    buffer_load_dwordx4 v14, s[32:35], s3 offen  lds
    s_add_u32 m0, s51, 122880
    s_add_u32 s3, s18, 8192
    buffer_load_dwordx4 v14, s[32:35], s3 offen  lds
    s_add_u32 m0, s51, 126976
    s_add_u32 s3, s18, 12288
    buffer_load_dwordx4 v14, s[32:35], s3 offen  lds
    s_add_u32 s18, s52, 256
    s_and_b32 s18, s18, s55
    s_add_u32 s18, s18, s48
    s_add_u32 m0, s51, 32768
    s_add_u32 s3, s18, 0
    buffer_load_dwordx4 v7, s[24:27], s3 offen  lds
    s_add_u32 m0, s51, 36864
    s_add_u32 s3, s18, 131072
    buffer_load_dwordx4 v7, s[24:27], s3 offen  lds
    s_add_u32 m0, s51, 40960
    s_add_u32 s3, s18, 262144
    buffer_load_dwordx4 v7, s[24:27], s3 offen  lds
    s_add_u32 m0, s51, 45056
    s_add_u32 s3, s18, 393216
    buffer_load_dwordx4 v7, s[24:27], s3 offen  lds
    s_add_u32 m0, s51, 98304
    s_add_u32 s3, s18, 524288
    buffer_load_dwordx4 v7, s[24:27], s3 offen  lds
    s_add_u32 m0, s51, 102400
    s_add_u32 s3, s18, 655360
    buffer_load_dwordx4 v7, s[24:27], s3 offen  lds
    s_add_u32 m0, s51, 106496
    s_add_u32 s3, s18, 786432
    buffer_load_dwordx4 v7, s[24:27], s3 offen  lds
    s_add_u32 m0, s51, 110592
    s_add_u32 s3, s18, 917504
    buffer_load_dwordx4 v7, s[24:27], s3 offen  lds
    s_add_u32 s18, s52, 256
    s_and_b32 s18, s18, s55
    s_lshl_b32 s18, s18, 7
    s_add_u32 s18, s18, s49
    s_add_u32 m0, s51, 131072
    s_add_u32 s3, s18, 0
    buffer_load_dwordx4 v14, s[32:35], s3 offen  lds
    s_add_u32 m0, s51, 135168
    s_add_u32 s3, s18, 4096
    buffer_load_dwordx4 v14, s[32:35], s3 offen  lds
    s_add_u32 m0, s51, 139264
    s_add_u32 s3, s18, 8192
    buffer_load_dwordx4 v14, s[32:35], s3 offen  lds
    s_add_u32 m0, s51, 143360
    s_add_u32 s3, s18, 12288
    buffer_load_dwordx4 v14, s[32:35], s3 offen  lds
    s_waitcnt vmcnt(16)
    s_barrier
    s_add_u32 s18, s52, 384
    s_and_b32 s18, s18, s55
    s_lshl_b32 s18, s18, 7
    s_add_u32 s18, s18, s49
    s_add_u32 m0, s51, 147456
    s_add_u32 s3, s18, 0
    buffer_load_dwordx4 v14, s[32:35], s3 offen  lds
    s_add_u32 m0, s51, 151552
    s_add_u32 s3, s18, 4096
    buffer_load_dwordx4 v14, s[32:35], s3 offen  lds
    s_add_u32 m0, s51, 155648
    s_add_u32 s3, s18, 8192
    buffer_load_dwordx4 v14, s[32:35], s3 offen  lds
    s_add_u32 m0, s51, 159744
    s_add_u32 s3, s18, 12288
    buffer_load_dwordx4 v14, s[32:35], s3 offen  lds
    s_waitcnt vmcnt(16)
    s_barrier
    s_add_u32 s18, s52, 384
    s_and_b32 s18, s18, s55
    s_add_u32 s18, s18, s48
    s_add_u32 m0, s51, 0
    s_add_u32 s3, s18, 0
    buffer_load_dwordx4 v7, s[24:27], s3 offen  lds
    s_add_u32 m0, s51, 4096
    s_add_u32 s3, s18, 131072
    buffer_load_dwordx4 v7, s[24:27], s3 offen  lds
    s_add_u32 m0, s51, 8192
    s_add_u32 s3, s18, 262144
    buffer_load_dwordx4 v7, s[24:27], s3 offen  lds
    s_add_u32 m0, s51, 12288
    s_add_u32 s3, s18, 393216
    buffer_load_dwordx4 v7, s[24:27], s3 offen  lds
    s_add_u32 m0, s51, 65536
    s_add_u32 s3, s18, 524288
    buffer_load_dwordx4 v7, s[24:27], s3 offen  lds
    s_add_u32 m0, s51, 69632
    s_add_u32 s3, s18, 655360
    buffer_load_dwordx4 v7, s[24:27], s3 offen  lds
    s_add_u32 m0, s51, 73728
    s_add_u32 s3, s18, 786432
    buffer_load_dwordx4 v7, s[24:27], s3 offen  lds
    s_add_u32 m0, s51, 77824
    s_add_u32 s3, s18, 917504
    buffer_load_dwordx4 v7, s[24:27], s3 offen  lds
    v_lshlrev_b32 v2, 7, v1
    s_add_u32 s3, s68, L_lgo-L_pc0
    buffer_load_dword v10, v2, s[44:47], s3 offen
    s_waitcnt vmcnt(13)
    s_barrier
    s_add_u32 s18, s52, 512
    s_and_b32 s18, s18, s55
    s_add_u32 s18, s18, s48
    s_add_u32 m0, s51, 16384
    s_add_u32 s3, s18, 512
    buffer_load_dwordx4 v7, s[24:27], s3 offen  lds
    s_add_u32 m0, s51, 20480
    s_add_u32 s3, s18, 131584
    buffer_load_dwordx4 v7, s[24:27], s3 offen  lds
    s_add_u32 m0, s51, 24576
    s_add_u32 s3, s18, 262656
    buffer_load_dwordx4 v7, s[24:27], s3 offen  lds
    s_add_u32 m0, s51, 28672
    s_add_u32 s3, s18, 393728
    buffer_load_dwordx4 v7, s[24:27], s3 offen  lds
    s_add_u32 m0, s51, 81920
    s_add_u32 s3, s18, 524800
    buffer_load_dwordx4 v7, s[24:27], s3 offen  lds
    s_add_u32 m0, s51, 86016
    s_add_u32 s3, s18, 655872
    buffer_load_dwordx4 v7, s[24:27], s3 offen  lds
    s_add_u32 m0, s51, 90112
    s_add_u32 s3, s18, 786944
    buffer_load_dwordx4 v7, s[24:27], s3 offen  lds
    s_add_u32 m0, s51, 94208
    s_add_u32 s3, s18, 918016
    buffer_load_dwordx4 v7, s[24:27], s3 offen  lds
    s_add_u32 s18, s52, 512
    s_and_b32 s18, s18, s55
    s_lshl_b32 s18, s18, 7
    s_add_u32 s18, s18, s49
    s_add_u32 m0, s51, 49152
    s_add_u32 s3, s18, 65536
    buffer_load_dwordx4 v14, s[32:35], s3 offen  lds
    s_add_u32 m0, s51, 53248
    s_add_u32 s3, s18, 69632
    buffer_load_dwordx4 v14, s[32:35], s3 offen  lds
    s_add_u32 m0, s51, 57344
    s_add_u32 s3, s18, 73728
    buffer_load_dwordx4 v14, s[32:35], s3 offen  lds
    s_add_u32 m0, s51, 61440
    s_add_u32 s3, s18, 77824
    buffer_load_dwordx4 v14, s[32:35], s3 offen  lds
    s_add_u32 s18, s52, 640
    s_and_b32 s18, s18, s55
    s_lshl_b32 s18, s18, 7
    s_add_u32 s18, s18, s49
    s_add_u32 m0, s51, 114688
    s_add_u32 s3, s18, 65536
    buffer_load_dwordx4 v14, s[32:35], s3 offen  lds
    s_add_u32 m0, s51, 118784
    s_add_u32 s3, s18, 69632
    buffer_load_dwordx4 v14, s[32:35], s3 offen  lds
    s_add_u32 m0, s51, 122880
    s_add_u32 s3, s18, 73728
    buffer_load_dwordx4 v14, s[32:35], s3 offen  lds
    s_add_u32 m0, s51, 126976
    s_add_u32 s3, s18, 77824
    buffer_load_dwordx4 v14, s[32:35], s3 offen  lds
    s_waitcnt vmcnt(17)
    s_barrier
    s_add_u32 s18, s52, 640
    s_and_b32 s18, s18, s55
    s_add_u32 s18, s18, s48
    s_add_u32 m0, s51, 32768
    s_add_u32 s3, s18, 512
    buffer_load_dwordx4 v7, s[24:27], s3 offen  lds
    s_add_u32 m0, s51, 36864
    s_add_u32 s3, s18, 131584
    buffer_load_dwordx4 v7, s[24:27], s3 offen  lds
    s_add_u32 m0, s51, 40960
    s_add_u32 s3, s18, 262656
    buffer_load_dwordx4 v7, s[24:27], s3 offen  lds
    s_add_u32 m0, s51, 45056
    s_add_u32 s3, s18, 393728
    buffer_load_dwordx4 v7, s[24:27], s3 offen  lds
    s_add_u32 m0, s51, 98304
    s_add_u32 s3, s18, 524800
    buffer_load_dwordx4 v7, s[24:27], s3 offen  lds
    s_add_u32 m0, s51, 102400
    s_add_u32 s3, s18, 655872
    buffer_load_dwordx4 v7, s[24:27], s3 offen  lds
    s_add_u32 m0, s51, 106496
    s_add_u32 s3, s18, 786944
    buffer_load_dwordx4 v7, s[24:27], s3 offen  lds
    s_add_u32 m0, s51, 110592
    s_add_u32 s3, s18, 918016
    buffer_load_dwordx4 v7, s[24:27], s3 offen  lds
    s_waitcnt vmcnt(12)
    s_barrier
    s_add_u32 s18, s52, 768
    s_and_b32 s18, s18, s55
    s_add_u32 s18, s18, s48
    s_add_u32 m0, s51, 0
    s_add_u32 s3, s18, 512
    buffer_load_dwordx4 v7, s[24:27], s3 offen  lds
    s_add_u32 m0, s51, 4096
    s_add_u32 s3, s18, 131584
    buffer_load_dwordx4 v7, s[24:27], s3 offen  lds
    s_add_u32 m0, s51, 8192
    s_add_u32 s3, s18, 262656
    buffer_load_dwordx4 v7, s[24:27], s3 offen  lds
    s_add_u32 m0, s51, 12288
    s_add_u32 s3, s18, 393728
    buffer_load_dwordx4 v7, s[24:27], s3 offen  lds
    s_add_u32 m0, s51, 65536
    s_add_u32 s3, s18, 524800
    buffer_load_dwordx4 v7, s[24:27], s3 offen  lds
    s_add_u32 m0, s51, 69632
    s_add_u32 s3, s18, 655872
    buffer_load_dwordx4 v7, s[24:27], s3 offen  lds
    s_add_u32 m0, s51, 73728
    s_add_u32 s3, s18, 786944
    buffer_load_dwordx4 v7, s[24:27], s3 offen  lds
    s_add_u32 m0, s51, 77824
    s_add_u32 s3, s18, 918016
    buffer_load_dwordx4 v7, s[24:27], s3 offen  lds
    s_add_u32 s18, s52, 768
    s_and_b32 s18, s18, s55
    s_lshl_b32 s18, s18, 7
    s_add_u32 s18, s18, s49
    s_add_u32 m0, s51, 131072
    s_add_u32 s3, s18, 65536
    buffer_load_dwordx4 v14, s[32:35], s3 offen  lds
    s_add_u32 m0, s51, 135168
    s_add_u32 s3, s18, 69632
    buffer_load_dwordx4 v14, s[32:35], s3 offen  lds
    s_add_u32 m0, s51, 139264
    s_add_u32 s3, s18, 73728
    buffer_load_dwordx4 v14, s[32:35], s3 offen  lds
    s_add_u32 m0, s51, 143360
    s_add_u32 s3, s18, 77824
    buffer_load_dwordx4 v14, s[32:35], s3 offen  lds
    s_add_u32 s18, s52, 896
    s_and_b32 s18, s18, s55
    s_lshl_b32 s18, s18, 7
    s_add_u32 s18, s18, s49
    s_add_u32 m0, s51, 147456
    s_add_u32 s3, s18, 65536
    buffer_load_dwordx4 v14, s[32:35], s3 offen  lds
    s_add_u32 m0, s51, 151552
    s_add_u32 s3, s18, 69632
    buffer_load_dwordx4 v14, s[32:35], s3 offen  lds
    s_add_u32 m0, s51, 155648
    s_add_u32 s3, s18, 73728
    buffer_load_dwordx4 v14, s[32:35], s3 offen  lds
    s_add_u32 m0, s51, 159744
    s_add_u32 s3, s18, 77824
    buffer_load_dwordx4 v14, s[32:35], s3 offen  lds
    s_waitcnt vmcnt(16)
    s_barrier
    s_add_u32 s18, s52, 896
    s_and_b32 s18, s18, s55
    s_add_u32 s18, s18, s48
    s_add_u32 m0, s51, 16384
    s_add_u32 s3, s18, 512
    buffer_load_dwordx4 v7, s[24:27], s3 offen  lds
    s_add_u32 m0, s51, 20480
    s_add_u32 s3, s18, 131584
    buffer_load_dwordx4 v7, s[24:27], s3 offen  lds
    s_add_u32 m0, s51, 24576
    s_add_u32 s3, s18, 262656
    buffer_load_dwordx4 v7, s[24:27], s3 offen  lds
    s_add_u32 m0, s51, 28672
    s_add_u32 s3, s18, 393728
    buffer_load_dwordx4 v7, s[24:27], s3 offen  lds
    s_add_u32 m0, s51, 81920
    s_add_u32 s3, s18, 524800
    buffer_load_dwordx4 v7, s[24:27], s3 offen  lds
    s_add_u32 m0, s51, 86016
    s_add_u32 s3, s18, 655872
    buffer_load_dwordx4 v7, s[24:27], s3 offen  lds
    s_add_u32 m0, s51, 90112
    s_add_u32 s3, s18, 786944
    buffer_load_dwordx4 v7, s[24:27], s3 offen  lds
    s_add_u32 m0, s51, 94208
    s_add_u32 s3, s18, 918016
    buffer_load_dwordx4 v7, s[24:27], s3 offen  lds
    v_lshlrev_b32 v2, 7, v1
    s_add_u32 s3, s68, L_lgo-L_pc0
    buffer_load_dword v10, v2, s[44:47], s3 offen
    s_waitcnt vmcnt(13)
    s_barrier
    s_add_u32 s18, s52, 1024
    s_and_b32 s18, s18, s55
    s_add_u32 s18, s18, s48
    s_add_u32 m0, s51, 32768
    s_add_u32 s3, s18, 1024
    buffer_load_dwordx4 v7, s[24:27], s3 offen  lds
    s_add_u32 m0, s51, 36864
    s_add_u32 s3, s18, 132096
    buffer_load_dwordx4 v7, s[24:27], s3 offen  lds
    s_add_u32 m0, s51, 40960
    s_add_u32 s3, s18, 263168
    buffer_load_dwordx4 v7, s[24:27], s3 offen  lds
    s_add_u32 m0, s51, 45056
    s_add_u32 s3, s18, 394240
    buffer_load_dwordx4 v7, s[24:27], s3 offen  lds
    s_add_u32 m0, s51, 98304
    s_add_u32 s3, s18, 525312
    buffer_load_dwordx4 v7, s[24:27], s3 offen  lds
    s_add_u32 m0, s51, 102400
    s_add_u32 s3, s18, 656384
    buffer_load_dwordx4 v7, s[24:27], s3 offen  lds
    s_add_u32 m0, s51, 106496
    s_add_u32 s3, s18, 787456
    buffer_load_dwordx4 v7, s[24:27], s3 offen  lds
    s_add_u32 m0, s51, 110592
    s_add_u32 s3, s18, 918528
    buffer_load_dwordx4 v7, s[24:27], s3 offen  lds
    s_add_u32 s18, s52, 1024
    s_and_b32 s18, s18, s55
    s_lshl_b32 s18, s18, 7
    s_add_u32 s18, s18, s49
    s_add_u32 m0, s51, 49152
    s_add_u32 s3, s18, 131072
    buffer_load_dwordx4 v14, s[32:35], s3 offen  lds
    s_add_u32 m0, s51, 53248
    s_add_u32 s3, s18, 135168
    buffer_load_dwordx4 v14, s[32:35], s3 offen  lds
    s_add_u32 m0, s51, 57344
    s_add_u32 s3, s18, 139264
    buffer_load_dwordx4 v14, s[32:35], s3 offen  lds
    s_add_u32 m0, s51, 61440
    s_add_u32 s3, s18, 143360
    buffer_load_dwordx4 v14, s[32:35], s3 offen  lds
    s_add_u32 s18, s52, 1152
    s_and_b32 s18, s18, s55
    s_lshl_b32 s18, s18, 7
    s_add_u32 s18, s18, s49
    s_add_u32 m0, s51, 114688
    s_add_u32 s3, s18, 131072
    buffer_load_dwordx4 v14, s[32:35], s3 offen  lds
    s_add_u32 m0, s51, 118784
    s_add_u32 s3, s18, 135168
    buffer_load_dwordx4 v14, s[32:35], s3 offen  lds
    s_add_u32 m0, s51, 122880
    s_add_u32 s3, s18, 139264
    buffer_load_dwordx4 v14, s[32:35], s3 offen  lds
    s_add_u32 m0, s51, 126976
    s_add_u32 s3, s18, 143360
    buffer_load_dwordx4 v14, s[32:35], s3 offen  lds
    s_waitcnt vmcnt(17)
    s_barrier
    s_add_u32 s18, s52, 1152
    s_and_b32 s18, s18, s55
    s_add_u32 s18, s18, s48
    s_add_u32 m0, s51, 0
    s_add_u32 s3, s18, 1024
    buffer_load_dwordx4 v7, s[24:27], s3 offen  lds
    s_add_u32 m0, s51, 4096
    s_add_u32 s3, s18, 132096
    buffer_load_dwordx4 v7, s[24:27], s3 offen  lds
    s_add_u32 m0, s51, 8192
    s_add_u32 s3, s18, 263168
    buffer_load_dwordx4 v7, s[24:27], s3 offen  lds
    s_add_u32 m0, s51, 12288
    s_add_u32 s3, s18, 394240
    buffer_load_dwordx4 v7, s[24:27], s3 offen  lds
    s_add_u32 m0, s51, 65536
    s_add_u32 s3, s18, 525312
    buffer_load_dwordx4 v7, s[24:27], s3 offen  lds
    s_add_u32 m0, s51, 69632
    s_add_u32 s3, s18, 656384
    buffer_load_dwordx4 v7, s[24:27], s3 offen  lds
    s_add_u32 m0, s51, 73728
    s_add_u32 s3, s18, 787456
    buffer_load_dwordx4 v7, s[24:27], s3 offen  lds
    s_add_u32 m0, s51, 77824
    s_add_u32 s3, s18, 918528
    buffer_load_dwordx4 v7, s[24:27], s3 offen  lds
    s_waitcnt vmcnt(12)
    s_barrier
    s_add_u32 s18, s52, 1280
    s_and_b32 s18, s18, s55
    s_add_u32 s18, s18, s48
    s_add_u32 m0, s51, 16384
    s_add_u32 s3, s18, 1024
    buffer_load_dwordx4 v7, s[24:27], s3 offen  lds
    s_add_u32 m0, s51, 20480
    s_add_u32 s3, s18, 132096
    buffer_load_dwordx4 v7, s[24:27], s3 offen  lds
    s_add_u32 m0, s51, 24576
    s_add_u32 s3, s18, 263168
    buffer_load_dwordx4 v7, s[24:27], s3 offen  lds
    s_add_u32 m0, s51, 28672
    s_add_u32 s3, s18, 394240
    buffer_load_dwordx4 v7, s[24:27], s3 offen  lds
    s_add_u32 m0, s51, 81920
    s_add_u32 s3, s18, 525312
    buffer_load_dwordx4 v7, s[24:27], s3 offen  lds
    s_add_u32 m0, s51, 86016
    s_add_u32 s3, s18, 656384
    buffer_load_dwordx4 v7, s[24:27], s3 offen  lds
    s_add_u32 m0, s51, 90112
    s_add_u32 s3, s18, 787456
    buffer_load_dwordx4 v7, s[24:27], s3 offen  lds
    s_add_u32 m0, s51, 94208
    s_add_u32 s3, s18, 918528
    buffer_load_dwordx4 v7, s[24:27], s3 offen  lds
    s_add_u32 s18, s52, 1280
    s_and_b32 s18, s18, s55
    s_lshl_b32 s18, s18, 7
    s_add_u32 s18, s18, s49
    s_add_u32 m0, s51, 131072
    s_add_u32 s3, s18, 131072
    buffer_load_dwordx4 v14, s[32:35], s3 offen  lds
    s_add_u32 m0, s51, 135168
    s_add_u32 s3, s18, 135168
    buffer_load_dwordx4 v14, s[32:35], s3 offen  lds
    s_add_u32 m0, s51, 139264
    s_add_u32 s3, s18, 139264
    buffer_load_dwordx4 v14, s[32:35], s3 offen  lds
    s_add_u32 m0, s51, 143360
    s_add_u32 s3, s18, 143360
    buffer_load_dwordx4 v14, s[32:35], s3 offen  lds
    s_add_u32 s18, s52, 1408
    s_and_b32 s18, s18, s55
    s_lshl_b32 s18, s18, 7
    s_add_u32 s18, s18, s49
    s_add_u32 m0, s51, 147456
    s_add_u32 s3, s18, 131072
    buffer_load_dwordx4 v14, s[32:35], s3 offen  lds
    s_add_u32 m0, s51, 151552
    s_add_u32 s3, s18, 135168
    buffer_load_dwordx4 v14, s[32:35], s3 offen  lds
    s_add_u32 m0, s51, 155648
    s_add_u32 s3, s18, 139264
    buffer_load_dwordx4 v14, s[32:35], s3 offen  lds
    s_add_u32 m0, s51, 159744
    s_add_u32 s3, s18, 143360
    buffer_load_dwordx4 v14, s[32:35], s3 offen  lds
    s_waitcnt vmcnt(16)
    s_barrier
    s_add_u32 s18, s52, 1408
    s_and_b32 s18, s18, s55
    s_add_u32 s18, s18, s48
    s_add_u32 m0, s51, 32768
    s_add_u32 s3, s18, 1024
    buffer_load_dwordx4 v7, s[24:27], s3 offen  lds
    s_add_u32 m0, s51, 36864
    s_add_u32 s3, s18, 132096
    buffer_load_dwordx4 v7, s[24:27], s3 offen  lds
    s_add_u32 m0, s51, 40960
    s_add_u32 s3, s18, 263168
    buffer_load_dwordx4 v7, s[24:27], s3 offen  lds
    s_add_u32 m0, s51, 45056
    s_add_u32 s3, s18, 394240
    buffer_load_dwordx4 v7, s[24:27], s3 offen  lds
    s_add_u32 m0, s51, 98304
    s_add_u32 s3, s18, 525312
    buffer_load_dwordx4 v7, s[24:27], s3 offen  lds
    s_add_u32 m0, s51, 102400
    s_add_u32 s3, s18, 656384
    buffer_load_dwordx4 v7, s[24:27], s3 offen  lds
    s_add_u32 m0, s51, 106496
    s_add_u32 s3, s18, 787456
    buffer_load_dwordx4 v7, s[24:27], s3 offen  lds
    s_add_u32 m0, s51, 110592
    s_add_u32 s3, s18, 918528
    buffer_load_dwordx4 v7, s[24:27], s3 offen  lds
    v_lshlrev_b32 v2, 7, v1
    s_add_u32 s3, s68, L_lgo-L_pc0
    buffer_load_dword v10, v2, s[44:47], s3 offen
    s_waitcnt vmcnt(13)
    s_barrier
    s_add_u32 s18, s52, 1536
    s_and_b32 s18, s18, s55
    s_add_u32 s18, s18, s48
    s_add_u32 m0, s51, 0
    s_add_u32 s3, s18, 1536
    buffer_load_dwordx4 v7, s[24:27], s3 offen  lds
    s_add_u32 m0, s51, 4096
    s_add_u32 s3, s18, 132608
    buffer_load_dwordx4 v7, s[24:27], s3 offen  lds
    s_add_u32 m0, s51, 8192
    s_add_u32 s3, s18, 263680
    buffer_load_dwordx4 v7, s[24:27], s3 offen  lds
    s_add_u32 m0, s51, 12288
    s_add_u32 s3, s18, 394752
    buffer_load_dwordx4 v7, s[24:27], s3 offen  lds
    s_add_u32 m0, s51, 65536
    s_add_u32 s3, s18, 525824
    buffer_load_dwordx4 v7, s[24:27], s3 offen  lds
    s_add_u32 m0, s51, 69632
    s_add_u32 s3, s18, 656896
    buffer_load_dwordx4 v7, s[24:27], s3 offen  lds
    s_add_u32 m0, s51, 73728
    s_add_u32 s3, s18, 787968
    buffer_load_dwordx4 v7, s[24:27], s3 offen  lds
    s_add_u32 m0, s51, 77824
    s_add_u32 s3, s18, 919040
    buffer_load_dwordx4 v7, s[24:27], s3 offen  lds
    s_add_u32 s18, s52, 1536
    s_and_b32 s18, s18, s55
    s_lshl_b32 s18, s18, 7
    s_add_u32 s18, s18, s49
    s_add_u32 m0, s51, 49152
    s_add_u32 s3, s18, 196608
    buffer_load_dwordx4 v14, s[32:35], s3 offen  lds
    s_add_u32 m0, s51, 53248
    s_add_u32 s3, s18, 200704
    buffer_load_dwordx4 v14, s[32:35], s3 offen  lds
    s_add_u32 m0, s51, 57344
    s_add_u32 s3, s18, 204800
    buffer_load_dwordx4 v14, s[32:35], s3 offen  lds
    s_add_u32 m0, s51, 61440
    s_add_u32 s3, s18, 208896
    buffer_load_dwordx4 v14, s[32:35], s3 offen  lds
    s_add_u32 s18, s52, 1664
    s_and_b32 s18, s18, s55
    s_lshl_b32 s18, s18, 7
    s_add_u32 s18, s18, s49
    s_add_u32 m0, s51, 114688
    s_add_u32 s3, s18, 196608
    buffer_load_dwordx4 v14, s[32:35], s3 offen  lds
    s_add_u32 m0, s51, 118784
    s_add_u32 s3, s18, 200704
    buffer_load_dwordx4 v14, s[32:35], s3 offen  lds
    s_add_u32 m0, s51, 122880
    s_add_u32 s3, s18, 204800
    buffer_load_dwordx4 v14, s[32:35], s3 offen  lds
    s_add_u32 m0, s51, 126976
    s_add_u32 s3, s18, 208896
    buffer_load_dwordx4 v14, s[32:35], s3 offen  lds
    s_waitcnt vmcnt(17)
    s_barrier
    s_add_u32 s18, s52, 1664
    s_and_b32 s18, s18, s55
    s_add_u32 s18, s18, s48
    s_add_u32 m0, s51, 16384
    s_add_u32 s3, s18, 1536
    buffer_load_dwordx4 v7, s[24:27], s3 offen  lds
    s_add_u32 m0, s51, 20480
    s_add_u32 s3, s18, 132608
    buffer_load_dwordx4 v7, s[24:27], s3 offen  lds
    s_add_u32 m0, s51, 24576
    s_add_u32 s3, s18, 263680
    buffer_load_dwordx4 v7, s[24:27], s3 offen  lds
    s_add_u32 m0, s51, 28672
    s_add_u32 s3, s18, 394752
    buffer_load_dwordx4 v7, s[24:27], s3 offen  lds
    s_add_u32 m0, s51, 81920
    s_add_u32 s3, s18, 525824
    buffer_load_dwordx4 v7, s[24:27], s3 offen  lds
    s_add_u32 m0, s51, 86016
    s_add_u32 s3, s18, 656896
    buffer_load_dwordx4 v7, s[24:27], s3 offen  lds
    s_add_u32 m0, s51, 90112
    s_add_u32 s3, s18, 787968
    buffer_load_dwordx4 v7, s[24:27], s3 offen  lds
    s_add_u32 m0, s51, 94208
    s_add_u32 s3, s18, 919040
    buffer_load_dwordx4 v7, s[24:27], s3 offen  lds
    s_waitcnt vmcnt(12)
    s_barrier
    s_add_u32 s18, s52, 1792
    s_and_b32 s18, s18, s55
    s_add_u32 s18, s18, s48
    s_add_u32 m0, s51, 32768
    s_add_u32 s3, s18, 1536
    buffer_load_dwordx4 v7, s[24:27], s3 offen  lds
    s_add_u32 m0, s51, 36864
    s_add_u32 s3, s18, 132608
    buffer_load_dwordx4 v7, s[24:27], s3 offen  lds
    s_add_u32 m0, s51, 40960
    s_add_u32 s3, s18, 263680
    buffer_load_dwordx4 v7, s[24:27], s3 offen  lds
    s_add_u32 m0, s51, 45056
    s_add_u32 s3, s18, 394752
    buffer_load_dwordx4 v7, s[24:27], s3 offen  lds
    s_add_u32 m0, s51, 98304
    s_add_u32 s3, s18, 525824
    buffer_load_dwordx4 v7, s[24:27], s3 offen  lds
    s_add_u32 m0, s51, 102400
    s_add_u32 s3, s18, 656896
    buffer_load_dwordx4 v7, s[24:27], s3 offen  lds
    s_add_u32 m0, s51, 106496
    s_add_u32 s3, s18, 787968
    buffer_load_dwordx4 v7, s[24:27], s3 offen  lds
    s_add_u32 m0, s51, 110592
    s_add_u32 s3, s18, 919040
    buffer_load_dwordx4 v7, s[24:27], s3 offen  lds
    s_add_u32 s18, s52, 1792
    s_and_b32 s18, s18, s55
    s_lshl_b32 s18, s18, 7
    s_add_u32 s18, s18, s49
    s_add_u32 m0, s51, 131072
    s_add_u32 s3, s18, 196608
    buffer_load_dwordx4 v14, s[32:35], s3 offen  lds
    s_add_u32 m0, s51, 135168
    s_add_u32 s3, s18, 200704
    buffer_load_dwordx4 v14, s[32:35], s3 offen  lds
    s_add_u32 m0, s51, 139264
    s_add_u32 s3, s18, 204800
    buffer_load_dwordx4 v14, s[32:35], s3 offen  lds
    s_add_u32 m0, s51, 143360
    s_add_u32 s3, s18, 208896
    buffer_load_dwordx4 v14, s[32:35], s3 offen  lds
    s_add_u32 s18, s52, 1920
    s_and_b32 s18, s18, s55
    s_lshl_b32 s18, s18, 7
    s_add_u32 s18, s18, s49
    s_add_u32 m0, s51, 147456
    s_add_u32 s3, s18, 196608
    buffer_load_dwordx4 v14, s[32:35], s3 offen  lds
    s_add_u32 m0, s51, 151552
    s_add_u32 s3, s18, 200704
    buffer_load_dwordx4 v14, s[32:35], s3 offen  lds
    s_add_u32 m0, s51, 155648
    s_add_u32 s3, s18, 204800
    buffer_load_dwordx4 v14, s[32:35], s3 offen  lds
    s_add_u32 m0, s51, 159744
    s_add_u32 s3, s18, 208896
    buffer_load_dwordx4 v14, s[32:35], s3 offen  lds
    s_waitcnt vmcnt(16)
    s_barrier
    s_add_u32 s18, s52, 1920
    s_and_b32 s18, s18, s55
    s_add_u32 s18, s18, s48
    s_add_u32 m0, s51, 0
    s_add_u32 s3, s18, 1536
    buffer_load_dwordx4 v7, s[24:27], s3 offen  lds
    s_add_u32 m0, s51, 4096
    s_add_u32 s3, s18, 132608
    buffer_load_dwordx4 v7, s[24:27], s3 offen  lds
    s_add_u32 m0, s51, 8192
    s_add_u32 s3, s18, 263680
    buffer_load_dwordx4 v7, s[24:27], s3 offen  lds
    s_add_u32 m0, s51, 12288
    s_add_u32 s3, s18, 394752
    buffer_load_dwordx4 v7, s[24:27], s3 offen  lds
    s_add_u32 m0, s51, 65536
    s_add_u32 s3, s18, 525824
    buffer_load_dwordx4 v7, s[24:27], s3 offen  lds
    s_add_u32 m0, s51, 69632
    s_add_u32 s3, s18, 656896
    buffer_load_dwordx4 v7, s[24:27], s3 offen  lds
    s_add_u32 m0, s51, 73728
    s_add_u32 s3, s18, 787968
    buffer_load_dwordx4 v7, s[24:27], s3 offen  lds
    s_add_u32 m0, s51, 77824
    s_add_u32 s3, s18, 919040
    buffer_load_dwordx4 v7, s[24:27], s3 offen  lds
    s_add_u32 s3, s59, 0
    buffer_load_dwordx4 v[16:19], v14, s[32:35], s3 offen offset:0
    buffer_load_dwordx4 v[20:23], v14, s[32:35], s3 offen offset:1024
    buffer_load_dwordx4 v[24:27], v14, s[32:35], s3 offen offset:2048
    buffer_load_dwordx4 v[28:31], v14, s[32:35], s3 offen offset:3072
    s_add_u32 s3, s59, 28672
    buffer_load_dwordx4 v[32:35], v14, s[32:35], s3 offen offset:0
    buffer_load_dwordx4 v[36:39], v14, s[32:35], s3 offen offset:1024
    buffer_load_dwordx4 v[40:43], v14, s[32:35], s3 offen offset:2048
    buffer_load_dwordx4 v[44:47], v14, s[32:35], s3 offen offset:3072
    v_lshlrev_b32 v2, 7, v1
    s_add_u32 s3, s68, L_lgo-L_pc0
    buffer_load_dword v10, v2, s[44:47], s3 offen
    s_waitcnt vmcnt(21)
    s_barrier
    s_add_u32 s3, s59, 57344
    buffer_load_dwordx4 v[48:51], v14, s[32:35], s3 offen offset:0
    buffer_load_dwordx4 v[52:55], v14, s[32:35], s3 offen offset:1024
    buffer_load_dwordx4 v[56:59], v14, s[32:35], s3 offen offset:2048
    buffer_load_dwordx4 v[60:63], v14, s[32:35], s3 offen offset:3072
    s_add_u32 s3, s59, 86016
    buffer_load_dwordx4 v[64:67], v14, s[32:35], s3 offen offset:0
    buffer_load_dwordx4 v[68:71], v14, s[32:35], s3 offen offset:1024
    buffer_load_dwordx4 v[72:75], v14, s[32:35], s3 offen offset:2048
    buffer_load_dwordx4 v[76:79], v14, s[32:35], s3 offen offset:3072
    s_bfe_u32 s3, s66, 0x30002
    s_mul_i32 s3, s3, 28672
    s_add_u32 s3, s3, s59
    v_lshlrev_b32 v2, 7, v1
    s_add_u32 s3, s3, 4096
    s_mov_b64 exec, 0xffffff
    buffer_load_dword v10, v2, s[32:35], s3 offen
    s_mov_b64 exec, -1
    s_waitcnt vmcnt(18)
    s_barrier
    s_add_u32 s3, s59, 114688
    buffer_load_dwordx4 v[80:83], v14, s[32:35], s3 offen offset:0
    buffer_load_dwordx4 v[84:87], v14, s[32:35], s3 offen offset:1024
    buffer_load_dwordx4 v[88:91], v14, s[32:35], s3 offen offset:2048
    buffer_load_dwordx4 v[92:95], v14, s[32:35], s3 offen offset:3072
    s_add_u32 s3, s59, 143360
    buffer_load_dwordx4 v[96:99], v14, s[32:35], s3 offen offset:0
    buffer_load_dwordx4 v[100:103], v14, s[32:35], s3 offen offset:1024
    buffer_load_dwordx4 v[104:107], v14, s[32:35], s3 offen offset:2048
    buffer_load_dwordx4 v[108:111], v14, s[32:35], s3 offen offset:3072
    s_barrier
    s_add_u32 s3, s59, 172032
    buffer_load_dwordx4 v[112:115], v14, s[32:35], s3 offen offset:0
    buffer_load_dwordx4 v[116:119], v14, s[32:35], s3 offen offset:1024
    buffer_load_dwordx4 v[120:123], v14, s[32:35], s3 offen offset:2048
    buffer_load_dwordx4 v[124:127], v14, s[32:35], s3 offen offset:3072
    s_add_u32 s3, s59, 200704
    buffer_load_dwordx4 v[128:131], v14, s[32:35], s3 offen offset:0
    buffer_load_dwordx4 v[132:135], v14, s[32:35], s3 offen offset:1024
    buffer_load_dwordx4 v[136:139], v14, s[32:35], s3 offen offset:2048
    buffer_load_dwordx4 v[140:143], v14, s[32:35], s3 offen offset:3072
    s_branch L_p3l
L_lg:
    s_add_u32 s18, s52, 0
    s_and_b32 s18, s18, s55
    s_lshl_b32 s18, s18, 7
    s_add_u32 s18, s18, s49
    s_add_u32 m0, s51, 49152
    s_add_u32 s3, s18, 0
    buffer_load_dwordx4 v14, s[32:35], s3 offen  lds
    s_add_u32 m0, s51, 53248
    s_add_u32 s3, s18, 4096
    buffer_load_dwordx4 v14, s[32:35], s3 offen  lds
    s_add_u32 m0, s51, 57344
    s_add_u32 s3, s18, 8192
    buffer_load_dwordx4 v14, s[32:35], s3 offen  lds
    s_add_u32 m0, s51, 61440
    s_add_u32 s3, s18, 12288
    buffer_load_dwordx4 v14, s[32:35], s3 offen  lds
    s_add_u32 s18, s52, 128
    s_and_b32 s18, s18, s55
    s_lshl_b32 s18, s18, 7
    s_add_u32 s18, s18, s49
    s_add_u32 m0, s51, 114688
    s_add_u32 s3, s18, 0
    buffer_load_dwordx4 v14, s[32:35], s3 offen  lds
    s_add_u32 m0, s51, 118784
    s_add_u32 s3, s18, 4096
    buffer_load_dwordx4 v14, s[32:35], s3 offen  lds
    s_add_u32 m0, s51, 122880
    s_add_u32 s3, s18, 8192
    buffer_load_dwordx4 v14, s[32:35], s3 offen  lds
    s_add_u32 m0, s51, 126976
    s_add_u32 s3, s18, 12288
    buffer_load_dwordx4 v14, s[32:35], s3 offen  lds
    s_add_u32 s18, s52, 256
    s_and_b32 s18, s18, s55
    s_add_u32 s18, s18, s48
    s_add_u32 m0, s51, 32768
    s_add_u32 s3, s18, 0
    buffer_load_dwordx4 v7, s[24:27], s3 offen  lds
    s_add_u32 m0, s51, 36864
    s_add_u32 s3, s18, 131072
    buffer_load_dwordx4 v7, s[24:27], s3 offen  lds
    s_add_u32 m0, s51, 40960
    s_add_u32 s3, s18, 262144
    buffer_load_dwordx4 v7, s[24:27], s3 offen  lds
    s_add_u32 m0, s51, 45056
    s_add_u32 s3, s18, 393216
    buffer_load_dwordx4 v7, s[24:27], s3 offen  lds
    s_add_u32 m0, s51, 98304
    s_add_u32 s3, s18, 524288
    buffer_load_dwordx4 v7, s[24:27], s3 offen  lds
    s_add_u32 m0, s51, 102400
    s_add_u32 s3, s18, 655360
    buffer_load_dwordx4 v7, s[24:27], s3 offen  lds
    s_add_u32 m0, s51, 106496
    s_add_u32 s3, s18, 786432
    buffer_load_dwordx4 v7, s[24:27], s3 offen  lds
    s_add_u32 m0, s51, 110592
    s_add_u32 s3, s18, 917504
    buffer_load_dwordx4 v7, s[24:27], s3 offen  lds
    s_add_u32 s18, s52, 256
    s_and_b32 s18, s18, s55
    s_lshl_b32 s18, s18, 7
    s_add_u32 s18, s18, s49
    s_add_u32 m0, s51, 131072
    s_add_u32 s3, s18, 0
    buffer_load_dwordx4 v14, s[32:35], s3 offen  lds
    s_add_u32 m0, s51, 135168
    s_add_u32 s3, s18, 4096
    buffer_load_dwordx4 v14, s[32:35], s3 offen  lds
    s_add_u32 m0, s51, 139264
    s_add_u32 s3, s18, 8192
    buffer_load_dwordx4 v14, s[32:35], s3 offen  lds
    s_add_u32 m0, s51, 143360
    s_add_u32 s3, s18, 12288
    buffer_load_dwordx4 v14, s[32:35], s3 offen  lds
    s_waitcnt vmcnt(16)
    s_barrier
    s_add_u32 s18, s52, 384
    s_and_b32 s18, s18, s55
    s_lshl_b32 s18, s18, 7
    s_add_u32 s18, s18, s49
    s_add_u32 m0, s51, 147456
    s_add_u32 s3, s18, 0
    buffer_load_dwordx4 v14, s[32:35], s3 offen  lds
    s_add_u32 m0, s51, 151552
    s_add_u32 s3, s18, 4096
    buffer_load_dwordx4 v14, s[32:35], s3 offen  lds
    s_add_u32 m0, s51, 155648
    s_add_u32 s3, s18, 8192
    buffer_load_dwordx4 v14, s[32:35], s3 offen  lds
    s_add_u32 m0, s51, 159744
    s_add_u32 s3, s18, 12288
    buffer_load_dwordx4 v14, s[32:35], s3 offen  lds
    s_waitcnt vmcnt(16)
    s_barrier
    s_add_u32 s18, s52, 384
    s_and_b32 s18, s18, s55
    s_add_u32 s18, s18, s48
    s_add_u32 m0, s51, 0
    s_add_u32 s3, s18, 0
    buffer_load_dwordx4 v7, s[24:27], s3 offen  lds
    s_add_u32 m0, s51, 4096
    s_add_u32 s3, s18, 131072
    buffer_load_dwordx4 v7, s[24:27], s3 offen  lds
    s_add_u32 m0, s51, 8192
    s_add_u32 s3, s18, 262144
    buffer_load_dwordx4 v7, s[24:27], s3 offen  lds
    s_add_u32 m0, s51, 12288
    s_add_u32 s3, s18, 393216
    buffer_load_dwordx4 v7, s[24:27], s3 offen  lds
    s_add_u32 m0, s51, 65536
    s_add_u32 s3, s18, 524288
    buffer_load_dwordx4 v7, s[24:27], s3 offen  lds
    s_add_u32 m0, s51, 69632
    s_add_u32 s3, s18, 655360
    buffer_load_dwordx4 v7, s[24:27], s3 offen  lds
    s_add_u32 m0, s51, 73728
    s_add_u32 s3, s18, 786432
    buffer_load_dwordx4 v7, s[24:27], s3 offen  lds
    s_add_u32 m0, s51, 77824
    s_add_u32 s3, s18, 917504
    buffer_load_dwordx4 v7, s[24:27], s3 offen  lds
    s_mov_b32 exec_lo, 0xf0f0f
    s_mov_b32 exec_hi, 0
    s_mov_b32 s3, 28573696
    buffer_load_dword v16, v13, s[32:35], s3 offen sc1
    s_mov_b64 exec, -1
    v_lshlrev_b32 v2, 7, v1
    s_add_u32 s3, s68, L_lgo-L_pc0
    buffer_load_dword v10, v2, s[44:47], s3 offen
    s_waitcnt vmcnt(14)
    s_barrier
    s_add_u32 s18, s52, 512
    s_and_b32 s18, s18, s55
    s_add_u32 s18, s18, s48
    s_add_u32 m0, s51, 16384
    s_add_u32 s3, s18, 0
    buffer_load_dwordx4 v7, s[24:27], s3 offen  lds
    s_add_u32 m0, s51, 20480
    s_add_u32 s3, s18, 131072
    buffer_load_dwordx4 v7, s[24:27], s3 offen  lds
    s_add_u32 m0, s51, 24576
    s_add_u32 s3, s18, 262144
    buffer_load_dwordx4 v7, s[24:27], s3 offen  lds
    s_add_u32 m0, s51, 28672
    s_add_u32 s3, s18, 393216
    buffer_load_dwordx4 v7, s[24:27], s3 offen  lds
    s_add_u32 m0, s51, 81920
    s_add_u32 s3, s18, 524288
    buffer_load_dwordx4 v7, s[24:27], s3 offen  lds
    s_add_u32 m0, s51, 86016
    s_add_u32 s3, s18, 655360
    buffer_load_dwordx4 v7, s[24:27], s3 offen  lds
    s_add_u32 m0, s51, 90112
    s_add_u32 s3, s18, 786432
    buffer_load_dwordx4 v7, s[24:27], s3 offen  lds
    s_add_u32 m0, s51, 94208
    s_add_u32 s3, s18, 917504
    buffer_load_dwordx4 v7, s[24:27], s3 offen  lds
    s_waitcnt vmcnt(9)
    s_mov_b32 exec_lo, 0xf0f0f
    s_mov_b32 exec_hi, 0
    v_cmp_eq_u32 vcc, 0, v16
    s_mov_b32 s18, 131072
    s_mov_b32 s3, 28573696
    s_cmp_eq_u64 vcc, 0
    s_cbranch_scc1 L_g2c0w
L_g2c0p:
    buffer_load_dword v16, v13, s[32:35], s3 offen sc1
    s_waitcnt vmcnt(0)
    v_cmp_eq_u32 vcc, 0, v16
    s_sub_u32 s18, s18, 1
    s_cmp_eq_u64 vcc, 0
    s_cbranch_scc1 L_g2c0w
    s_sleep 2
    s_cmp_gt_i32 s18, 0
    s_cbranch_scc1 L_g2c0p
L_g2c0w:
    s_mov_b64 exec, -1
    s_add_u32 s18, s52, 512
    s_and_b32 s18, s18, s55
    s_lshl_b32 s18, s18, 7
    s_add_u32 s18, s18, s49
    s_add_u32 m0, s51, 49152
    s_add_u32 s3, s18, 0
    buffer_load_dwordx4 v14, s[32:35], s3 offen  lds
    s_add_u32 m0, s51, 53248
    s_add_u32 s3, s18, 4096
    buffer_load_dwordx4 v14, s[32:35], s3 offen  lds
    s_add_u32 m0, s51, 57344
    s_add_u32 s3, s18, 8192
    buffer_load_dwordx4 v14, s[32:35], s3 offen  lds
    s_add_u32 m0, s51, 61440
    s_add_u32 s3, s18, 12288
    buffer_load_dwordx4 v14, s[32:35], s3 offen  lds
    s_add_u32 s18, s52, 640
    s_and_b32 s18, s18, s55
    s_lshl_b32 s18, s18, 7
    s_add_u32 s18, s18, s49
    s_add_u32 m0, s51, 114688
    s_add_u32 s3, s18, 0
    buffer_load_dwordx4 v14, s[32:35], s3 offen  lds
    s_add_u32 m0, s51, 118784
    s_add_u32 s3, s18, 4096
    buffer_load_dwordx4 v14, s[32:35], s3 offen  lds
    s_add_u32 m0, s51, 122880
    s_add_u32 s3, s18, 8192
    buffer_load_dwordx4 v14, s[32:35], s3 offen  lds
    s_add_u32 m0, s51, 126976
    s_add_u32 s3, s18, 12288
    buffer_load_dwordx4 v14, s[32:35], s3 offen  lds
    s_add_u32 s3, s50, 0
    buffer_load_dwordx4 v[144:147], v14, s[32:35], s3 offen
    s_add_u32 s3, s50, 28672
    buffer_load_dwordx4 v[148:151], v14, s[32:35], s3 offen
    s_barrier
    s_add_u32 s18, s52, 640
    s_and_b32 s18, s18, s55
    s_add_u32 s18, s18, s48
    s_add_u32 m0, s51, 32768
    s_add_u32 s3, s18, 0
    buffer_load_dwordx4 v7, s[24:27], s3 offen  lds
    s_add_u32 m0, s51, 36864
    s_add_u32 s3, s18, 131072
    buffer_load_dwordx4 v7, s[24:27], s3 offen  lds
    s_add_u32 m0, s51, 40960
    s_add_u32 s3, s18, 262144
    buffer_load_dwordx4 v7, s[24:27], s3 offen  lds
    s_add_u32 m0, s51, 45056
    s_add_u32 s3, s18, 393216
    buffer_load_dwordx4 v7, s[24:27], s3 offen  lds
    s_add_u32 m0, s51, 98304
    s_add_u32 s3, s18, 524288
    buffer_load_dwordx4 v7, s[24:27], s3 offen  lds
    s_add_u32 m0, s51, 102400
    s_add_u32 s3, s18, 655360
    buffer_load_dwordx4 v7, s[24:27], s3 offen  lds
    s_add_u32 m0, s51, 106496
    s_add_u32 s3, s18, 786432
    buffer_load_dwordx4 v7, s[24:27], s3 offen  lds
    s_add_u32 m0, s51, 110592
    s_add_u32 s3, s18, 917504
    buffer_load_dwordx4 v7, s[24:27], s3 offen  lds
    s_add_u32 s3, s50, 57344
    buffer_load_dwordx4 v[152:155], v14, s[32:35], s3 offen
    s_add_u32 s3, s50, 86016
    buffer_load_dwordx4 v[156:159], v14, s[32:35], s3 offen
    s_waitcnt vmcnt(16)
    s_barrier
    s_add_u32 s18, s52, 768
    s_and_b32 s18, s18, s55
    s_add_u32 s18, s18, s48
    s_add_u32 m0, s51, 0
    s_add_u32 s3, s18, 0
    buffer_load_dwordx4 v7, s[24:27], s3 offen  lds
    s_add_u32 m0, s51, 4096
    s_add_u32 s3, s18, 131072
    buffer_load_dwordx4 v7, s[24:27], s3 offen  lds
    s_add_u32 m0, s51, 8192
    s_add_u32 s3, s18, 262144
    buffer_load_dwordx4 v7, s[24:27], s3 offen  lds
    s_add_u32 m0, s51, 12288
    s_add_u32 s3, s18, 393216
    buffer_load_dwordx4 v7, s[24:27], s3 offen  lds
    s_add_u32 m0, s51, 65536
    s_add_u32 s3, s18, 524288
    buffer_load_dwordx4 v7, s[24:27], s3 offen  lds
    s_add_u32 m0, s51, 69632
    s_add_u32 s3, s18, 655360
    buffer_load_dwordx4 v7, s[24:27], s3 offen  lds
    s_add_u32 m0, s51, 73728
    s_add_u32 s3, s18, 786432
    buffer_load_dwordx4 v7, s[24:27], s3 offen  lds
    s_add_u32 m0, s51, 77824
    s_add_u32 s3, s18, 917504
    buffer_load_dwordx4 v7, s[24:27], s3 offen  lds
    s_add_u32 s18, s52, 768
    s_and_b32 s18, s18, s55
    s_lshl_b32 s18, s18, 7
    s_add_u32 s18, s18, s49
    s_add_u32 m0, s51, 131072
    s_add_u32 s3, s18, 0
    buffer_load_dwordx4 v14, s[32:35], s3 offen  lds
    s_add_u32 m0, s51, 135168
    s_add_u32 s3, s18, 4096
    buffer_load_dwordx4 v14, s[32:35], s3 offen  lds
    s_add_u32 m0, s51, 139264
    s_add_u32 s3, s18, 8192
    buffer_load_dwordx4 v14, s[32:35], s3 offen  lds
    s_add_u32 m0, s51, 143360
    s_add_u32 s3, s18, 12288
    buffer_load_dwordx4 v14, s[32:35], s3 offen  lds
    s_add_u32 s18, s52, 896
    s_and_b32 s18, s18, s55
    s_lshl_b32 s18, s18, 7
    s_add_u32 s18, s18, s49
    s_add_u32 m0, s51, 147456
    s_add_u32 s3, s18, 0
    buffer_load_dwordx4 v14, s[32:35], s3 offen  lds
    s_add_u32 m0, s51, 151552
    s_add_u32 s3, s18, 4096
    buffer_load_dwordx4 v14, s[32:35], s3 offen  lds
    s_add_u32 m0, s51, 155648
    s_add_u32 s3, s18, 8192
    buffer_load_dwordx4 v14, s[32:35], s3 offen  lds
    s_add_u32 m0, s51, 159744
    s_add_u32 s3, s18, 12288
    buffer_load_dwordx4 v14, s[32:35], s3 offen  lds
    s_mov_b32 exec_lo, 0xffff
    s_mov_b32 exec_hi, 0
    s_mov_b32 s3, 28573696
    buffer_load_dword v17, v13, s[32:35], s3 offen sc1
    s_mov_b64 exec, -1
    s_waitcnt vmcnt(19)
    s_barrier
    s_add_u32 s18, s52, 896
    s_and_b32 s18, s18, s55
    s_add_u32 s18, s18, s48
    s_add_u32 m0, s51, 16384
    s_add_u32 s3, s18, 0
    buffer_load_dwordx4 v7, s[24:27], s3 offen  lds
    s_add_u32 m0, s51, 20480
    s_add_u32 s3, s18, 131072
    buffer_load_dwordx4 v7, s[24:27], s3 offen  lds
    s_add_u32 m0, s51, 24576
    s_add_u32 s3, s18, 262144
    buffer_load_dwordx4 v7, s[24:27], s3 offen  lds
    s_add_u32 m0, s51, 28672
    s_add_u32 s3, s18, 393216
    buffer_load_dwordx4 v7, s[24:27], s3 offen  lds
    s_add_u32 m0, s51, 81920
    s_add_u32 s3, s18, 524288
    buffer_load_dwordx4 v7, s[24:27], s3 offen  lds
    s_add_u32 m0, s51, 86016
    s_add_u32 s3, s18, 655360
    buffer_load_dwordx4 v7, s[24:27], s3 offen  lds
    s_add_u32 m0, s51, 90112
    s_add_u32 s3, s18, 786432
    buffer_load_dwordx4 v7, s[24:27], s3 offen  lds
    s_add_u32 m0, s51, 94208
    s_add_u32 s3, s18, 917504
    buffer_load_dwordx4 v7, s[24:27], s3 offen  lds
    s_add_u32 s3, s50, 114688
    buffer_load_dwordx4 v[160:163], v14, s[32:35], s3 offen
    s_add_u32 s3, s50, 143360
    buffer_load_dwordx4 v[164:167], v14, s[32:35], s3 offen
    v_lshlrev_b32 v2, 7, v1
    s_add_u32 s3, s68, L_lgo-L_pc0
    buffer_load_dword v10, v2, s[44:47], s3 offen
    s_waitcnt vmcnt(16)
    s_barrier
    s_add_u32 s18, s52, 1024
    s_and_b32 s18, s18, s55
    s_add_u32 s18, s18, s48
    s_add_u32 m0, s51, 32768
    s_add_u32 s3, s18, 1024
    buffer_load_dwordx4 v7, s[24:27], s3 offen  lds
    s_add_u32 m0, s51, 36864
    s_add_u32 s3, s18, 132096
    buffer_load_dwordx4 v7, s[24:27], s3 offen  lds
    s_add_u32 m0, s51, 40960
    s_add_u32 s3, s18, 263168
    buffer_load_dwordx4 v7, s[24:27], s3 offen  lds
    s_add_u32 m0, s51, 45056
    s_add_u32 s3, s18, 394240
    buffer_load_dwordx4 v7, s[24:27], s3 offen  lds
    s_add_u32 m0, s51, 98304
    s_add_u32 s3, s18, 525312
    buffer_load_dwordx4 v7, s[24:27], s3 offen  lds
    s_add_u32 m0, s51, 102400
    s_add_u32 s3, s18, 656384
    buffer_load_dwordx4 v7, s[24:27], s3 offen  lds
    s_add_u32 m0, s51, 106496
    s_add_u32 s3, s18, 787456
    buffer_load_dwordx4 v7, s[24:27], s3 offen  lds
    s_add_u32 m0, s51, 110592
    s_add_u32 s3, s18, 918528
    buffer_load_dwordx4 v7, s[24:27], s3 offen  lds
    s_waitcnt vmcnt(19)
    s_mov_b32 exec_lo, 0xffff
    s_mov_b32 exec_hi, 0
    v_cmp_eq_u32 vcc, 0, v17
    s_mov_b32 s18, 131072
    s_mov_b32 s3, 28573696
    s_cmp_eq_u64 vcc, 0
    s_cbranch_scc1 L_g2c1w
L_g2c1p:
    buffer_load_dword v17, v13, s[32:35], s3 offen sc1
    s_waitcnt vmcnt(0)
    v_cmp_eq_u32 vcc, 0, v17
    s_sub_u32 s18, s18, 1
    s_cmp_eq_u64 vcc, 0
    s_cbranch_scc1 L_g2c1w
    s_sleep 2
    s_cmp_gt_i32 s18, 0
    s_cbranch_scc1 L_g2c1p
L_g2c1w:
    s_mov_b64 exec, -1
    s_add_u32 s18, s52, 1024
    s_and_b32 s18, s18, s55
    s_lshl_b32 s18, s18, 7
    s_add_u32 s18, s18, s49
    s_add_u32 m0, s51, 49152
    s_add_u32 s3, s18, 131072
    buffer_load_dwordx4 v14, s[32:35], s3 offen  lds
    s_add_u32 m0, s51, 53248
    s_add_u32 s3, s18, 135168
    buffer_load_dwordx4 v14, s[32:35], s3 offen  lds
    s_add_u32 m0, s51, 57344
    s_add_u32 s3, s18, 139264
    buffer_load_dwordx4 v14, s[32:35], s3 offen  lds
    s_add_u32 m0, s51, 61440
    s_add_u32 s3, s18, 143360
    buffer_load_dwordx4 v14, s[32:35], s3 offen  lds
    s_add_u32 s18, s52, 1152
    s_and_b32 s18, s18, s55
    s_lshl_b32 s18, s18, 7
    s_add_u32 s18, s18, s49
    s_add_u32 m0, s51, 114688
    s_add_u32 s3, s18, 131072
    buffer_load_dwordx4 v14, s[32:35], s3 offen  lds
    s_add_u32 m0, s51, 118784
    s_add_u32 s3, s18, 135168
    buffer_load_dwordx4 v14, s[32:35], s3 offen  lds
    s_add_u32 m0, s51, 122880
    s_add_u32 s3, s18, 139264
    buffer_load_dwordx4 v14, s[32:35], s3 offen  lds
    s_add_u32 m0, s51, 126976
    s_add_u32 s3, s18, 143360
    buffer_load_dwordx4 v14, s[32:35], s3 offen  lds
    s_waitcnt vmcnt(19)
    s_barrier
    s_add_u32 s18, s52, 1152
    s_and_b32 s18, s18, s55
    s_add_u32 s18, s18, s48
    s_add_u32 m0, s51, 0
    s_add_u32 s3, s18, 1024
    buffer_load_dwordx4 v7, s[24:27], s3 offen  lds
    s_add_u32 m0, s51, 4096
    s_add_u32 s3, s18, 132096
    buffer_load_dwordx4 v7, s[24:27], s3 offen  lds
    s_add_u32 m0, s51, 8192
    s_add_u32 s3, s18, 263168
    buffer_load_dwordx4 v7, s[24:27], s3 offen  lds
    s_add_u32 m0, s51, 12288
    s_add_u32 s3, s18, 394240
    buffer_load_dwordx4 v7, s[24:27], s3 offen  lds
    s_add_u32 m0, s51, 65536
    s_add_u32 s3, s18, 525312
    buffer_load_dwordx4 v7, s[24:27], s3 offen  lds
    s_add_u32 m0, s51, 69632
    s_add_u32 s3, s18, 656384
    buffer_load_dwordx4 v7, s[24:27], s3 offen  lds
    s_add_u32 m0, s51, 73728
    s_add_u32 s3, s18, 787456
    buffer_load_dwordx4 v7, s[24:27], s3 offen  lds
    s_add_u32 m0, s51, 77824
    s_add_u32 s3, s18, 918528
    buffer_load_dwordx4 v7, s[24:27], s3 offen  lds
    s_add_u32 s3, s50, 172032
    buffer_load_dwordx4 v[168:171], v14, s[32:35], s3 offen
    s_add_u32 s3, s50, 200704
    buffer_load_dwordx4 v[172:175], v14, s[32:35], s3 offen
    s_waitcnt vmcnt(14)
    s_barrier
    s_add_u32 s18, s52, 1280
    s_and_b32 s18, s18, s55
    s_add_u32 s18, s18, s48
    s_add_u32 m0, s51, 16384
    s_add_u32 s3, s18, 1024
    buffer_load_dwordx4 v7, s[24:27], s3 offen  lds
    s_add_u32 m0, s51, 20480
    s_add_u32 s3, s18, 132096
    buffer_load_dwordx4 v7, s[24:27], s3 offen  lds
    s_add_u32 m0, s51, 24576
    s_add_u32 s3, s18, 263168
    buffer_load_dwordx4 v7, s[24:27], s3 offen  lds
    s_add_u32 m0, s51, 28672
    s_add_u32 s3, s18, 394240
    buffer_load_dwordx4 v7, s[24:27], s3 offen  lds
    s_add_u32 m0, s51, 81920
    s_add_u32 s3, s18, 525312
    buffer_load_dwordx4 v7, s[24:27], s3 offen  lds
    s_add_u32 m0, s51, 86016
    s_add_u32 s3, s18, 656384
    buffer_load_dwordx4 v7, s[24:27], s3 offen  lds
    s_add_u32 m0, s51, 90112
    s_add_u32 s3, s18, 787456
    buffer_load_dwordx4 v7, s[24:27], s3 offen  lds
    s_add_u32 m0, s51, 94208
    s_add_u32 s3, s18, 918528
    buffer_load_dwordx4 v7, s[24:27], s3 offen  lds
    s_add_u32 s18, s52, 1280
    s_and_b32 s18, s18, s55
    s_lshl_b32 s18, s18, 7
    s_add_u32 s18, s18, s49
    s_add_u32 m0, s51, 131072
    s_add_u32 s3, s18, 131072
    buffer_load_dwordx4 v14, s[32:35], s3 offen  lds
    s_add_u32 m0, s51, 135168
    s_add_u32 s3, s18, 135168
    buffer_load_dwordx4 v14, s[32:35], s3 offen  lds
    s_add_u32 m0, s51, 139264
    s_add_u32 s3, s18, 139264
    buffer_load_dwordx4 v14, s[32:35], s3 offen  lds
    s_add_u32 m0, s51, 143360
    s_add_u32 s3, s18, 143360
    buffer_load_dwordx4 v14, s[32:35], s3 offen  lds
    s_add_u32 s18, s52, 1408
    s_and_b32 s18, s18, s55
    s_lshl_b32 s18, s18, 7
    s_add_u32 s18, s18, s49
    s_add_u32 m0, s51, 147456
    s_add_u32 s3, s18, 131072
    buffer_load_dwordx4 v14, s[32:35], s3 offen  lds
    s_add_u32 m0, s51, 151552
    s_add_u32 s3, s18, 135168
    buffer_load_dwordx4 v14, s[32:35], s3 offen  lds
    s_add_u32 m0, s51, 155648
    s_add_u32 s3, s18, 139264
    buffer_load_dwordx4 v14, s[32:35], s3 offen  lds
    s_add_u32 m0, s51, 159744
    s_add_u32 s3, s18, 143360
    buffer_load_dwordx4 v14, s[32:35], s3 offen  lds
    s_waitcnt vmcnt(18)
    s_barrier
    s_add_u32 s18, s52, 1408
    s_and_b32 s18, s18, s55
    s_add_u32 s18, s18, s48
    s_add_u32 m0, s51, 32768
    s_add_u32 s3, s18, 1024
    buffer_load_dwordx4 v7, s[24:27], s3 offen  lds
    s_add_u32 m0, s51, 36864
    s_add_u32 s3, s18, 132096
    buffer_load_dwordx4 v7, s[24:27], s3 offen  lds
    s_add_u32 m0, s51, 40960
    s_add_u32 s3, s18, 263168
    buffer_load_dwordx4 v7, s[24:27], s3 offen  lds
    s_add_u32 m0, s51, 45056
    s_add_u32 s3, s18, 394240
    buffer_load_dwordx4 v7, s[24:27], s3 offen  lds
    s_add_u32 m0, s51, 98304
    s_add_u32 s3, s18, 525312
    buffer_load_dwordx4 v7, s[24:27], s3 offen  lds
    s_add_u32 m0, s51, 102400
    s_add_u32 s3, s18, 656384
    buffer_load_dwordx4 v7, s[24:27], s3 offen  lds
    s_add_u32 m0, s51, 106496
    s_add_u32 s3, s18, 787456
    buffer_load_dwordx4 v7, s[24:27], s3 offen  lds
    s_add_u32 m0, s51, 110592
    s_add_u32 s3, s18, 918528
    buffer_load_dwordx4 v7, s[24:27], s3 offen  lds
    s_add_u32 s3, s50, 229376
    buffer_load_dwordx4 v[176:179], v14, s[32:35], s3 offen
    s_add_u32 s3, s50, 258048
    buffer_load_dwordx4 v[180:183], v14, s[32:35], s3 offen
    v_lshlrev_b32 v2, 7, v1
    s_add_u32 s3, s68, L_lgo-L_pc0
    buffer_load_dword v10, v2, s[44:47], s3 offen
    s_waitcnt vmcnt(15)
    s_barrier
    s_add_u32 s18, s52, 1536
    s_and_b32 s18, s18, s55
    s_add_u32 s18, s18, s48
    s_add_u32 m0, s51, 0
    s_add_u32 s3, s18, 1024
    buffer_load_dwordx4 v7, s[24:27], s3 offen  lds
    s_add_u32 m0, s51, 4096
    s_add_u32 s3, s18, 132096
    buffer_load_dwordx4 v7, s[24:27], s3 offen  lds
    s_add_u32 m0, s51, 8192
    s_add_u32 s3, s18, 263168
    buffer_load_dwordx4 v7, s[24:27], s3 offen  lds
    s_add_u32 m0, s51, 12288
    s_add_u32 s3, s18, 394240
    buffer_load_dwordx4 v7, s[24:27], s3 offen  lds
    s_add_u32 m0, s51, 65536
    s_add_u32 s3, s18, 525312
    buffer_load_dwordx4 v7, s[24:27], s3 offen  lds
    s_add_u32 m0, s51, 69632
    s_add_u32 s3, s18, 656384
    buffer_load_dwordx4 v7, s[24:27], s3 offen  lds
    s_add_u32 m0, s51, 73728
    s_add_u32 s3, s18, 787456
    buffer_load_dwordx4 v7, s[24:27], s3 offen  lds
    s_add_u32 m0, s51, 77824
    s_add_u32 s3, s18, 918528
    buffer_load_dwordx4 v7, s[24:27], s3 offen  lds
    s_add_u32 s18, s52, 1536
    s_and_b32 s18, s18, s55
    s_lshl_b32 s18, s18, 7
    s_add_u32 s18, s18, s49
    s_add_u32 m0, s51, 49152
    s_add_u32 s3, s18, 131072
    buffer_load_dwordx4 v14, s[32:35], s3 offen  lds
    s_add_u32 m0, s51, 53248
    s_add_u32 s3, s18, 135168
    buffer_load_dwordx4 v14, s[32:35], s3 offen  lds
    s_add_u32 m0, s51, 57344
    s_add_u32 s3, s18, 139264
    buffer_load_dwordx4 v14, s[32:35], s3 offen  lds
    s_add_u32 m0, s51, 61440
    s_add_u32 s3, s18, 143360
    buffer_load_dwordx4 v14, s[32:35], s3 offen  lds
    s_add_u32 s18, s52, 1664
    s_and_b32 s18, s18, s55
    s_lshl_b32 s18, s18, 7
    s_add_u32 s18, s18, s49
    s_add_u32 m0, s51, 114688
    s_add_u32 s3, s18, 131072
    buffer_load_dwordx4 v14, s[32:35], s3 offen  lds
    s_add_u32 m0, s51, 118784
    s_add_u32 s3, s18, 135168
    buffer_load_dwordx4 v14, s[32:35], s3 offen  lds
    s_add_u32 m0, s51, 122880
    s_add_u32 s3, s18, 139264
    buffer_load_dwordx4 v14, s[32:35], s3 offen  lds
    s_add_u32 m0, s51, 126976
    s_add_u32 s3, s18, 143360
    buffer_load_dwordx4 v14, s[32:35], s3 offen  lds
    s_waitcnt vmcnt(19)
    s_barrier
    s_add_u32 s18, s52, 1664
    s_and_b32 s18, s18, s55
    s_add_u32 s18, s18, s48
    s_add_u32 m0, s51, 16384
    s_add_u32 s3, s18, 1024
    buffer_load_dwordx4 v7, s[24:27], s3 offen  lds
    s_add_u32 m0, s51, 20480
    s_add_u32 s3, s18, 132096
    buffer_load_dwordx4 v7, s[24:27], s3 offen  lds
    s_add_u32 m0, s51, 24576
    s_add_u32 s3, s18, 263168
    buffer_load_dwordx4 v7, s[24:27], s3 offen  lds
    s_add_u32 m0, s51, 28672
    s_add_u32 s3, s18, 394240
    buffer_load_dwordx4 v7, s[24:27], s3 offen  lds
    s_add_u32 m0, s51, 81920
    s_add_u32 s3, s18, 525312
    buffer_load_dwordx4 v7, s[24:27], s3 offen  lds
    s_add_u32 m0, s51, 86016
    s_add_u32 s3, s18, 656384
    buffer_load_dwordx4 v7, s[24:27], s3 offen  lds
    s_add_u32 m0, s51, 90112
    s_add_u32 s3, s18, 787456
    buffer_load_dwordx4 v7, s[24:27], s3 offen  lds
    s_add_u32 m0, s51, 94208
    s_add_u32 s3, s18, 918528
    buffer_load_dwordx4 v7, s[24:27], s3 offen  lds
    s_add_u32 s3, s50, 286720
    buffer_load_dwordx4 v[184:187], v14, s[32:35], s3 offen
    s_add_u32 s3, s50, 315392
    buffer_load_dwordx4 v[188:191], v14, s[32:35], s3 offen
    s_waitcnt vmcnt(14)
    s_barrier
    s_add_u32 s18, s52, 1792
    s_and_b32 s18, s18, s55
    s_add_u32 s18, s18, s48
    s_add_u32 m0, s51, 32768
    s_add_u32 s3, s18, 1024
    buffer_load_dwordx4 v7, s[24:27], s3 offen  lds
    s_add_u32 m0, s51, 36864
    s_add_u32 s3, s18, 132096
    buffer_load_dwordx4 v7, s[24:27], s3 offen  lds
    s_add_u32 m0, s51, 40960
    s_add_u32 s3, s18, 263168
    buffer_load_dwordx4 v7, s[24:27], s3 offen  lds
    s_add_u32 m0, s51, 45056
    s_add_u32 s3, s18, 394240
    buffer_load_dwordx4 v7, s[24:27], s3 offen  lds
    s_add_u32 m0, s51, 98304
    s_add_u32 s3, s18, 525312
    buffer_load_dwordx4 v7, s[24:27], s3 offen  lds
    s_add_u32 m0, s51, 102400
    s_add_u32 s3, s18, 656384
    buffer_load_dwordx4 v7, s[24:27], s3 offen  lds
    s_add_u32 m0, s51, 106496
    s_add_u32 s3, s18, 787456
    buffer_load_dwordx4 v7, s[24:27], s3 offen  lds
    s_add_u32 m0, s51, 110592
    s_add_u32 s3, s18, 918528
    buffer_load_dwordx4 v7, s[24:27], s3 offen  lds
    s_add_u32 s18, s52, 1792
    s_and_b32 s18, s18, s55
    s_lshl_b32 s18, s18, 7
    s_add_u32 s18, s18, s49
    s_add_u32 m0, s51, 131072
    s_add_u32 s3, s18, 131072
    buffer_load_dwordx4 v14, s[32:35], s3 offen  lds
    s_add_u32 m0, s51, 135168
    s_add_u32 s3, s18, 135168
    buffer_load_dwordx4 v14, s[32:35], s3 offen  lds
    s_add_u32 m0, s51, 139264
    s_add_u32 s3, s18, 139264
    buffer_load_dwordx4 v14, s[32:35], s3 offen  lds
    s_add_u32 m0, s51, 143360
    s_add_u32 s3, s18, 143360
    buffer_load_dwordx4 v14, s[32:35], s3 offen  lds
    s_add_u32 s18, s52, 1920
    s_and_b32 s18, s18, s55
    s_lshl_b32 s18, s18, 7
    s_add_u32 s18, s18, s49
    s_add_u32 m0, s51, 147456
    s_add_u32 s3, s18, 131072
    buffer_load_dwordx4 v14, s[32:35], s3 offen  lds
    s_add_u32 m0, s51, 151552
    s_add_u32 s3, s18, 135168
    buffer_load_dwordx4 v14, s[32:35], s3 offen  lds
    s_add_u32 m0, s51, 155648
    s_add_u32 s3, s18, 139264
    buffer_load_dwordx4 v14, s[32:35], s3 offen  lds
    s_add_u32 m0, s51, 159744
    s_add_u32 s3, s18, 143360
    buffer_load_dwordx4 v14, s[32:35], s3 offen  lds
    s_add_u32 s3, s50, 344064
    buffer_load_dwordx4 v[192:195], v14, s[32:35], s3 offen
    s_add_u32 s3, s50, 372736
    buffer_load_dwordx4 v[196:199], v14, s[32:35], s3 offen
    s_waitcnt vmcnt(20)
    s_barrier
    s_add_u32 s18, s52, 1920
    s_and_b32 s18, s18, s55
    s_add_u32 s18, s18, s48
    s_add_u32 m0, s51, 0
    s_add_u32 s3, s18, 1024
    buffer_load_dwordx4 v7, s[24:27], s3 offen  lds
    s_add_u32 m0, s51, 4096
    s_add_u32 s3, s18, 132096
    buffer_load_dwordx4 v7, s[24:27], s3 offen  lds
    s_add_u32 m0, s51, 8192
    s_add_u32 s3, s18, 263168
    buffer_load_dwordx4 v7, s[24:27], s3 offen  lds
    s_add_u32 m0, s51, 12288
    s_add_u32 s3, s18, 394240
    buffer_load_dwordx4 v7, s[24:27], s3 offen  lds
    s_add_u32 m0, s51, 65536
    s_add_u32 s3, s18, 525312
    buffer_load_dwordx4 v7, s[24:27], s3 offen  lds
    s_add_u32 m0, s51, 69632
    s_add_u32 s3, s18, 656384
    buffer_load_dwordx4 v7, s[24:27], s3 offen  lds
    s_add_u32 m0, s51, 73728
    s_add_u32 s3, s18, 787456
    buffer_load_dwordx4 v7, s[24:27], s3 offen  lds
    s_add_u32 m0, s51, 77824
    s_add_u32 s3, s18, 918528
    buffer_load_dwordx4 v7, s[24:27], s3 offen  lds
    s_add_u32 s3, s50, 401408
    buffer_load_dwordx4 v[200:203], v14, s[32:35], s3 offen
    s_add_u32 s3, s50, 430080
    buffer_load_dwordx4 v[204:207], v14, s[32:35], s3 offen
    s_add_u32 s3, s59, 0
    buffer_load_dwordx4 v[16:19], v14, s[32:35], s3 offen offset:0
    buffer_load_dwordx4 v[20:23], v14, s[32:35], s3 offen offset:1024
    buffer_load_dwordx4 v[24:27], v14, s[32:35], s3 offen offset:2048
    buffer_load_dwordx4 v[28:31], v14, s[32:35], s3 offen offset:3072
    s_add_u32 s3, s59, 28672
    buffer_load_dwordx4 v[32:35], v14, s[32:35], s3 offen offset:0
    buffer_load_dwordx4 v[36:39], v14, s[32:35], s3 offen offset:1024
    buffer_load_dwordx4 v[40:43], v14, s[32:35], s3 offen offset:2048
    buffer_load_dwordx4 v[44:47], v14, s[32:35], s3 offen offset:3072
    v_lshlrev_b32 v2, 7, v1
    s_add_u32 s3, s68, L_lgo-L_pc0
    buffer_load_dword v10, v2, s[44:47], s3 offen
    s_waitcnt vmcnt(25)
    s_barrier
    s_add_u32 s3, s59, 57344
    buffer_load_dwordx4 v[48:51], v14, s[32:35], s3 offen offset:0
    buffer_load_dwordx4 v[52:55], v14, s[32:35], s3 offen offset:1024
    buffer_load_dwordx4 v[56:59], v14, s[32:35], s3 offen offset:2048
    buffer_load_dwordx4 v[60:63], v14, s[32:35], s3 offen offset:3072
    s_add_u32 s3, s59, 86016
    buffer_load_dwordx4 v[64:67], v14, s[32:35], s3 offen offset:0
    buffer_load_dwordx4 v[68:71], v14, s[32:35], s3 offen offset:1024
    buffer_load_dwordx4 v[72:75], v14, s[32:35], s3 offen offset:2048
    buffer_load_dwordx4 v[76:79], v14, s[32:35], s3 offen offset:3072
    s_bfe_u32 s3, s66, 0x30002
    s_mul_i32 s3, s3, 28672
    s_add_u32 s3, s3, s59
    v_lshlrev_b32 v2, 7, v1
    s_add_u32 s3, s3, 4096
    s_mov_b64 exec, 0xffffff
    buffer_load_dword v10, v2, s[32:35], s3 offen
    s_mov_b64 exec, -1
    s_waitcnt vmcnt(18)
    ds_write_b128 v12, v[160:163] offset:16384
    ds_write_b128 v12, v[164:167] offset:16448
    ds_write_b128 v12, v[168:171] offset:24576
    ds_write_b128 v12, v[172:175] offset:24640
    ds_write_b128 v9, v[192:195] offset:16384
    ds_write_b128 v9, v[196:199] offset:16448
    ds_write_b128 v9, v[200:203] offset:24576
    ds_write_b128 v9, v[204:207] offset:24640
    s_waitcnt lgkmcnt(0)
    s_barrier
    s_add_u32 s3, s59, 114688
    buffer_load_dwordx4 v[80:83], v14, s[32:35], s3 offen offset:0
    buffer_load_dwordx4 v[84:87], v14, s[32:35], s3 offen offset:1024
    buffer_load_dwordx4 v[88:91], v14, s[32:35], s3 offen offset:2048
    buffer_load_dwordx4 v[92:95], v14, s[32:35], s3 offen offset:3072
    s_add_u32 s3, s59, 143360
    buffer_load_dwordx4 v[96:99], v14, s[32:35], s3 offen offset:0
    buffer_load_dwordx4 v[100:103], v14, s[32:35], s3 offen offset:1024
    buffer_load_dwordx4 v[104:107], v14, s[32:35], s3 offen offset:2048
    buffer_load_dwordx4 v[108:111], v14, s[32:35], s3 offen offset:3072
    ds_write_b128 v12, v[144:147] offset:32768
    ds_write_b128 v12, v[148:151] offset:32832
    ds_write_b128 v12, v[152:155] offset:40960
    ds_write_b128 v12, v[156:159] offset:41024
    ds_write_b128 v9, v[176:179] offset:32768
    ds_write_b128 v9, v[180:183] offset:32832
    ds_write_b128 v9, v[184:187] offset:40960
    ds_write_b128 v9, v[188:191] offset:41024
    s_waitcnt lgkmcnt(0)
    s_barrier
    s_add_u32 s3, s59, 172032
    buffer_load_dwordx4 v[112:115], v14, s[32:35], s3 offen offset:0
    buffer_load_dwordx4 v[116:119], v14, s[32:35], s3 offen offset:1024
    buffer_load_dwordx4 v[120:123], v14, s[32:35], s3 offen offset:2048
    buffer_load_dwordx4 v[124:127], v14, s[32:35], s3 offen offset:3072
    s_add_u32 s3, s59, 200704
    buffer_load_dwordx4 v[128:131], v14, s[32:35], s3 offen offset:0
    buffer_load_dwordx4 v[132:135], v14, s[32:35], s3 offen offset:1024
    buffer_load_dwordx4 v[136:139], v14, s[32:35], s3 offen offset:2048
    buffer_load_dwordx4 v[140:143], v14, s[32:35], s3 offen offset:3072
    s_branch L_p3l
L_spare:
    s_waitcnt vmcnt(0)
    s_barrier
    v_lshlrev_b32 v9, 7, v1
    s_and_b32 s3, s66, 1
    s_lshl2_add_u32 s3, s3, s67
    s_lshl_b32 s3, s3, 13
    s_add_u32 s3, s3, 27262976
    buffer_load_dword v8, v9, s[32:35], s3 offen
    s_add_u32 s3, s3, 65536
    buffer_load_dword v8, v9, s[32:35], s3 offen
    s_add_u32 s3, s3, 65536
    buffer_load_dword v8, v9, s[32:35], s3 offen
    s_add_u32 s3, s3, 65536
    buffer_load_dword v8, v9, s[32:35], s3 offen
    s_add_u32 s3, s3, 65536
    buffer_load_dword v8, v9, s[32:35], s3 offen
    s_add_u32 s3, s3, 65536
    buffer_load_dword v8, v9, s[32:35], s3 offen
    s_add_u32 s3, s3, 65536
    buffer_load_dword v8, v9, s[32:35], s3 offen
    s_add_u32 s3, s3, 65536
    buffer_load_dword v8, v9, s[32:35], s3 offen
    s_add_u32 s3, s3, 65536
    buffer_load_dword v8, v9, s[32:35], s3 offen
    s_add_u32 s3, s3, 65536
    buffer_load_dword v8, v9, s[32:35], s3 offen
    s_add_u32 s3, s3, 65536
    buffer_load_dword v8, v9, s[32:35], s3 offen
    s_add_u32 s3, s3, 65536
    buffer_load_dword v8, v9, s[32:35], s3 offen
    s_add_u32 s3, s3, 65536
    buffer_load_dword v8, v9, s[32:35], s3 offen
    s_add_u32 s3, s3, 65536
    buffer_load_dword v8, v9, s[32:35], s3 offen
    s_add_u32 s3, s3, 65536
    s_add_u32 s3, s59, 0
    buffer_load_dwordx4 v[16:19], v14, s[32:35], s3 offen offset:0
    buffer_load_dwordx4 v[20:23], v14, s[32:35], s3 offen offset:1024
    buffer_load_dwordx4 v[24:27], v14, s[32:35], s3 offen offset:2048
    buffer_load_dwordx4 v[28:31], v14, s[32:35], s3 offen offset:3072
    s_add_u32 s3, s59, 28672
    buffer_load_dwordx4 v[32:35], v14, s[32:35], s3 offen offset:0
    buffer_load_dwordx4 v[36:39], v14, s[32:35], s3 offen offset:1024
    buffer_load_dwordx4 v[40:43], v14, s[32:35], s3 offen offset:2048
    buffer_load_dwordx4 v[44:47], v14, s[32:35], s3 offen offset:3072
    s_add_u32 s3, s59, 57344
    buffer_load_dwordx4 v[48:51], v14, s[32:35], s3 offen offset:0
    buffer_load_dwordx4 v[52:55], v14, s[32:35], s3 offen offset:1024
    buffer_load_dwordx4 v[56:59], v14, s[32:35], s3 offen offset:2048
    buffer_load_dwordx4 v[60:63], v14, s[32:35], s3 offen offset:3072
    s_add_u32 s3, s59, 86016
    buffer_load_dwordx4 v[64:67], v14, s[32:35], s3 offen offset:0
    buffer_load_dwordx4 v[68:71], v14, s[32:35], s3 offen offset:1024
    buffer_load_dwordx4 v[72:75], v14, s[32:35], s3 offen offset:2048
    buffer_load_dwordx4 v[76:79], v14, s[32:35], s3 offen offset:3072
    s_add_u32 s3, s59, 114688
    buffer_load_dwordx4 v[80:83], v14, s[32:35], s3 offen offset:0
    buffer_load_dwordx4 v[84:87], v14, s[32:35], s3 offen offset:1024
    buffer_load_dwordx4 v[88:91], v14, s[32:35], s3 offen offset:2048
    buffer_load_dwordx4 v[92:95], v14, s[32:35], s3 offen offset:3072
    s_add_u32 s3, s59, 143360
    buffer_load_dwordx4 v[96:99], v14, s[32:35], s3 offen offset:0
    buffer_load_dwordx4 v[100:103], v14, s[32:35], s3 offen offset:1024
    buffer_load_dwordx4 v[104:107], v14, s[32:35], s3 offen offset:2048
    buffer_load_dwordx4 v[108:111], v14, s[32:35], s3 offen offset:3072
    s_add_u32 s3, s59, 172032
    buffer_load_dwordx4 v[112:115], v14, s[32:35], s3 offen offset:0
    buffer_load_dwordx4 v[116:119], v14, s[32:35], s3 offen offset:1024
    buffer_load_dwordx4 v[120:123], v14, s[32:35], s3 offen offset:2048
    buffer_load_dwordx4 v[124:127], v14, s[32:35], s3 offen offset:3072
    s_add_u32 s3, s59, 200704
    buffer_load_dwordx4 v[128:131], v14, s[32:35], s3 offen offset:0
    buffer_load_dwordx4 v[132:135], v14, s[32:35], s3 offen offset:1024
    buffer_load_dwordx4 v[136:139], v14, s[32:35], s3 offen offset:2048
    buffer_load_dwordx4 v[140:143], v14, s[32:35], s3 offen offset:3072
    s_branch L_p3l
L_comp:
    v_and_b32 v26, 15, v1
    v_lshrrev_b32 v27, 4, v1
    s_lshl_b32 s3, s60, 4
    s_add_u32 s3, s3, s61
    s_lshl_b32 s69, s3, 10
    s_add_u32 s69, s69, 28311552
    s_getreg_b32 s18, hwreg(HW_REG_XCC_ID, 0, 3)
    s_add_u32 s18, s18, 1
    s_lshl_b32 s65, s18, 8
    s_and_b32 s3, s2, 7
    s_lshl_b32 s3, s3, 5
    s_or_b32 s65, s65, s3
    s_lshr_b32 s3, s2, 3
    s_or_b32 s65, s65, s3
    v_mov_b32 v24, s18
    v_mov_b32 v136, 0
    v_mov_b32 v137, 0
    v_mov_b32 v138, 0
    v_mov_b32 v139, 0
    s_and_b32 s57, s60, 7
    s_cmp_eq_u32 s19, 3
    s_cbranch_scc1 L_j3
    s_lshl1_add_u32 s48, s2, s19
    s_and_b32 s3, s2, 127
    s_cmp_eq_u32 s19, 2
    s_cselect_b32 s48, s3, s48
    s_lshl_b32 s48, s48, 12
    s_waitcnt lgkmcnt(0)
    s_bitcmp1_b32 s2, 7
    s_cselect_b64 s[16:17], s[10:11], s[8:9]
    s_cmp_eq_u32 s19, 2
    s_cselect_b64 s[16:17], s[16:17], s[4:5]
    s_mov_b32 s24, s16
    s_and_b32 s25, s17, 0xffff
    s_mov_b32 s26, 2097152
    s_mov_b32 s27, 0x00020000
    s_cmp_eq_u32 s19, 2
    s_cselect_b32 s26, 524288, s26
    buffer_load_dwordx4 v[32:35], v14, s[24:27], s48 offen offset:0
    buffer_load_dwordx4 v[36:39], v14, s[24:27], s48 offen offset:1024
    buffer_load_dwordx4 v[40:43], v14, s[24:27], s48 offen offset:2048
    buffer_load_dwordx4 v[44:47], v14, s[24:27], s48 offen offset:3072
    s_branch L_tx
L_j3:
    s_load_dwordx2 s[16:17], s[0:1], 72
    s_lshl_b32 s49, s2, 8
    s_add_u32 s49, s49, 28573696
    v_lshrrev_b32 v20, 3, v1
    v_and_b32 v21, 7, v1
    v_lshrrev_b32 v22, 5, v1
    v_lshlrev_b32 v22, 1, v22
    v_xor_b32 v21, v21, v22
    v_xor_b32 v22, 4, v21
    v_lshlrev_b32 v21, 4, v21
    v_lshlrev_b32 v22, 4, v22
    v_lshl_add_u32 v21, v20, 10, v21
    v_lshl_add_u32 v22, v20, 10, v22
    s_lshr_b32 s50, s2, 3
    s_and_b32 s51, s2, 7
    s_lshl_b32 s48, s50, 15
    s_lshl_b32 s3, s51, 7
    s_add_u32 s48, s48, s3
    s_waitcnt lgkmcnt(0)
    s_mov_b32 s28, s16
    s_and_b32 s29, s17, 0xffff
    s_mov_b32 s30, 917504
    s_mov_b32 s31, 0x00020000
    s_mov_b32 s32, s14
    s_and_b32 s33, s15, 0xffff
    s_mov_b32 s34, 58720256
    s_mov_b32 s35, 0x00020000
    s_cmp_eq_u32 s2, 0
    s_cbranch_scc0 L_nan
    s_mov_b32 s3, 29097984
    buffer_store_dwordx4 v[136:139], v14, s[32:35], s3 offen sc1
    s_mov_b32 s36, s12
    s_and_b32 s37, s13, 0xffff
    s_mov_b32 s38, 256
    s_mov_b32 s39, 0x00020000
    s_mov_b64 exec, 1
    s_waitcnt vmcnt(0)
    buffer_store_dword v24, v14, s[36:39], 0 offen sc1
    s_mov_b64 exec, -1
L_nan:
    s_mov_b32 m0, 159744
    s_add_u32 s3, s48, 0
    buffer_load_dwordx4 v21, s[28:31], s3 offen  lds
    s_mov_b32 m0, 160768
    s_add_u32 s3, s48, 8192
    buffer_load_dwordx4 v22, s[28:31], s3 offen  lds
    s_mov_b32 m0, 161792
    s_add_u32 s3, s48, 16384
    buffer_load_dwordx4 v21, s[28:31], s3 offen  lds
    s_mov_b32 m0, 162816
    s_add_u32 s3, s48, 24576
    buffer_load_dwordx4 v22, s[28:31], s3 offen  lds
    buffer_store_dwordx4 v[136:139], v14, s[32:35], s69 offen sc1
    s_mov_b64 exec, 0xffff
    buffer_store_dwordx4 v[136:139], v14, s[32:35], s49 offen sc1
    s_lshl_b32 s49, s2, 9
    s_add_u32 s49, s49, 29130752
    s_mov_b32 exec_lo, -1
    buffer_store_dwordx4 v[136:139], v14, s[32:35], s49 offen sc1
    s_mov_b64 exec, -1
    s_mul_i32 s51, s51, 112
    s_add_u32 s51, s51, s50
    s_lshl_b32 s51, s51, 10
    s_add_u32 s51, s51, 27262976
    s_cmp_ge_u32 s2, 224
    s_cselect_b32 s51, 58720256, s51
L_tx:
    s_mov_b32 s20, s4
    s_and_b32 s21, s5, 0xffff
    s_mov_b32 s22, 2097152
    s_mov_b32 s23, 0x00020000
    s_mov_b32 s32, s14
    s_and_b32 s33, s15, 0xffff
    s_mov_b32 s34, 58720256
    s_mov_b32 s35, 0x00020000
    s_mov_b32 s36, s12
    s_and_b32 s37, s13, 0xffff
    s_mov_b32 s38, 256
    s_mov_b32 s39, 0x00020000
    v_lshrrev_b32 v28, 2, v26
    v_and_b32 v29, 3, v26
    v_lshl_add_u32 v28, v28, 3, v29
    s_lshl_b32 s3, s19, 5
    v_add_u32 v28, s3, v28
    v_lshlrev_b32 v28, 7, v28
    v_bfe_u32 v29, v26, 1, 1
    v_bfe_u32 v25, v26, 3, 1
    v_lshl_or_b32 v29, v25, 1, v29
    v_bfe_u32 v25, v26, 2, 1
    v_lshl_or_b32 v29, v25, 2, v29
    v_xor_b32 v29, v29, v27
    v_lshl_add_u32 v2, v29, 4, v28
    v_xor_b32 v3, 32, v2
    v_add_u32 v3, 512, v3
    v_xor_b32 v4, 64, v2
    v_xor_b32 v5, 64, v3
    v_bfe_u32 v29, v26, 1, 3
    v_xor_b32 v29, v29, v27
    v_lshlrev_b32 v28, 7, v26
    v_lshl_add_u32 v6, v29, 4, v28
    v_add_u32 v10, 65536, v6
    v_add_u32 v6, 131072, v6
    v_xor_b32 v7, 32, v6
    v_xor_b32 v8, 64, v6
    v_xor_b32 v9, 64, v7
    v_xor_b32 v11, 32, v10
    v_xor_b32 v12, 64, v10
    v_xor_b32 v13, 64, v11
    s_cmp_eq_u32 s64, 1
    s_cbranch_scc1 L_natr
    v_lshrrev_b32 v28, 2, v26
    v_lshl_add_u32 v28, v27, 3, v28
    v_lshlrev_b32 v28, 7, v28
    v_and_b32 v29, 3, v26
    v_lshl_add_u32 v28, v29, 3, v28
    v_bfe_u32 v29, v26, 3, 1
    v_and_b32 v25, 1, v27
    v_lshl_or_b32 v29, v25, 1, v29
    v_xor_b32 v29, s19, v29
    v_lshl_add_u32 v10, v29, 5, v28
    v_add_u32 v10, 65536, v10
    v_xor_b32 v11, 32, v10
    v_xor_b32 v12, 64, v10
    v_xor_b32 v13, 96, v10
L_natr:
    v_mov_b32 v140, 0
    v_mov_b32 v141, 0
    v_mov_b32 v142, 0
    v_mov_b32 v143, 0
    v_mov_b32 v144, 0
    v_mov_b32 v145, 0
    v_mov_b32 v146, 0
    v_mov_b32 v147, 0
    v_mov_b32 v148, 0
    v_mov_b32 v149, 0
    v_mov_b32 v150, 0
    v_mov_b32 v151, 0
    v_mov_b32 v152, 0
    v_mov_b32 v153, 0
    v_mov_b32 v154, 0
    v_mov_b32 v155, 0
    v_mov_b32 v156, 0
    v_mov_b32 v157, 0
    v_mov_b32 v158, 0
    v_mov_b32 v159, 0
    v_mov_b32 v160, 0
    v_mov_b32 v161, 0
    v_mov_b32 v162, 0
    v_mov_b32 v163, 0
    v_mov_b32 v164, 0
    v_mov_b32 v165, 0
    v_mov_b32 v166, 0
    v_mov_b32 v167, 0
    v_mov_b32 v168, 0
    v_mov_b32 v169, 0
    v_mov_b32 v170, 0
    v_mov_b32 v171, 0
    v_mov_b32 v172, 0
    v_mov_b32 v173, 0
    v_mov_b32 v174, 0
    v_mov_b32 v175, 0
    v_mov_b32 v176, 0
    v_mov_b32 v177, 0
    v_mov_b32 v178, 0
    v_mov_b32 v179, 0
    v_mov_b32 v180, 0
    v_mov_b32 v181, 0
    v_mov_b32 v182, 0
    v_mov_b32 v183, 0
    v_mov_b32 v184, 0
    v_mov_b32 v185, 0
    v_mov_b32 v186, 0
    v_mov_b32 v187, 0
    v_mov_b32 v188, 0
    v_mov_b32 v189, 0
    v_mov_b32 v190, 0
    v_mov_b32 v191, 0
    v_mov_b32 v192, 0
    v_mov_b32 v193, 0
    v_mov_b32 v194, 0
    v_mov_b32 v195, 0
    v_mov_b32 v196, 0
    v_mov_b32 v197, 0
    v_mov_b32 v198, 0
    v_mov_b32 v199, 0
    v_mov_b32 v200, 0
    v_mov_b32 v201, 0
    v_mov_b32 v202, 0
    v_mov_b32 v203, 0
    v_mov_b32 v204, 0
    v_mov_b32 v205, 0
    v_mov_b32 v206, 0
    v_mov_b32 v207, 0
    v_mov_b32 v208, 0
    v_mov_b32 v209, 0
    v_mov_b32 v210, 0
    v_mov_b32 v211, 0
    v_mov_b32 v212, 0
    v_mov_b32 v213, 0
    v_mov_b32 v214, 0
    v_mov_b32 v215, 0
    v_mov_b32 v216, 0
    v_mov_b32 v217, 0
    v_mov_b32 v218, 0
    v_mov_b32 v219, 0
    v_mov_b32 v220, 0
    v_mov_b32 v221, 0
    v_mov_b32 v222, 0
    v_mov_b32 v223, 0
    v_mov_b32 v224, 0
    v_mov_b32 v225, 0
    v_mov_b32 v226, 0
    v_mov_b32 v227, 0
    v_mov_b32 v228, 0
    v_mov_b32 v229, 0
    v_mov_b32 v230, 0
    v_mov_b32 v231, 0
    v_mov_b32 v16, 0x3f803f80
    v_mov_b32 v17, 0x3f803f80
    v_mov_b32 v18, 0x3f803f80
    v_mov_b32 v19, 0x3f803f80
    v_lshlrev_b32 v28, 2, v1
    s_lshl4_add_u32 s3, s60, s61
    s_lshl_b32 s3, s3, 8
    s_add_u32 s3, s3, 28573696
    v_mov_b32 v252, s3
    s_lshl2_add_u32 s3, s19, s3
    v_mov_b32 v253, s3
    s_cmp_eq_u32 s19, 3
    s_cbranch_scc1 L_k3
    v_mov_b32 v48, 0
    v_mov_b32 v49, 0
    v_mov_b32 v50, 0
    v_mov_b32 v51, 0
    v_mov_b32 v52, 0
    v_mov_b32 v53, 0
    v_mov_b32 v54, 0
    v_mov_b32 v55, 0
    s_lshl1_add_u32 s48, s2, s19
    s_lshl_b32 s48, s48, 4
    s_add_u32 s48, s48, 28835840
    s_lshl_b32 s49, s2, 4
    s_add_u32 s49, s49, 28852224
    v_mov_b32 v20, 0
    s_waitcnt vmcnt(3)
    v_dot2c_f32_bf16 v48, v32, v16
    v_dot2c_f32_bf16 v52, v32, v32
    v_dot2c_f32_bf16 v48, v33, v16
    v_dot2c_f32_bf16 v52, v33, v33
    v_dot2c_f32_bf16 v48, v34, v16
    v_dot2c_f32_bf16 v52, v34, v34
    v_dot2c_f32_bf16 v48, v35, v16
    v_dot2c_f32_bf16 v52, v35, v35
    s_waitcnt vmcnt(2)
    v_dot2c_f32_bf16 v49, v36, v16
    v_dot2c_f32_bf16 v53, v36, v36
    v_dot2c_f32_bf16 v49, v37, v16
    v_dot2c_f32_bf16 v53, v37, v37
    v_dot2c_f32_bf16 v49, v38, v16
    v_dot2c_f32_bf16 v53, v38, v38
    v_dot2c_f32_bf16 v49, v39, v16
    v_dot2c_f32_bf16 v53, v39, v39
    s_waitcnt vmcnt(1)
    v_dot2c_f32_bf16 v50, v40, v16
    v_dot2c_f32_bf16 v54, v40, v40
    v_dot2c_f32_bf16 v50, v41, v16
    v_dot2c_f32_bf16 v54, v41, v41
    v_dot2c_f32_bf16 v50, v42, v16
    v_dot2c_f32_bf16 v54, v42, v42
    v_dot2c_f32_bf16 v50, v43, v16
    v_dot2c_f32_bf16 v54, v43, v43
    s_waitcnt vmcnt(0)
    v_dot2c_f32_bf16 v51, v44, v16
    v_dot2c_f32_bf16 v55, v44, v44
    v_dot2c_f32_bf16 v51, v45, v16
    v_dot2c_f32_bf16 v55, v45, v45
    v_dot2c_f32_bf16 v51, v46, v16
    v_dot2c_f32_bf16 v55, v46, v46
    v_dot2c_f32_bf16 v51, v47, v16
    v_dot2c_f32_bf16 v55, v47, v47
    s_nop 2
    v_add_f32_dpp v48, v48, v48 quad_perm:[1,0,3,2] row_mask:0xf bank_mask:0xf
    v_add_f32_dpp v49, v49, v49 quad_perm:[1,0,3,2] row_mask:0xf bank_mask:0xf
    v_add_f32_dpp v50, v50, v50 quad_perm:[1,0,3,2] row_mask:0xf bank_mask:0xf
    v_add_f32_dpp v51, v51, v51 quad_perm:[1,0,3,2] row_mask:0xf bank_mask:0xf
    v_add_f32_dpp v52, v52, v52 quad_perm:[1,0,3,2] row_mask:0xf bank_mask:0xf
    v_add_f32_dpp v53, v53, v53 quad_perm:[1,0,3,2] row_mask:0xf bank_mask:0xf
    v_add_f32_dpp v54, v54, v54 quad_perm:[1,0,3,2] row_mask:0xf bank_mask:0xf
    v_add_f32_dpp v55, v55, v55 quad_perm:[1,0,3,2] row_mask:0xf bank_mask:0xf
    v_add_f32_dpp v48, v48, v48 quad_perm:[2,3,0,1] row_mask:0xf bank_mask:0xf
    v_add_f32_dpp v49, v49, v49 quad_perm:[2,3,0,1] row_mask:0xf bank_mask:0xf
    v_add_f32_dpp v50, v50, v50 quad_perm:[2,3,0,1] row_mask:0xf bank_mask:0xf
    v_add_f32_dpp v51, v51, v51 quad_perm:[2,3,0,1] row_mask:0xf bank_mask:0xf
    v_add_f32_dpp v52, v52, v52 quad_perm:[2,3,0,1] row_mask:0xf bank_mask:0xf
    v_add_f32_dpp v53, v53, v53 quad_perm:[2,3,0,1] row_mask:0xf bank_mask:0xf
    v_add_f32_dpp v54, v54, v54 quad_perm:[2,3,0,1] row_mask:0xf bank_mask:0xf
    v_add_f32_dpp v55, v55, v55 quad_perm:[2,3,0,1] row_mask:0xf bank_mask:0xf
    v_add_f32_dpp v48, v48, v48 row_half_mirror row_mask:0xf bank_mask:0xf
    v_add_f32_dpp v49, v49, v49 row_half_mirror row_mask:0xf bank_mask:0xf
    v_add_f32_dpp v50, v50, v50 row_half_mirror row_mask:0xf bank_mask:0xf
    v_add_f32_dpp v51, v51, v51 row_half_mirror row_mask:0xf bank_mask:0xf
    v_add_f32_dpp v52, v52, v52 row_half_mirror row_mask:0xf bank_mask:0xf
    v_add_f32_dpp v53, v53, v53 row_half_mirror row_mask:0xf bank_mask:0xf
    v_add_f32_dpp v54, v54, v54 row_half_mirror row_mask:0xf bank_mask:0xf
    v_add_f32_dpp v55, v55, v55 row_half_mirror row_mask:0xf bank_mask:0xf
    v_add_f32_dpp v48, v48, v48 row_mirror row_mask:0xf bank_mask:0xf
    v_add_f32_dpp v49, v49, v49 row_mirror row_mask:0xf bank_mask:0xf
    v_add_f32_dpp v50, v50, v50 row_mirror row_mask:0xf bank_mask:0xf
    v_add_f32_dpp v51, v51, v51 row_mirror row_mask:0xf bank_mask:0xf
    v_add_f32_dpp v52, v52, v52 row_mirror row_mask:0xf bank_mask:0xf
    v_add_f32_dpp v53, v53, v53 row_mirror row_mask:0xf bank_mask:0xf
    v_add_f32_dpp v54, v54, v54 row_mirror row_mask:0xf bank_mask:0xf
    v_add_f32_dpp v55, v55, v55 row_mirror row_mask:0xf bank_mask:0xf
    v_add_f32_dpp v48, v48, v48 row_bcast:15 row_mask:0xa bank_mask:0xf
    v_add_f32_dpp v49, v49, v49 row_bcast:15 row_mask:0xa bank_mask:0xf
    v_add_f32_dpp v50, v50, v50 row_bcast:15 row_mask:0xa bank_mask:0xf
    v_add_f32_dpp v51, v51, v51 row_bcast:15 row_mask:0xa bank_mask:0xf
    v_add_f32_dpp v52, v52, v52 row_bcast:15 row_mask:0xa bank_mask:0xf
    v_add_f32_dpp v53, v53, v53 row_bcast:15 row_mask:0xa bank_mask:0xf
    v_add_f32_dpp v54, v54, v54 row_bcast:15 row_mask:0xa bank_mask:0xf
    v_add_f32_dpp v55, v55, v55 row_bcast:15 row_mask:0xa bank_mask:0xf
    v_add_f32_dpp v48, v48, v48 row_bcast:31 row_mask:0xc bank_mask:0xf
    v_add_f32_dpp v49, v49, v49 row_bcast:31 row_mask:0xc bank_mask:0xf
    v_add_f32_dpp v50, v50, v50 row_bcast:31 row_mask:0xc bank_mask:0xf
    v_add_f32_dpp v51, v51, v51 row_bcast:31 row_mask:0xc bank_mask:0xf
    v_add_f32_dpp v52, v52, v52 row_bcast:31 row_mask:0xc bank_mask:0xf
    v_add_f32_dpp v53, v53, v53 row_bcast:31 row_mask:0xc bank_mask:0xf
    v_add_f32_dpp v54, v54, v54 row_bcast:31 row_mask:0xc bank_mask:0xf
    v_add_f32_dpp v55, v55, v55 row_bcast:31 row_mask:0xc bank_mask:0xf
    s_mov_b32 exec_lo, 0
    s_mov_b32 exec_hi, 0x80000000
    s_cmp_eq_u32 s19, 2
    s_cbranch_scc0 L_k0
    buffer_store_dwordx4 v[48:51], v20, s[32:35], s49 offen sc1
    s_branch L_kx
L_k0:
    v_mul_f32 v48, 0x3b000000, v48
    v_mul_f32 v49, 0x3b000000, v49
    v_mul_f32 v50, 0x3b000000, v50
    v_mul_f32 v51, 0x3b000000, v51
    v_mul_f32 v52, 0x3b000000, v52
    v_mul_f32 v53, 0x3b000000, v53
    v_mul_f32 v54, 0x3b000000, v54
    v_mul_f32 v55, 0x3b000000, v55
    v_fma_f32 v52, -v48, v48, v52
    v_fma_f32 v53, -v49, v49, v53
    v_fma_f32 v54, -v50, v50, v54
    v_fma_f32 v55, -v51, v51, v55
    v_add_f32 v52, 0x3727c5ac, v52
    v_add_f32 v53, 0x3727c5ac, v53
    v_add_f32 v54, 0x3727c5ac, v54
    v_add_f32 v55, 0x3727c5ac, v55
    v_rsq_f32 v52, v52
    v_rsq_f32 v53, v53
    v_rsq_f32 v54, v54
    v_rsq_f32 v55, v55
    s_add_u32 s49, s48, 8192
    buffer_store_dwordx4 v[48:51], v20, s[32:35], s49 offen sc1
    buffer_store_dwordx4 v[52:55], v20, s[32:35], s48 offen sc1
    s_branch L_kx
L_k3:
    v_bfe_u32 v20, v1, 2, 2
    v_lshl_add_u32 v20, v27, 2, v20
    v_lshlrev_b32 v20, 7, v20
    v_add_u32 v20, 159744, v20
    v_and_b32 v21, 1, v1
    v_lshl_add_u32 v20, v21, 3, v20
    v_bfe_u32 v21, v1, 1, 1
    v_lshlrev_b32 v22, 1, v27
    v_xor_b32 v23, 0, v22
    v_or_b32 v23, v23, v21
    v_lshl_add_u32 v48, v23, 4, v20
    v_xor_b32 v23, 2, v22
    v_or_b32 v23, v23, v21
    v_lshl_add_u32 v49, v23, 4, v20
    v_xor_b32 v23, 4, v22
    v_or_b32 v23, v23, v21
    v_lshl_add_u32 v50, v23, 4, v20
    v_xor_b32 v23, 6, v22
    v_or_b32 v23, v23, v21
    v_lshl_add_u32 v51, v23, 4, v20
    s_waitcnt vmcnt(3)
    ds_read_b64_tr_b16 v[32:33], v48
    ds_read_b64_tr_b16 v[34:35], v48 offset:2048
    ds_read_b64_tr_b16 v[36:37], v49
    ds_read_b64_tr_b16 v[38:39], v49 offset:2048
    ds_read_b64_tr_b16 v[40:41], v50
    ds_read_b64_tr_b16 v[42:43], v50 offset:2048
    ds_read_b64_tr_b16 v[44:45], v51
    ds_read_b64_tr_b16 v[46:47], v51 offset:2048
    s_waitcnt lgkmcnt(0)
    v_lshlrev_b32 v20, 16, v32
    v_and_b32 v21, 0xffff0000, v32
    v_cvt_pk_f16_f32 v32, v20, v21
    v_lshlrev_b32 v22, 16, v33
    v_and_b32 v23, 0xffff0000, v33
    v_cvt_pk_f16_f32 v33, v22, v23
    v_lshlrev_b32 v20, 16, v34
    v_and_b32 v21, 0xffff0000, v34
    v_cvt_pk_f16_f32 v34, v20, v21
    v_lshlrev_b32 v22, 16, v35
    v_and_b32 v23, 0xffff0000, v35
    v_cvt_pk_f16_f32 v35, v22, v23
    s_add_u32 s3, s51, 0
    buffer_store_dwordx4 v[32:35], v14, s[32:35], s3 offen sc1
    v_lshlrev_b32 v20, 16, v36
    v_and_b32 v21, 0xffff0000, v36
    v_cvt_pk_f16_f32 v36, v20, v21
    v_lshlrev_b32 v22, 16, v37
    v_and_b32 v23, 0xffff0000, v37
    v_cvt_pk_f16_f32 v37, v22, v23
    v_lshlrev_b32 v20, 16, v38
    v_and_b32 v21, 0xffff0000, v38
    v_cvt_pk_f16_f32 v38, v20, v21
    v_lshlrev_b32 v22, 16, v39
    v_and_b32 v23, 0xffff0000, v39
    v_cvt_pk_f16_f32 v39, v22, v23
    s_add_u32 s3, s51, 28672
    buffer_store_dwordx4 v[36:39], v14, s[32:35], s3 offen sc1
    v_lshlrev_b32 v20, 16, v40
    v_and_b32 v21, 0xffff0000, v40
    v_cvt_pk_f16_f32 v40, v20, v21
    v_lshlrev_b32 v22, 16, v41
    v_and_b32 v23, 0xffff0000, v41
    v_cvt_pk_f16_f32 v41, v22, v23
    v_lshlrev_b32 v20, 16, v42
    v_and_b32 v21, 0xffff0000, v42
    v_cvt_pk_f16_f32 v42, v20, v21
    v_lshlrev_b32 v22, 16, v43
    v_and_b32 v23, 0xffff0000, v43
    v_cvt_pk_f16_f32 v43, v22, v23
    s_add_u32 s3, s51, 57344
    buffer_store_dwordx4 v[40:43], v14, s[32:35], s3 offen sc1
    v_lshlrev_b32 v20, 16, v44
    v_and_b32 v21, 0xffff0000, v44
    v_cvt_pk_f16_f32 v44, v20, v21
    v_lshlrev_b32 v22, 16, v45
    v_and_b32 v23, 0xffff0000, v45
    v_cvt_pk_f16_f32 v45, v22, v23
    v_lshlrev_b32 v20, 16, v46
    v_and_b32 v21, 0xffff0000, v46
    v_cvt_pk_f16_f32 v46, v20, v21
    v_lshlrev_b32 v22, 16, v47
    v_and_b32 v23, 0xffff0000, v47
    v_cvt_pk_f16_f32 v47, v22, v23
    s_add_u32 s3, s51, 86016
    buffer_store_dwordx4 v[44:47], v14, s[32:35], s3 offen sc1
L_kx:
    s_mov_b64 exec, -1
    s_cmp_eq_u32 s64, 1
    s_cbranch_scc1 L_cab
L_cz:
    s_barrier
    ds_read_b128 v[32:35], v2 offset:0
    ds_read_b64_tr_b16 v[40:41], v10 offset:0
    ds_read_b64_tr_b16 v[42:43], v10 offset:512
    ds_read_b128 v[36:39], v3 offset:0
    ds_read_b64_tr_b16 v[44:45], v11 offset:0
    ds_read_b64_tr_b16 v[46:47], v11 offset:512
    ds_read_b64_tr_b16 v[48:49], v12 offset:0
    ds_read_b64_tr_b16 v[50:51], v12 offset:512
    ds_read_b64_tr_b16 v[52:53], v13 offset:0
    ds_read_b64_tr_b16 v[54:55], v13 offset:512
    ds_read_b64_tr_b16 v[56:57], v10 offset:8192
    ds_read_b64_tr_b16 v[58:59], v10 offset:8704
    ds_read_b64_tr_b16 v[60:61], v11 offset:8192
    ds_read_b64_tr_b16 v[62:63], v11 offset:8704
    ds_read_b64_tr_b16 v[64:65], v12 offset:8192
    ds_read_b64_tr_b16 v[66:67], v12 offset:8704
    ds_read_b64_tr_b16 v[68:69], v13 offset:8192
    ds_read_b64_tr_b16 v[70:71], v13 offset:8704
    ds_read_b128 v[72:75], v6 offset:0
    ds_read_b128 v[76:79], v7 offset:2048
    ds_read_b128 v[80:83], v6 offset:4096
    s_waitcnt lgkmcnt(15)
    v_mfma_f32_16x16x32_bf16 v[136:139], v[32:35], v[40:43], v[136:139]
    ds_read_b128 v[84:87], v4 offset:0
    v_mfma_f32_16x16x32_bf16 v[140:143], v[36:39], v[40:43], v[140:143]
    ds_read_b64_tr_b16 v[92:93], v10 offset:4096
    v_mfma_f32_16x16x32_bf16 v[224:227], v[16:19], v[40:43], v[224:227]
    ds_read_b64_tr_b16 v[94:95], v10 offset:4608
    v_mfma_f32_16x16x32_bf16 v[144:147], v[32:35], v[44:47], v[144:147]
    ds_read_b128 v[88:91], v5 offset:0
    v_mfma_f32_16x16x32_bf16 v[148:151], v[36:39], v[44:47], v[148:151]
    ds_read_b64_tr_b16 v[96:97], v11 offset:4096
    s_waitcnt lgkmcnt(15)
    v_mfma_f32_16x16x32_bf16 v[152:155], v[32:35], v[48:51], v[152:155]
    ds_read_b64_tr_b16 v[98:99], v11 offset:4608
    v_mfma_f32_16x16x32_bf16 v[156:159], v[36:39], v[48:51], v[156:159]
    ds_read_b64_tr_b16 v[100:101], v12 offset:4096
    v_mfma_f32_16x16x32_bf16 v[160:163], v[32:35], v[52:55], v[160:163]
    ds_read_b64_tr_b16 v[102:103], v12 offset:4608
    v_mfma_f32_16x16x32_bf16 v[164:167], v[36:39], v[52:55], v[164:167]
    ds_read_b64_tr_b16 v[104:105], v13 offset:4096
    s_waitcnt lgkmcnt(15)
    v_mfma_f32_16x16x32_bf16 v[168:171], v[56:59], v[32:35], v[168:171]
    ds_read_b64_tr_b16 v[106:107], v13 offset:4608
    v_mfma_f32_16x16x32_bf16 v[184:187], v[56:59], v[36:39], v[184:187]
    ds_read_b64_tr_b16 v[108:109], v10 offset:12288
    v_mfma_f32_16x16x32_bf16 v[228:231], v[16:19], v[56:59], v[228:231]
    ds_read_b64_tr_b16 v[110:111], v10 offset:12800
    v_mfma_f32_16x16x32_bf16 v[172:175], v[60:63], v[32:35], v[172:175]
    ds_read_b64_tr_b16 v[112:113], v11 offset:12288
    v_mfma_f32_16x16x32_bf16 v[188:191], v[60:63], v[36:39], v[188:191]
    ds_read_b64_tr_b16 v[114:115], v11 offset:12800
    s_waitcnt lgkmcnt(15)
    v_mfma_f32_16x16x32_bf16 v[176:179], v[64:67], v[32:35], v[176:179]
    ds_read_b64_tr_b16 v[116:117], v12 offset:12288
    v_mfma_f32_16x16x32_bf16 v[192:195], v[64:67], v[36:39], v[192:195]
    ds_read_b64_tr_b16 v[118:119], v12 offset:12800
    v_mfma_f32_16x16x32_bf16 v[180:183], v[68:71], v[32:35], v[180:183]
    ds_read_b64_tr_b16 v[120:121], v13 offset:12288
    v_mfma_f32_16x16x32_bf16 v[196:199], v[68:71], v[36:39], v[196:199]
    ds_read_b64_tr_b16 v[122:123], v13 offset:12800
    v_mfma_f32_16x16x32_bf16 v[200:203], v[32:35], v[72:75], v[200:203]
    ds_read_b128 v[124:127], v8 offset:0
    v_mfma_f32_16x16x32_bf16 v[204:207], v[36:39], v[72:75], v[204:207]
    ds_read_b128 v[128:131], v9 offset:2048
    v_mfma_f32_16x16x32_bf16 v[208:211], v[32:35], v[76:79], v[208:211]
    ds_read_b128 v[132:135], v8 offset:4096
    v_mfma_f32_16x16x32_bf16 v[212:215], v[36:39], v[76:79], v[212:215]
    s_waitcnt lgkmcnt(15)
    v_mfma_f32_16x16x32_bf16 v[216:219], v[32:35], v[80:83], v[216:219]
    v_mfma_f32_16x16x32_bf16 v[220:223], v[36:39], v[80:83], v[220:223]
    v_mfma_f32_16x16x32_bf16 v[136:139], v[84:87], v[92:95], v[136:139]
    v_mfma_f32_16x16x32_bf16 v[140:143], v[88:91], v[92:95], v[140:143]
    v_mfma_f32_16x16x32_bf16 v[224:227], v[16:19], v[92:95], v[224:227]
    v_mfma_f32_16x16x32_bf16 v[144:147], v[84:87], v[96:99], v[144:147]
    s_waitcnt lgkmcnt(0)
    s_barrier
    s_cmp_eq_u32 s19, 3
    s_cbranch_scc0 L_cz_nal
    buffer_load_dword v20, off, s[36:39], 0 sc1
L_cz_nal:
    ds_read_b128 v[32:35], v2 offset:16384
    v_mfma_f32_16x16x32_bf16 v[148:151], v[88:91], v[96:99], v[148:151]
    ds_read_b64_tr_b16 v[40:41], v10 offset:16384
    v_mfma_f32_16x16x32_bf16 v[152:155], v[84:87], v[100:103], v[152:155]
    ds_read_b64_tr_b16 v[42:43], v10 offset:16896
    v_mfma_f32_16x16x32_bf16 v[156:159], v[88:91], v[100:103], v[156:159]
    ds_read_b128 v[36:39], v3 offset:16384
    v_mfma_f32_16x16x32_bf16 v[160:163], v[84:87], v[104:107], v[160:163]
    ds_read_b64_tr_b16 v[44:45], v11 offset:16384
    v_mfma_f32_16x16x32_bf16 v[164:167], v[88:91], v[104:107], v[164:167]
    ds_read_b64_tr_b16 v[46:47], v11 offset:16896
    v_mfma_f32_16x16x32_bf16 v[168:171], v[108:111], v[84:87], v[168:171]
    ds_read_b64_tr_b16 v[48:49], v12 offset:16384
    v_mfma_f32_16x16x32_bf16 v[184:187], v[108:111], v[88:91], v[184:187]
    ds_read_b64_tr_b16 v[50:51], v12 offset:16896
    v_mfma_f32_16x16x32_bf16 v[228:231], v[16:19], v[108:111], v[228:231]
    ds_read_b64_tr_b16 v[52:53], v13 offset:16384
    v_mfma_f32_16x16x32_bf16 v[172:175], v[112:115], v[84:87], v[172:175]
    ds_read_b64_tr_b16 v[54:55], v13 offset:16896
    v_mfma_f32_16x16x32_bf16 v[188:191], v[112:115], v[88:91], v[188:191]
    ds_read_b64_tr_b16 v[56:57], v10 offset:24576
    v_mfma_f32_16x16x32_bf16 v[176:179], v[116:119], v[84:87], v[176:179]
    ds_read_b64_tr_b16 v[58:59], v10 offset:25088
    v_mfma_f32_16x16x32_bf16 v[192:195], v[116:119], v[88:91], v[192:195]
    ds_read_b64_tr_b16 v[60:61], v11 offset:24576
    v_mfma_f32_16x16x32_bf16 v[180:183], v[120:123], v[84:87], v[180:183]
    ds_read_b64_tr_b16 v[62:63], v11 offset:25088
    v_mfma_f32_16x16x32_bf16 v[196:199], v[120:123], v[88:91], v[196:199]
    ds_read_b64_tr_b16 v[64:65], v12 offset:24576
    v_mfma_f32_16x16x32_bf16 v[200:203], v[84:87], v[124:127], v[200:203]
    ds_read_b64_tr_b16 v[66:67], v12 offset:25088
    v_mfma_f32_16x16x32_bf16 v[204:207], v[88:91], v[124:127], v[204:207]
    ds_read_b64_tr_b16 v[68:69], v13 offset:24576
    v_mfma_f32_16x16x32_bf16 v[208:211], v[84:87], v[128:131], v[208:211]
    ds_read_b64_tr_b16 v[70:71], v13 offset:25088
    v_mfma_f32_16x16x32_bf16 v[212:215], v[88:91], v[128:131], v[212:215]
    ds_read_b128 v[72:75], v6 offset:6144
    v_mfma_f32_16x16x32_bf16 v[216:219], v[84:87], v[132:135], v[216:219]
    ds_read_b128 v[76:79], v7 offset:8192
    v_mfma_f32_16x16x32_bf16 v[220:223], v[88:91], v[132:135], v[220:223]
    ds_read_b128 v[80:83], v6 offset:10240
    s_waitcnt lgkmcnt(15)
    v_mfma_f32_16x16x32_bf16 v[136:139], v[32:35], v[40:43], v[136:139]
    ds_read_b128 v[84:87], v4 offset:16384
    v_mfma_f32_16x16x32_bf16 v[140:143], v[36:39], v[40:43], v[140:143]
    ds_read_b64_tr_b16 v[92:93], v10 offset:20480
    v_mfma_f32_16x16x32_bf16 v[224:227], v[16:19], v[40:43], v[224:227]
    ds_read_b64_tr_b16 v[94:95], v10 offset:20992
    v_mfma_f32_16x16x32_bf16 v[144:147], v[32:35], v[44:47], v[144:147]
    ds_read_b128 v[88:91], v5 offset:16384
    v_mfma_f32_16x16x32_bf16 v[148:151], v[36:39], v[44:47], v[148:151]
    ds_read_b64_tr_b16 v[96:97], v11 offset:20480
    s_waitcnt lgkmcnt(15)
    v_mfma_f32_16x16x32_bf16 v[152:155], v[32:35], v[48:51], v[152:155]
    ds_read_b64_tr_b16 v[98:99], v11 offset:20992
    v_mfma_f32_16x16x32_bf16 v[156:159], v[36:39], v[48:51], v[156:159]
    ds_read_b64_tr_b16 v[100:101], v12 offset:20480
    v_mfma_f32_16x16x32_bf16 v[160:163], v[32:35], v[52:55], v[160:163]
    ds_read_b64_tr_b16 v[102:103], v12 offset:20992
    v_mfma_f32_16x16x32_bf16 v[164:167], v[36:39], v[52:55], v[164:167]
    ds_read_b64_tr_b16 v[104:105], v13 offset:20480
    s_waitcnt lgkmcnt(15)
    v_mfma_f32_16x16x32_bf16 v[168:171], v[56:59], v[32:35], v[168:171]
    ds_read_b64_tr_b16 v[106:107], v13 offset:20992
    v_mfma_f32_16x16x32_bf16 v[184:187], v[56:59], v[36:39], v[184:187]
    ds_read_b64_tr_b16 v[108:109], v10 offset:28672
    v_mfma_f32_16x16x32_bf16 v[228:231], v[16:19], v[56:59], v[228:231]
    ds_read_b64_tr_b16 v[110:111], v10 offset:29184
    v_mfma_f32_16x16x32_bf16 v[172:175], v[60:63], v[32:35], v[172:175]
    ds_read_b64_tr_b16 v[112:113], v11 offset:28672
    v_mfma_f32_16x16x32_bf16 v[188:191], v[60:63], v[36:39], v[188:191]
    ds_read_b64_tr_b16 v[114:115], v11 offset:29184
    s_waitcnt lgkmcnt(15)
    v_mfma_f32_16x16x32_bf16 v[176:179], v[64:67], v[32:35], v[176:179]
    ds_read_b64_tr_b16 v[116:117], v12 offset:28672
    v_mfma_f32_16x16x32_bf16 v[192:195], v[64:67], v[36:39], v[192:195]
    ds_read_b64_tr_b16 v[118:119], v12 offset:29184
    v_mfma_f32_16x16x32_bf16 v[180:183], v[68:71], v[32:35], v[180:183]
    ds_read_b64_tr_b16 v[120:121], v13 offset:28672
    v_mfma_f32_16x16x32_bf16 v[196:199], v[68:71], v[36:39], v[196:199]
    ds_read_b64_tr_b16 v[122:123], v13 offset:29184
    v_mfma_f32_16x16x32_bf16 v[200:203], v[32:35], v[72:75], v[200:203]
    ds_read_b128 v[124:127], v8 offset:6144
    v_mfma_f32_16x16x32_bf16 v[204:207], v[36:39], v[72:75], v[204:207]
    ds_read_b128 v[128:131], v9 offset:8192
    v_mfma_f32_16x16x32_bf16 v[208:211], v[32:35], v[76:79], v[208:211]
    ds_read_b128 v[132:135], v8 offset:10240
    v_mfma_f32_16x16x32_bf16 v[212:215], v[36:39], v[76:79], v[212:215]
    s_waitcnt lgkmcnt(15)
    v_mfma_f32_16x16x32_bf16 v[216:219], v[32:35], v[80:83], v[216:219]
    v_mfma_f32_16x16x32_bf16 v[220:223], v[36:39], v[80:83], v[220:223]
    v_mfma_f32_16x16x32_bf16 v[136:139], v[84:87], v[92:95], v[136:139]
    v_mfma_f32_16x16x32_bf16 v[140:143], v[88:91], v[92:95], v[140:143]
    v_mfma_f32_16x16x32_bf16 v[224:227], v[16:19], v[92:95], v[224:227]
    v_mfma_f32_16x16x32_bf16 v[144:147], v[84:87], v[96:99], v[144:147]
    s_waitcnt lgkmcnt(0)
    s_waitcnt vmcnt(0)
    s_cmp_eq_u32 s19, 3
    s_cbranch_scc0 L_cz_nan
    s_mov_b32 s18, 131072
L_cz_an0:
    v_readfirstlane_b32 s3, v20
    s_sub_u32 s18, s18, 1
    s_cmp_lg_u32 s3, 0
    s_cbranch_scc1 L_cz_nan
    s_cmp_le_i32 s18, 0
    s_cbranch_scc1 L_cz_nan
    buffer_load_dword v20, off, s[36:39], 0 sc1
    s_waitcnt vmcnt(0)
    s_branch L_cz_an0
L_cz_nan:
    s_barrier
    s_cmp_eq_u32 s19, 3
    s_cbranch_scc0 L_cz_npb
    v_readfirstlane_b32 s18, v20
    s_lshr_b32 s3, s65, 8
    s_sub_u32 s3, s3, s18
    s_and_b32 s3, s3, 7
    s_add_u32 s3, s3, 1
    v_mov_b32 v24, s3
    s_lshl_b32 s3, s3, 8
    s_and_b32 s65, s65, 255
    s_or_b32 s65, s65, s3
    s_and_b32 s3, s65, 255
    s_lshl_b32 s3, s3, 2
    s_add_u32 s3, s3, 29097984
    s_mov_b64 exec, 1
    buffer_store_dword v24, off, s[32:35], s3 sc1
    s_mov_b64 exec, -1
L_cz_npb:
    ds_read_b128 v[32:35], v2 offset:32768
    v_mfma_f32_16x16x32_bf16 v[148:151], v[88:91], v[96:99], v[148:151]
    ds_read_b64_tr_b16 v[40:41], v10 offset:32768
    v_mfma_f32_16x16x32_bf16 v[152:155], v[84:87], v[100:103], v[152:155]
    ds_read_b64_tr_b16 v[42:43], v10 offset:33280
    v_mfma_f32_16x16x32_bf16 v[156:159], v[88:91], v[100:103], v[156:159]
    ds_read_b128 v[36:39], v3 offset:32768
    v_mfma_f32_16x16x32_bf16 v[160:163], v[84:87], v[104:107], v[160:163]
    ds_read_b64_tr_b16 v[44:45], v11 offset:32768
    v_mfma_f32_16x16x32_bf16 v[164:167], v[88:91], v[104:107], v[164:167]
    ds_read_b64_tr_b16 v[46:47], v11 offset:33280
    v_mfma_f32_16x16x32_bf16 v[168:171], v[108:111], v[84:87], v[168:171]
    ds_read_b64_tr_b16 v[48:49], v12 offset:32768
    v_mfma_f32_16x16x32_bf16 v[184:187], v[108:111], v[88:91], v[184:187]
    ds_read_b64_tr_b16 v[50:51], v12 offset:33280
    v_mfma_f32_16x16x32_bf16 v[228:231], v[16:19], v[108:111], v[228:231]
    ds_read_b64_tr_b16 v[52:53], v13 offset:32768
    v_mfma_f32_16x16x32_bf16 v[172:175], v[112:115], v[84:87], v[172:175]
    ds_read_b64_tr_b16 v[54:55], v13 offset:33280
    v_mfma_f32_16x16x32_bf16 v[188:191], v[112:115], v[88:91], v[188:191]
    ds_read_b64_tr_b16 v[56:57], v10 offset:40960
    v_mfma_f32_16x16x32_bf16 v[176:179], v[116:119], v[84:87], v[176:179]
    ds_read_b64_tr_b16 v[58:59], v10 offset:41472
    v_mfma_f32_16x16x32_bf16 v[192:195], v[116:119], v[88:91], v[192:195]
    ds_read_b64_tr_b16 v[60:61], v11 offset:40960
    v_mfma_f32_16x16x32_bf16 v[180:183], v[120:123], v[84:87], v[180:183]
    ds_read_b64_tr_b16 v[62:63], v11 offset:41472
    v_mfma_f32_16x16x32_bf16 v[196:199], v[120:123], v[88:91], v[196:199]
    ds_read_b64_tr_b16 v[64:65], v12 offset:40960
    v_mfma_f32_16x16x32_bf16 v[200:203], v[84:87], v[124:127], v[200:203]
    ds_read_b64_tr_b16 v[66:67], v12 offset:41472
    v_mfma_f32_16x16x32_bf16 v[204:207], v[88:91], v[124:127], v[204:207]
    ds_read_b64_tr_b16 v[68:69], v13 offset:40960
    v_mfma_f32_16x16x32_bf16 v[208:211], v[84:87], v[128:131], v[208:211]
    ds_read_b64_tr_b16 v[70:71], v13 offset:41472
    v_mfma_f32_16x16x32_bf16 v[212:215], v[88:91], v[128:131], v[212:215]
    ds_read_b128 v[72:75], v6 offset:12288
    v_mfma_f32_16x16x32_bf16 v[216:219], v[84:87], v[132:135], v[216:219]
    ds_read_b128 v[76:79], v7 offset:14336
    v_mfma_f32_16x16x32_bf16 v[220:223], v[88:91], v[132:135], v[220:223]
    ds_read_b128 v[80:83], v6 offset:16384
    s_waitcnt lgkmcnt(15)
    v_mfma_f32_16x16x32_bf16 v[136:139], v[32:35], v[40:43], v[136:139]
    ds_read_b128 v[84:87], v4 offset:32768
    v_mfma_f32_16x16x32_bf16 v[140:143], v[36:39], v[40:43], v[140:143]
    ds_read_b64_tr_b16 v[92:93], v10 offset:36864
    v_mfma_f32_16x16x32_bf16 v[224:227], v[16:19], v[40:43], v[224:227]
    ds_read_b64_tr_b16 v[94:95], v10 offset:37376
    v_mfma_f32_16x16x32_bf16 v[144:147], v[32:35], v[44:47], v[144:147]
    ds_read_b128 v[88:91], v5 offset:32768
    v_mfma_f32_16x16x32_bf16 v[148:151], v[36:39], v[44:47], v[148:151]
    ds_read_b64_tr_b16 v[96:97], v11 offset:36864
    s_waitcnt lgkmcnt(15)
    v_mfma_f32_16x16x32_bf16 v[152:155], v[32:35], v[48:51], v[152:155]
    ds_read_b64_tr_b16 v[98:99], v11 offset:37376
    v_mfma_f32_16x16x32_bf16 v[156:159], v[36:39], v[48:51], v[156:159]
    ds_read_b64_tr_b16 v[100:101], v12 offset:36864
    v_mfma_f32_16x16x32_bf16 v[160:163], v[32:35], v[52:55], v[160:163]
    ds_read_b64_tr_b16 v[102:103], v12 offset:37376
    v_mfma_f32_16x16x32_bf16 v[164:167], v[36:39], v[52:55], v[164:167]
    ds_read_b64_tr_b16 v[104:105], v13 offset:36864
    s_waitcnt lgkmcnt(15)
    v_mfma_f32_16x16x32_bf16 v[168:171], v[56:59], v[32:35], v[168:171]
    ds_read_b64_tr_b16 v[106:107], v13 offset:37376
    v_mfma_f32_16x16x32_bf16 v[184:187], v[56:59], v[36:39], v[184:187]
    ds_read_b64_tr_b16 v[108:109], v10 offset:45056
    v_mfma_f32_16x16x32_bf16 v[228:231], v[16:19], v[56:59], v[228:231]
    ds_read_b64_tr_b16 v[110:111], v10 offset:45568
    v_mfma_f32_16x16x32_bf16 v[172:175], v[60:63], v[32:35], v[172:175]
    ds_read_b64_tr_b16 v[112:113], v11 offset:45056
    v_mfma_f32_16x16x32_bf16 v[188:191], v[60:63], v[36:39], v[188:191]
    ds_read_b64_tr_b16 v[114:115], v11 offset:45568
    s_waitcnt lgkmcnt(15)
    v_mfma_f32_16x16x32_bf16 v[176:179], v[64:67], v[32:35], v[176:179]
    ds_read_b64_tr_b16 v[116:117], v12 offset:45056
    v_mfma_f32_16x16x32_bf16 v[192:195], v[64:67], v[36:39], v[192:195]
    ds_read_b64_tr_b16 v[118:119], v12 offset:45568
    v_mfma_f32_16x16x32_bf16 v[180:183], v[68:71], v[32:35], v[180:183]
    ds_read_b64_tr_b16 v[120:121], v13 offset:45056
    v_mfma_f32_16x16x32_bf16 v[196:199], v[68:71], v[36:39], v[196:199]
    ds_read_b64_tr_b16 v[122:123], v13 offset:45568
    v_mfma_f32_16x16x32_bf16 v[200:203], v[32:35], v[72:75], v[200:203]
    ds_read_b128 v[124:127], v8 offset:12288
    v_mfma_f32_16x16x32_bf16 v[204:207], v[36:39], v[72:75], v[204:207]
    ds_read_b128 v[128:131], v9 offset:14336
    v_mfma_f32_16x16x32_bf16 v[208:211], v[32:35], v[76:79], v[208:211]
    ds_read_b128 v[132:135], v8 offset:16384
    v_mfma_f32_16x16x32_bf16 v[212:215], v[36:39], v[76:79], v[212:215]
    s_waitcnt lgkmcnt(15)
    v_mfma_f32_16x16x32_bf16 v[216:219], v[32:35], v[80:83], v[216:219]
    v_mfma_f32_16x16x32_bf16 v[220:223], v[36:39], v[80:83], v[220:223]
    v_mfma_f32_16x16x32_bf16 v[136:139], v[84:87], v[92:95], v[136:139]
    v_mfma_f32_16x16x32_bf16 v[140:143], v[88:91], v[92:95], v[140:143]
    v_mfma_f32_16x16x32_bf16 v[224:227], v[16:19], v[92:95], v[224:227]
    v_mfma_f32_16x16x32_bf16 v[144:147], v[84:87], v[96:99], v[144:147]
    s_waitcnt lgkmcnt(0)
    s_barrier
    ds_read_b128 v[32:35], v2 offset:49152
    v_mfma_f32_16x16x32_bf16 v[148:151], v[88:91], v[96:99], v[148:151]
    ds_read_b64_tr_b16 v[40:41], v10 offset:49152
    v_mfma_f32_16x16x32_bf16 v[152:155], v[84:87], v[100:103], v[152:155]
    ds_read_b64_tr_b16 v[42:43], v10 offset:49664
    v_mfma_f32_16x16x32_bf16 v[156:159], v[88:91], v[100:103], v[156:159]
    ds_read_b128 v[36:39], v3 offset:49152
    v_mfma_f32_16x16x32_bf16 v[160:163], v[84:87], v[104:107], v[160:163]
    ds_read_b64_tr_b16 v[44:45], v11 offset:49152
    v_mfma_f32_16x16x32_bf16 v[164:167], v[88:91], v[104:107], v[164:167]
    ds_read_b64_tr_b16 v[46:47], v11 offset:49664
    v_mfma_f32_16x16x32_bf16 v[168:171], v[108:111], v[84:87], v[168:171]
    ds_read_b64_tr_b16 v[48:49], v12 offset:49152
    v_mfma_f32_16x16x32_bf16 v[184:187], v[108:111], v[88:91], v[184:187]
    ds_read_b64_tr_b16 v[50:51], v12 offset:49664
    v_mfma_f32_16x16x32_bf16 v[228:231], v[16:19], v[108:111], v[228:231]
    ds_read_b64_tr_b16 v[52:53], v13 offset:49152
    v_mfma_f32_16x16x32_bf16 v[172:175], v[112:115], v[84:87], v[172:175]
    ds_read_b64_tr_b16 v[54:55], v13 offset:49664
    v_mfma_f32_16x16x32_bf16 v[188:191], v[112:115], v[88:91], v[188:191]
    ds_read_b64_tr_b16 v[56:57], v10 offset:57344
    v_mfma_f32_16x16x32_bf16 v[176:179], v[116:119], v[84:87], v[176:179]
    ds_read_b64_tr_b16 v[58:59], v10 offset:57856
    v_mfma_f32_16x16x32_bf16 v[192:195], v[116:119], v[88:91], v[192:195]
    ds_read_b64_tr_b16 v[60:61], v11 offset:57344
    v_mfma_f32_16x16x32_bf16 v[180:183], v[120:123], v[84:87], v[180:183]
    ds_read_b64_tr_b16 v[62:63], v11 offset:57856
    v_mfma_f32_16x16x32_bf16 v[196:199], v[120:123], v[88:91], v[196:199]
    ds_read_b64_tr_b16 v[64:65], v12 offset:57344
    v_mfma_f32_16x16x32_bf16 v[200:203], v[84:87], v[124:127], v[200:203]
    ds_read_b64_tr_b16 v[66:67], v12 offset:57856
    v_mfma_f32_16x16x32_bf16 v[204:207], v[88:91], v[124:127], v[204:207]
    ds_read_b64_tr_b16 v[68:69], v13 offset:57344
    v_mfma_f32_16x16x32_bf16 v[208:211], v[84:87], v[128:131], v[208:211]
    ds_read_b64_tr_b16 v[70:71], v13 offset:57856
    v_mfma_f32_16x16x32_bf16 v[212:215], v[88:91], v[128:131], v[212:215]
    ds_read_b128 v[72:75], v6 offset:18432
    v_mfma_f32_16x16x32_bf16 v[216:219], v[84:87], v[132:135], v[216:219]
    ds_read_b128 v[76:79], v7 offset:20480
    v_mfma_f32_16x16x32_bf16 v[220:223], v[88:91], v[132:135], v[220:223]
    ds_read_b128 v[80:83], v6 offset:22528
    s_waitcnt lgkmcnt(15)
    v_mfma_f32_16x16x32_bf16 v[136:139], v[32:35], v[40:43], v[136:139]
    ds_read_b128 v[84:87], v4 offset:49152
    v_mfma_f32_16x16x32_bf16 v[140:143], v[36:39], v[40:43], v[140:143]
    ds_read_b64_tr_b16 v[92:93], v10 offset:53248
    v_mfma_f32_16x16x32_bf16 v[224:227], v[16:19], v[40:43], v[224:227]
    ds_read_b64_tr_b16 v[94:95], v10 offset:53760
    v_mfma_f32_16x16x32_bf16 v[144:147], v[32:35], v[44:47], v[144:147]
    ds_read_b128 v[88:91], v5 offset:49152
    v_mfma_f32_16x16x32_bf16 v[148:151], v[36:39], v[44:47], v[148:151]
    ds_read_b64_tr_b16 v[96:97], v11 offset:53248
    s_waitcnt lgkmcnt(15)
    v_mfma_f32_16x16x32_bf16 v[152:155], v[32:35], v[48:51], v[152:155]
    ds_read_b64_tr_b16 v[98:99], v11 offset:53760
    v_mfma_f32_16x16x32_bf16 v[156:159], v[36:39], v[48:51], v[156:159]
    ds_read_b64_tr_b16 v[100:101], v12 offset:53248
    v_mfma_f32_16x16x32_bf16 v[160:163], v[32:35], v[52:55], v[160:163]
    ds_read_b64_tr_b16 v[102:103], v12 offset:53760
    v_mfma_f32_16x16x32_bf16 v[164:167], v[36:39], v[52:55], v[164:167]
    ds_read_b64_tr_b16 v[104:105], v13 offset:53248
    s_waitcnt lgkmcnt(15)
    v_mfma_f32_16x16x32_bf16 v[168:171], v[56:59], v[32:35], v[168:171]
    ds_read_b64_tr_b16 v[106:107], v13 offset:53760
    v_mfma_f32_16x16x32_bf16 v[184:187], v[56:59], v[36:39], v[184:187]
    ds_read_b64_tr_b16 v[108:109], v10 offset:61440
    v_mfma_f32_16x16x32_bf16 v[228:231], v[16:19], v[56:59], v[228:231]
    ds_read_b64_tr_b16 v[110:111], v10 offset:61952
    v_mfma_f32_16x16x32_bf16 v[172:175], v[60:63], v[32:35], v[172:175]
    ds_read_b64_tr_b16 v[112:113], v11 offset:61440
    v_mfma_f32_16x16x32_bf16 v[188:191], v[60:63], v[36:39], v[188:191]
    ds_read_b64_tr_b16 v[114:115], v11 offset:61952
    s_waitcnt lgkmcnt(15)
    v_mfma_f32_16x16x32_bf16 v[176:179], v[64:67], v[32:35], v[176:179]
    ds_read_b64_tr_b16 v[116:117], v12 offset:61440
    v_mfma_f32_16x16x32_bf16 v[192:195], v[64:67], v[36:39], v[192:195]
    ds_read_b64_tr_b16 v[118:119], v12 offset:61952
    v_mfma_f32_16x16x32_bf16 v[180:183], v[68:71], v[32:35], v[180:183]
    ds_read_b64_tr_b16 v[120:121], v13 offset:61440
    v_mfma_f32_16x16x32_bf16 v[196:199], v[68:71], v[36:39], v[196:199]
    ds_read_b64_tr_b16 v[122:123], v13 offset:61952
    v_mfma_f32_16x16x32_bf16 v[200:203], v[32:35], v[72:75], v[200:203]
    ds_read_b128 v[124:127], v8 offset:18432
    v_mfma_f32_16x16x32_bf16 v[204:207], v[36:39], v[72:75], v[204:207]
    ds_read_b128 v[128:131], v9 offset:20480
    v_mfma_f32_16x16x32_bf16 v[208:211], v[32:35], v[76:79], v[208:211]
    ds_read_b128 v[132:135], v8 offset:22528
    v_mfma_f32_16x16x32_bf16 v[212:215], v[36:39], v[76:79], v[212:215]
    s_waitcnt lgkmcnt(15)
    v_mfma_f32_16x16x32_bf16 v[216:219], v[32:35], v[80:83], v[216:219]
    v_mfma_f32_16x16x32_bf16 v[220:223], v[36:39], v[80:83], v[220:223]
    v_mfma_f32_16x16x32_bf16 v[136:139], v[84:87], v[92:95], v[136:139]
    v_mfma_f32_16x16x32_bf16 v[140:143], v[88:91], v[92:95], v[140:143]
    v_mfma_f32_16x16x32_bf16 v[224:227], v[16:19], v[92:95], v[224:227]
    v_mfma_f32_16x16x32_bf16 v[144:147], v[84:87], v[96:99], v[144:147]
    s_waitcnt lgkmcnt(0)
    s_barrier
    ds_read_b128 v[32:35], v2 offset:0
    v_mfma_f32_16x16x32_bf16 v[148:151], v[88:91], v[96:99], v[148:151]
    ds_read_b64_tr_b16 v[40:41], v10 offset:0
    v_mfma_f32_16x16x32_bf16 v[152:155], v[84:87], v[100:103], v[152:155]
    ds_read_b64_tr_b16 v[42:43], v10 offset:512
    v_mfma_f32_16x16x32_bf16 v[156:159], v[88:91], v[100:103], v[156:159]
    ds_read_b128 v[36:39], v3 offset:0
    v_mfma_f32_16x16x32_bf16 v[160:163], v[84:87], v[104:107], v[160:163]
    ds_read_b64_tr_b16 v[44:45], v11 offset:0
    v_mfma_f32_16x16x32_bf16 v[164:167], v[88:91], v[104:107], v[164:167]
    ds_read_b64_tr_b16 v[46:47], v11 offset:512
    v_mfma_f32_16x16x32_bf16 v[168:171], v[108:111], v[84:87], v[168:171]
    ds_read_b64_tr_b16 v[48:49], v12 offset:0
    v_mfma_f32_16x16x32_bf16 v[184:187], v[108:111], v[88:91], v[184:187]
    ds_read_b64_tr_b16 v[50:51], v12 offset:512
    v_mfma_f32_16x16x32_bf16 v[228:231], v[16:19], v[108:111], v[228:231]
    ds_read_b64_tr_b16 v[52:53], v13 offset:0
    v_mfma_f32_16x16x32_bf16 v[172:175], v[112:115], v[84:87], v[172:175]
    ds_read_b64_tr_b16 v[54:55], v13 offset:512
    v_mfma_f32_16x16x32_bf16 v[188:191], v[112:115], v[88:91], v[188:191]
    ds_read_b64_tr_b16 v[56:57], v10 offset:8192
    v_mfma_f32_16x16x32_bf16 v[176:179], v[116:119], v[84:87], v[176:179]
    ds_read_b64_tr_b16 v[58:59], v10 offset:8704
    v_mfma_f32_16x16x32_bf16 v[192:195], v[116:119], v[88:91], v[192:195]
    ds_read_b64_tr_b16 v[60:61], v11 offset:8192
    v_mfma_f32_16x16x32_bf16 v[180:183], v[120:123], v[84:87], v[180:183]
    ds_read_b64_tr_b16 v[62:63], v11 offset:8704
    v_mfma_f32_16x16x32_bf16 v[196:199], v[120:123], v[88:91], v[196:199]
    ds_read_b64_tr_b16 v[64:65], v12 offset:8192
    v_mfma_f32_16x16x32_bf16 v[200:203], v[84:87], v[124:127], v[200:203]
    ds_read_b64_tr_b16 v[66:67], v12 offset:8704
    v_mfma_f32_16x16x32_bf16 v[204:207], v[88:91], v[124:127], v[204:207]
    ds_read_b64_tr_b16 v[68:69], v13 offset:8192
    v_mfma_f32_16x16x32_bf16 v[208:211], v[84:87], v[128:131], v[208:211]
    ds_read_b64_tr_b16 v[70:71], v13 offset:8704
    v_mfma_f32_16x16x32_bf16 v[212:215], v[88:91], v[128:131], v[212:215]
    ds_read_b128 v[72:75], v6 offset:0
    v_mfma_f32_16x16x32_bf16 v[216:219], v[84:87], v[132:135], v[216:219]
    ds_read_b128 v[76:79], v7 offset:2048
    v_mfma_f32_16x16x32_bf16 v[220:223], v[88:91], v[132:135], v[220:223]
    ds_read_b128 v[80:83], v6 offset:4096
    s_waitcnt lgkmcnt(15)
    v_mfma_f32_16x16x32_bf16 v[136:139], v[32:35], v[40:43], v[136:139]
    ds_read_b128 v[84:87], v4 offset:0
    v_mfma_f32_16x16x32_bf16 v[140:143], v[36:39], v[40:43], v[140:143]
    ds_read_b64_tr_b16 v[92:93], v10 offset:4096
    v_mfma_f32_16x16x32_bf16 v[224:227], v[16:19], v[40:43], v[224:227]
    ds_read_b64_tr_b16 v[94:95], v10 offset:4608
    v_mfma_f32_16x16x32_bf16 v[144:147], v[32:35], v[44:47], v[144:147]
    ds_read_b128 v[88:91], v5 offset:0
    v_mfma_f32_16x16x32_bf16 v[148:151], v[36:39], v[44:47], v[148:151]
    ds_read_b64_tr_b16 v[96:97], v11 offset:4096
    s_waitcnt lgkmcnt(15)
    v_mfma_f32_16x16x32_bf16 v[152:155], v[32:35], v[48:51], v[152:155]
    ds_read_b64_tr_b16 v[98:99], v11 offset:4608
    v_mfma_f32_16x16x32_bf16 v[156:159], v[36:39], v[48:51], v[156:159]
    ds_read_b64_tr_b16 v[100:101], v12 offset:4096
    v_mfma_f32_16x16x32_bf16 v[160:163], v[32:35], v[52:55], v[160:163]
    ds_read_b64_tr_b16 v[102:103], v12 offset:4608
    v_mfma_f32_16x16x32_bf16 v[164:167], v[36:39], v[52:55], v[164:167]
    ds_read_b64_tr_b16 v[104:105], v13 offset:4096
    s_waitcnt lgkmcnt(15)
    v_mfma_f32_16x16x32_bf16 v[168:171], v[56:59], v[32:35], v[168:171]
    ds_read_b64_tr_b16 v[106:107], v13 offset:4608
    v_mfma_f32_16x16x32_bf16 v[184:187], v[56:59], v[36:39], v[184:187]
    ds_read_b64_tr_b16 v[108:109], v10 offset:12288
    v_mfma_f32_16x16x32_bf16 v[228:231], v[16:19], v[56:59], v[228:231]
    ds_read_b64_tr_b16 v[110:111], v10 offset:12800
    v_mfma_f32_16x16x32_bf16 v[172:175], v[60:63], v[32:35], v[172:175]
    ds_read_b64_tr_b16 v[112:113], v11 offset:12288
    v_mfma_f32_16x16x32_bf16 v[188:191], v[60:63], v[36:39], v[188:191]
    ds_read_b64_tr_b16 v[114:115], v11 offset:12800
    s_waitcnt lgkmcnt(15)
    v_mfma_f32_16x16x32_bf16 v[176:179], v[64:67], v[32:35], v[176:179]
    ds_read_b64_tr_b16 v[116:117], v12 offset:12288
    v_mfma_f32_16x16x32_bf16 v[192:195], v[64:67], v[36:39], v[192:195]
    ds_read_b64_tr_b16 v[118:119], v12 offset:12800
    v_mfma_f32_16x16x32_bf16 v[180:183], v[68:71], v[32:35], v[180:183]
    ds_read_b64_tr_b16 v[120:121], v13 offset:12288
    v_mfma_f32_16x16x32_bf16 v[196:199], v[68:71], v[36:39], v[196:199]
    ds_read_b64_tr_b16 v[122:123], v13 offset:12800
    v_mfma_f32_16x16x32_bf16 v[200:203], v[32:35], v[72:75], v[200:203]
    ds_read_b128 v[124:127], v8 offset:0
    v_mfma_f32_16x16x32_bf16 v[204:207], v[36:39], v[72:75], v[204:207]
    ds_read_b128 v[128:131], v9 offset:2048
    v_mfma_f32_16x16x32_bf16 v[208:211], v[32:35], v[76:79], v[208:211]
    ds_read_b128 v[132:135], v8 offset:4096
    v_mfma_f32_16x16x32_bf16 v[212:215], v[36:39], v[76:79], v[212:215]
    s_waitcnt lgkmcnt(15)
    v_mfma_f32_16x16x32_bf16 v[216:219], v[32:35], v[80:83], v[216:219]
    v_mfma_f32_16x16x32_bf16 v[220:223], v[36:39], v[80:83], v[220:223]
    v_mfma_f32_16x16x32_bf16 v[136:139], v[84:87], v[92:95], v[136:139]
    v_mfma_f32_16x16x32_bf16 v[140:143], v[88:91], v[92:95], v[140:143]
    v_mfma_f32_16x16x32_bf16 v[224:227], v[16:19], v[92:95], v[224:227]
    v_mfma_f32_16x16x32_bf16 v[144:147], v[84:87], v[96:99], v[144:147]
    s_waitcnt lgkmcnt(0)
    s_cmp_eq_u32 s19, 3
    s_cbranch_scc0 L_cz_ntl
    s_mov_b32 s3, 29097984
    buffer_load_dwordx4 v[20:23], v14, s[32:35], s3 offen
L_cz_ntl:
    s_barrier
    ds_read_b128 v[32:35], v2 offset:16384
    v_mfma_f32_16x16x32_bf16 v[148:151], v[88:91], v[96:99], v[148:151]
    ds_read_b64_tr_b16 v[40:41], v10 offset:16384
    v_mfma_f32_16x16x32_bf16 v[152:155], v[84:87], v[100:103], v[152:155]
    ds_read_b64_tr_b16 v[42:43], v10 offset:16896
    v_mfma_f32_16x16x32_bf16 v[156:159], v[88:91], v[100:103], v[156:159]
    ds_read_b128 v[36:39], v3 offset:16384
    v_mfma_f32_16x16x32_bf16 v[160:163], v[84:87], v[104:107], v[160:163]
    ds_read_b64_tr_b16 v[44:45], v11 offset:16384
    v_mfma_f32_16x16x32_bf16 v[164:167], v[88:91], v[104:107], v[164:167]
    ds_read_b64_tr_b16 v[46:47], v11 offset:16896
    v_mfma_f32_16x16x32_bf16 v[168:171], v[108:111], v[84:87], v[168:171]
    ds_read_b64_tr_b16 v[48:49], v12 offset:16384
    v_mfma_f32_16x16x32_bf16 v[184:187], v[108:111], v[88:91], v[184:187]
    ds_read_b64_tr_b16 v[50:51], v12 offset:16896
    v_mfma_f32_16x16x32_bf16 v[228:231], v[16:19], v[108:111], v[228:231]
    ds_read_b64_tr_b16 v[52:53], v13 offset:16384
    v_mfma_f32_16x16x32_bf16 v[172:175], v[112:115], v[84:87], v[172:175]
    ds_read_b64_tr_b16 v[54:55], v13 offset:16896
    v_mfma_f32_16x16x32_bf16 v[188:191], v[112:115], v[88:91], v[188:191]
    ds_read_b64_tr_b16 v[56:57], v10 offset:24576
    v_mfma_f32_16x16x32_bf16 v[176:179], v[116:119], v[84:87], v[176:179]
    ds_read_b64_tr_b16 v[58:59], v10 offset:25088
    v_mfma_f32_16x16x32_bf16 v[192:195], v[116:119], v[88:91], v[192:195]
    ds_read_b64_tr_b16 v[60:61], v11 offset:24576
    v_mfma_f32_16x16x32_bf16 v[180:183], v[120:123], v[84:87], v[180:183]
    ds_read_b64_tr_b16 v[62:63], v11 offset:25088
    v_mfma_f32_16x16x32_bf16 v[196:199], v[120:123], v[88:91], v[196:199]
    ds_read_b64_tr_b16 v[64:65], v12 offset:24576
    v_mfma_f32_16x16x32_bf16 v[200:203], v[84:87], v[124:127], v[200:203]
    ds_read_b64_tr_b16 v[66:67], v12 offset:25088
    v_mfma_f32_16x16x32_bf16 v[204:207], v[88:91], v[124:127], v[204:207]
    ds_read_b64_tr_b16 v[68:69], v13 offset:24576
    v_mfma_f32_16x16x32_bf16 v[208:211], v[84:87], v[128:131], v[208:211]
    ds_read_b64_tr_b16 v[70:71], v13 offset:25088
    v_mfma_f32_16x16x32_bf16 v[212:215], v[88:91], v[128:131], v[212:215]
    ds_read_b128 v[72:75], v6 offset:6144
    v_mfma_f32_16x16x32_bf16 v[216:219], v[84:87], v[132:135], v[216:219]
    ds_read_b128 v[76:79], v7 offset:8192
    v_mfma_f32_16x16x32_bf16 v[220:223], v[88:91], v[132:135], v[220:223]
    ds_read_b128 v[80:83], v6 offset:10240
    s_waitcnt lgkmcnt(15)
    v_mfma_f32_16x16x32_bf16 v[136:139], v[32:35], v[40:43], v[136:139]
    ds_read_b128 v[84:87], v4 offset:16384
    v_mfma_f32_16x16x32_bf16 v[140:143], v[36:39], v[40:43], v[140:143]
    ds_read_b64_tr_b16 v[92:93], v10 offset:20480
    v_mfma_f32_16x16x32_bf16 v[224:227], v[16:19], v[40:43], v[224:227]
    ds_read_b64_tr_b16 v[94:95], v10 offset:20992
    v_mfma_f32_16x16x32_bf16 v[144:147], v[32:35], v[44:47], v[144:147]
    ds_read_b128 v[88:91], v5 offset:16384
    v_mfma_f32_16x16x32_bf16 v[148:151], v[36:39], v[44:47], v[148:151]
    ds_read_b64_tr_b16 v[96:97], v11 offset:20480
    s_waitcnt lgkmcnt(15)
    v_mfma_f32_16x16x32_bf16 v[152:155], v[32:35], v[48:51], v[152:155]
    ds_read_b64_tr_b16 v[98:99], v11 offset:20992
    v_mfma_f32_16x16x32_bf16 v[156:159], v[36:39], v[48:51], v[156:159]
    ds_read_b64_tr_b16 v[100:101], v12 offset:20480
    v_mfma_f32_16x16x32_bf16 v[160:163], v[32:35], v[52:55], v[160:163]
    ds_read_b64_tr_b16 v[102:103], v12 offset:20992
    v_mfma_f32_16x16x32_bf16 v[164:167], v[36:39], v[52:55], v[164:167]
    ds_read_b64_tr_b16 v[104:105], v13 offset:20480
    s_waitcnt lgkmcnt(15)
    v_mfma_f32_16x16x32_bf16 v[168:171], v[56:59], v[32:35], v[168:171]
    ds_read_b64_tr_b16 v[106:107], v13 offset:20992
    v_mfma_f32_16x16x32_bf16 v[184:187], v[56:59], v[36:39], v[184:187]
    ds_read_b64_tr_b16 v[108:109], v10 offset:28672
    v_mfma_f32_16x16x32_bf16 v[228:231], v[16:19], v[56:59], v[228:231]
    ds_read_b64_tr_b16 v[110:111], v10 offset:29184
    v_mfma_f32_16x16x32_bf16 v[172:175], v[60:63], v[32:35], v[172:175]
    ds_read_b64_tr_b16 v[112:113], v11 offset:28672
    v_mfma_f32_16x16x32_bf16 v[188:191], v[60:63], v[36:39], v[188:191]
    ds_read_b64_tr_b16 v[114:115], v11 offset:29184
    s_waitcnt lgkmcnt(15)
    v_mfma_f32_16x16x32_bf16 v[176:179], v[64:67], v[32:35], v[176:179]
    ds_read_b64_tr_b16 v[116:117], v12 offset:28672
    v_mfma_f32_16x16x32_bf16 v[192:195], v[64:67], v[36:39], v[192:195]
    ds_read_b64_tr_b16 v[118:119], v12 offset:29184
    v_mfma_f32_16x16x32_bf16 v[180:183], v[68:71], v[32:35], v[180:183]
    ds_read_b64_tr_b16 v[120:121], v13 offset:28672
    v_mfma_f32_16x16x32_bf16 v[196:199], v[68:71], v[36:39], v[196:199]
    ds_read_b64_tr_b16 v[122:123], v13 offset:29184
    v_mfma_f32_16x16x32_bf16 v[200:203], v[32:35], v[72:75], v[200:203]
    ds_read_b128 v[124:127], v8 offset:6144
    v_mfma_f32_16x16x32_bf16 v[204:207], v[36:39], v[72:75], v[204:207]
    ds_read_b128 v[128:131], v9 offset:8192
    v_mfma_f32_16x16x32_bf16 v[208:211], v[32:35], v[76:79], v[208:211]
    ds_read_b128 v[132:135], v8 offset:10240
    v_mfma_f32_16x16x32_bf16 v[212:215], v[36:39], v[76:79], v[212:215]
    s_waitcnt lgkmcnt(15)
    v_mfma_f32_16x16x32_bf16 v[216:219], v[32:35], v[80:83], v[216:219]
    v_mfma_f32_16x16x32_bf16 v[220:223], v[36:39], v[80:83], v[220:223]
    v_mfma_f32_16x16x32_bf16 v[136:139], v[84:87], v[92:95], v[136:139]
    v_mfma_f32_16x16x32_bf16 v[140:143], v[88:91], v[92:95], v[140:143]
    v_mfma_f32_16x16x32_bf16 v[224:227], v[16:19], v[92:95], v[224:227]
    v_mfma_f32_16x16x32_bf16 v[144:147], v[84:87], v[96:99], v[144:147]
    s_waitcnt lgkmcnt(0)
    s_cmp_eq_u32 s19, 3
    s_cbranch_scc0 L_cz_nrk
    s_mov_b32 s18, 131072
L_cz_rk0:
    s_waitcnt vmcnt(0)
    v_min_u32 v24, v20, v21
    v_min3_u32 v24, v24, v22, v23
    v_cmp_eq_u32 vcc, 0, v24
    s_sub_u32 s18, s18, 1
    s_cmp_eq_u64 vcc, 0
    s_cbranch_scc1 L_cz_rk1
    s_cmp_le_i32 s18, 0
    s_cbranch_scc1 L_cz_rk1
    s_sleep 2
    s_mov_b32 s3, 29097984
    buffer_load_dwordx4 v[20:23], v14, s[32:35], s3 offen sc1
    s_branch L_cz_rk0
L_cz_rk1:
    s_mov_b32 s66, 0
    s_mov_b32 s48, 0
    s_mov_b32 s49, 0
    s_lshr_b32 s18, s65, 8
    v_lshl_add_u32 v24, v20, 8, v28
    v_cmp_gt_u32 s[50:51], s18, v20
    v_add_u32 v24, 0, v24
    v_cmp_eq_u32 s[52:53], s18, v20
    v_cmp_gt_u32 vcc, s65, v24
    s_bcnt1_i32_b64 s3, s[50:51]
    s_add_u32 s48, s48, s3
    s_bcnt1_i32_b64 s3, s[52:53]
    s_add_u32 s49, s49, s3
    s_bcnt1_i32_b64 s3, vcc
    s_add_u32 s66, s66, s3
    v_lshl_add_u32 v24, v21, 8, v28
    v_cmp_gt_u32 s[50:51], s18, v21
    v_add_u32 v24, 1, v24
    v_cmp_eq_u32 s[52:53], s18, v21
    v_cmp_gt_u32 vcc, s65, v24
    s_bcnt1_i32_b64 s3, s[50:51]
    s_add_u32 s48, s48, s3
    s_bcnt1_i32_b64 s3, s[52:53]
    s_add_u32 s49, s49, s3
    s_bcnt1_i32_b64 s3, vcc
    s_add_u32 s66, s66, s3
    v_lshl_add_u32 v24, v22, 8, v28
    v_cmp_gt_u32 s[50:51], s18, v22
    v_add_u32 v24, 2, v24
    v_cmp_eq_u32 s[52:53], s18, v22
    v_cmp_gt_u32 vcc, s65, v24
    s_bcnt1_i32_b64 s3, s[50:51]
    s_add_u32 s48, s48, s3
    s_bcnt1_i32_b64 s3, s[52:53]
    s_add_u32 s49, s49, s3
    s_bcnt1_i32_b64 s3, vcc
    s_add_u32 s66, s66, s3
    v_lshl_add_u32 v24, v23, 8, v28
    v_cmp_gt_u32 s[50:51], s18, v23
    v_add_u32 v24, 3, v24
    v_cmp_eq_u32 s[52:53], s18, v23
    v_cmp_gt_u32 vcc, s65, v24
    s_bcnt1_i32_b64 s3, s[50:51]
    s_add_u32 s48, s48, s3
    s_bcnt1_i32_b64 s3, s[52:53]
    s_add_u32 s49, s49, s3
    s_bcnt1_i32_b64 s3, vcc
    s_add_u32 s66, s66, s3
    s_and_b32 s48, s48, 31
    s_xor_b32 s49, s49, 32
    s_or_b32 s48, s48, s49
    s_cmp_eq_u32 s48, 0
    s_cselect_b32 s3, 0, 0
    s_or_b32 s66, s66, s3
    v_mov_b32 v20, s66
    v_mov_b32 v21, 0
    v_mov_b32 v22, 0
    v_mov_b32 v23, 0
    v_mov_b32 v24, 158208
    ds_write_b128 v24, v[20:23]
    s_waitcnt lgkmcnt(0)
L_cz_nrk:
    s_barrier
    ds_read_b128 v[32:35], v2 offset:32768
    v_mfma_f32_16x16x32_bf16 v[148:151], v[88:91], v[96:99], v[148:151]
    ds_read_b64_tr_b16 v[40:41], v10 offset:32768
    v_mfma_f32_16x16x32_bf16 v[152:155], v[84:87], v[100:103], v[152:155]
    ds_read_b64_tr_b16 v[42:43], v10 offset:33280
    v_mfma_f32_16x16x32_bf16 v[156:159], v[88:91], v[100:103], v[156:159]
    ds_read_b128 v[36:39], v3 offset:32768
    v_mfma_f32_16x16x32_bf16 v[160:163], v[84:87], v[104:107], v[160:163]
    ds_read_b64_tr_b16 v[44:45], v11 offset:32768
    v_mfma_f32_16x16x32_bf16 v[164:167], v[88:91], v[104:107], v[164:167]
    ds_read_b64_tr_b16 v[46:47], v11 offset:33280
    v_mfma_f32_16x16x32_bf16 v[168:171], v[108:111], v[84:87], v[168:171]
    ds_read_b64_tr_b16 v[48:49], v12 offset:32768
    v_mfma_f32_16x16x32_bf16 v[184:187], v[108:111], v[88:91], v[184:187]
    ds_read_b64_tr_b16 v[50:51], v12 offset:33280
    v_mfma_f32_16x16x32_bf16 v[228:231], v[16:19], v[108:111], v[228:231]
    ds_read_b64_tr_b16 v[52:53], v13 offset:32768
    v_mfma_f32_16x16x32_bf16 v[172:175], v[112:115], v[84:87], v[172:175]
    ds_read_b64_tr_b16 v[54:55], v13 offset:33280
    v_mfma_f32_16x16x32_bf16 v[188:191], v[112:115], v[88:91], v[188:191]
    ds_read_b64_tr_b16 v[56:57], v10 offset:40960
    v_mfma_f32_16x16x32_bf16 v[176:179], v[116:119], v[84:87], v[176:179]
    ds_read_b64_tr_b16 v[58:59], v10 offset:41472
    v_mfma_f32_16x16x32_bf16 v[192:195], v[116:119], v[88:91], v[192:195]
    ds_read_b64_tr_b16 v[60:61], v11 offset:40960
    v_mfma_f32_16x16x32_bf16 v[180:183], v[120:123], v[84:87], v[180:183]
    ds_read_b64_tr_b16 v[62:63], v11 offset:41472
    v_mfma_f32_16x16x32_bf16 v[196:199], v[120:123], v[88:91], v[196:199]
    ds_read_b64_tr_b16 v[64:65], v12 offset:40960
    v_mfma_f32_16x16x32_bf16 v[200:203], v[84:87], v[124:127], v[200:203]
    ds_read_b64_tr_b16 v[66:67], v12 offset:41472
    v_mfma_f32_16x16x32_bf16 v[204:207], v[88:91], v[124:127], v[204:207]
    ds_read_b64_tr_b16 v[68:69], v13 offset:40960
    v_mfma_f32_16x16x32_bf16 v[208:211], v[84:87], v[128:131], v[208:211]
    ds_read_b64_tr_b16 v[70:71], v13 offset:41472
    v_mfma_f32_16x16x32_bf16 v[212:215], v[88:91], v[128:131], v[212:215]
    ds_read_b128 v[72:75], v6 offset:12288
    v_mfma_f32_16x16x32_bf16 v[216:219], v[84:87], v[132:135], v[216:219]
    ds_read_b128 v[76:79], v7 offset:14336
    v_mfma_f32_16x16x32_bf16 v[220:223], v[88:91], v[132:135], v[220:223]
    ds_read_b128 v[80:83], v6 offset:16384
    s_waitcnt lgkmcnt(15)
    v_mfma_f32_16x16x32_bf16 v[136:139], v[32:35], v[40:43], v[136:139]
    ds_read_b128 v[84:87], v4 offset:32768
    v_mfma_f32_16x16x32_bf16 v[140:143], v[36:39], v[40:43], v[140:143]
    ds_read_b64_tr_b16 v[92:93], v10 offset:36864
    v_mfma_f32_16x16x32_bf16 v[224:227], v[16:19], v[40:43], v[224:227]
    ds_read_b64_tr_b16 v[94:95], v10 offset:37376
    v_mfma_f32_16x16x32_bf16 v[144:147], v[32:35], v[44:47], v[144:147]
    ds_read_b128 v[88:91], v5 offset:32768
    v_mfma_f32_16x16x32_bf16 v[148:151], v[36:39], v[44:47], v[148:151]
    ds_read_b64_tr_b16 v[96:97], v11 offset:36864
    s_waitcnt lgkmcnt(15)
    v_mfma_f32_16x16x32_bf16 v[152:155], v[32:35], v[48:51], v[152:155]
    ds_read_b64_tr_b16 v[98:99], v11 offset:37376
    v_mfma_f32_16x16x32_bf16 v[156:159], v[36:39], v[48:51], v[156:159]
    ds_read_b64_tr_b16 v[100:101], v12 offset:36864
    v_mfma_f32_16x16x32_bf16 v[160:163], v[32:35], v[52:55], v[160:163]
    ds_read_b64_tr_b16 v[102:103], v12 offset:37376
    v_mfma_f32_16x16x32_bf16 v[164:167], v[36:39], v[52:55], v[164:167]
    ds_read_b64_tr_b16 v[104:105], v13 offset:36864
    s_waitcnt lgkmcnt(15)
    v_mfma_f32_16x16x32_bf16 v[168:171], v[56:59], v[32:35], v[168:171]
    ds_read_b64_tr_b16 v[106:107], v13 offset:37376
    v_mfma_f32_16x16x32_bf16 v[184:187], v[56:59], v[36:39], v[184:187]
    ds_read_b64_tr_b16 v[108:109], v10 offset:45056
    v_mfma_f32_16x16x32_bf16 v[228:231], v[16:19], v[56:59], v[228:231]
    ds_read_b64_tr_b16 v[110:111], v10 offset:45568
    v_mfma_f32_16x16x32_bf16 v[172:175], v[60:63], v[32:35], v[172:175]
    ds_read_b64_tr_b16 v[112:113], v11 offset:45056
    v_mfma_f32_16x16x32_bf16 v[188:191], v[60:63], v[36:39], v[188:191]
    ds_read_b64_tr_b16 v[114:115], v11 offset:45568
    s_waitcnt lgkmcnt(15)
    v_mfma_f32_16x16x32_bf16 v[176:179], v[64:67], v[32:35], v[176:179]
    ds_read_b64_tr_b16 v[116:117], v12 offset:45056
    v_mfma_f32_16x16x32_bf16 v[192:195], v[64:67], v[36:39], v[192:195]
    ds_read_b64_tr_b16 v[118:119], v12 offset:45568
    v_mfma_f32_16x16x32_bf16 v[180:183], v[68:71], v[32:35], v[180:183]
    ds_read_b64_tr_b16 v[120:121], v13 offset:45056
    v_mfma_f32_16x16x32_bf16 v[196:199], v[68:71], v[36:39], v[196:199]
    ds_read_b64_tr_b16 v[122:123], v13 offset:45568
    v_mfma_f32_16x16x32_bf16 v[200:203], v[32:35], v[72:75], v[200:203]
    ds_read_b128 v[124:127], v8 offset:12288
    v_mfma_f32_16x16x32_bf16 v[204:207], v[36:39], v[72:75], v[204:207]
    ds_read_b128 v[128:131], v9 offset:14336
    v_mfma_f32_16x16x32_bf16 v[208:211], v[32:35], v[76:79], v[208:211]
    ds_read_b128 v[132:135], v8 offset:16384
    v_mfma_f32_16x16x32_bf16 v[212:215], v[36:39], v[76:79], v[212:215]
    s_waitcnt lgkmcnt(15)
    v_mfma_f32_16x16x32_bf16 v[216:219], v[32:35], v[80:83], v[216:219]
    v_mfma_f32_16x16x32_bf16 v[220:223], v[36:39], v[80:83], v[220:223]
    v_mfma_f32_16x16x32_bf16 v[136:139], v[84:87], v[92:95], v[136:139]
    v_mfma_f32_16x16x32_bf16 v[140:143], v[88:91], v[92:95], v[140:143]
    v_mfma_f32_16x16x32_bf16 v[224:227], v[16:19], v[92:95], v[224:227]
    v_mfma_f32_16x16x32_bf16 v[144:147], v[84:87], v[96:99], v[144:147]
    s_waitcnt lgkmcnt(0)
    s_barrier
    ds_read_b128 v[32:35], v2 offset:49152
    v_mfma_f32_16x16x32_bf16 v[148:151], v[88:91], v[96:99], v[148:151]
    ds_read_b64_tr_b16 v[40:41], v10 offset:49152
    v_mfma_f32_16x16x32_bf16 v[152:155], v[84:87], v[100:103], v[152:155]
    ds_read_b64_tr_b16 v[42:43], v10 offset:49664
    v_mfma_f32_16x16x32_bf16 v[156:159], v[88:91], v[100:103], v[156:159]
    ds_read_b128 v[36:39], v3 offset:49152
    v_mfma_f32_16x16x32_bf16 v[160:163], v[84:87], v[104:107], v[160:163]
    ds_read_b64_tr_b16 v[44:45], v11 offset:49152
    v_mfma_f32_16x16x32_bf16 v[164:167], v[88:91], v[104:107], v[164:167]
    ds_read_b64_tr_b16 v[46:47], v11 offset:49664
    v_mfma_f32_16x16x32_bf16 v[168:171], v[108:111], v[84:87], v[168:171]
    ds_read_b64_tr_b16 v[48:49], v12 offset:49152
    v_mfma_f32_16x16x32_bf16 v[184:187], v[108:111], v[88:91], v[184:187]
    ds_read_b64_tr_b16 v[50:51], v12 offset:49664
    v_mfma_f32_16x16x32_bf16 v[228:231], v[16:19], v[108:111], v[228:231]
    ds_read_b64_tr_b16 v[52:53], v13 offset:49152
    v_mfma_f32_16x16x32_bf16 v[172:175], v[112:115], v[84:87], v[172:175]
    ds_read_b64_tr_b16 v[54:55], v13 offset:49664
    v_mfma_f32_16x16x32_bf16 v[188:191], v[112:115], v[88:91], v[188:191]
    ds_read_b64_tr_b16 v[56:57], v10 offset:57344
    v_mfma_f32_16x16x32_bf16 v[176:179], v[116:119], v[84:87], v[176:179]
    ds_read_b64_tr_b16 v[58:59], v10 offset:57856
    v_mfma_f32_16x16x32_bf16 v[192:195], v[116:119], v[88:91], v[192:195]
    ds_read_b64_tr_b16 v[60:61], v11 offset:57344
    v_mfma_f32_16x16x32_bf16 v[180:183], v[120:123], v[84:87], v[180:183]
    ds_read_b64_tr_b16 v[62:63], v11 offset:57856
    v_mfma_f32_16x16x32_bf16 v[196:199], v[120:123], v[88:91], v[196:199]
    ds_read_b64_tr_b16 v[64:65], v12 offset:57344
    v_mfma_f32_16x16x32_bf16 v[200:203], v[84:87], v[124:127], v[200:203]
    ds_read_b64_tr_b16 v[66:67], v12 offset:57856
    v_mfma_f32_16x16x32_bf16 v[204:207], v[88:91], v[124:127], v[204:207]
    ds_read_b64_tr_b16 v[68:69], v13 offset:57344
    v_mfma_f32_16x16x32_bf16 v[208:211], v[84:87], v[128:131], v[208:211]
    ds_read_b64_tr_b16 v[70:71], v13 offset:57856
    v_mfma_f32_16x16x32_bf16 v[212:215], v[88:91], v[128:131], v[212:215]
    ds_read_b128 v[72:75], v6 offset:18432
    v_mfma_f32_16x16x32_bf16 v[216:219], v[84:87], v[132:135], v[216:219]
    ds_read_b128 v[76:79], v7 offset:20480
    v_mfma_f32_16x16x32_bf16 v[220:223], v[88:91], v[132:135], v[220:223]
    ds_read_b128 v[80:83], v6 offset:22528
    s_waitcnt lgkmcnt(15)
    v_mfma_f32_16x16x32_bf16 v[136:139], v[32:35], v[40:43], v[136:139]
    ds_read_b128 v[84:87], v4 offset:49152
    v_mfma_f32_16x16x32_bf16 v[140:143], v[36:39], v[40:43], v[140:143]
    ds_read_b64_tr_b16 v[92:93], v10 offset:53248
    v_mfma_f32_16x16x32_bf16 v[224:227], v[16:19], v[40:43], v[224:227]
    ds_read_b64_tr_b16 v[94:95], v10 offset:53760
    v_mfma_f32_16x16x32_bf16 v[144:147], v[32:35], v[44:47], v[144:147]
    ds_read_b128 v[88:91], v5 offset:49152
    v_mfma_f32_16x16x32_bf16 v[148:151], v[36:39], v[44:47], v[148:151]
    ds_read_b64_tr_b16 v[96:97], v11 offset:53248
    s_waitcnt lgkmcnt(15)
    v_mfma_f32_16x16x32_bf16 v[152:155], v[32:35], v[48:51], v[152:155]
    ds_read_b64_tr_b16 v[98:99], v11 offset:53760
    v_mfma_f32_16x16x32_bf16 v[156:159], v[36:39], v[48:51], v[156:159]
    ds_read_b64_tr_b16 v[100:101], v12 offset:53248
    v_mfma_f32_16x16x32_bf16 v[160:163], v[32:35], v[52:55], v[160:163]
    ds_read_b64_tr_b16 v[102:103], v12 offset:53760
    v_mfma_f32_16x16x32_bf16 v[164:167], v[36:39], v[52:55], v[164:167]
    ds_read_b64_tr_b16 v[104:105], v13 offset:53248
    s_waitcnt lgkmcnt(15)
    v_mfma_f32_16x16x32_bf16 v[168:171], v[56:59], v[32:35], v[168:171]
    ds_read_b64_tr_b16 v[106:107], v13 offset:53760
    v_mfma_f32_16x16x32_bf16 v[184:187], v[56:59], v[36:39], v[184:187]
    ds_read_b64_tr_b16 v[108:109], v10 offset:61440
    v_mfma_f32_16x16x32_bf16 v[228:231], v[16:19], v[56:59], v[228:231]
    ds_read_b64_tr_b16 v[110:111], v10 offset:61952
    v_mfma_f32_16x16x32_bf16 v[172:175], v[60:63], v[32:35], v[172:175]
    ds_read_b64_tr_b16 v[112:113], v11 offset:61440
    v_mfma_f32_16x16x32_bf16 v[188:191], v[60:63], v[36:39], v[188:191]
    ds_read_b64_tr_b16 v[114:115], v11 offset:61952
    s_waitcnt lgkmcnt(15)
    v_mfma_f32_16x16x32_bf16 v[176:179], v[64:67], v[32:35], v[176:179]
    ds_read_b64_tr_b16 v[116:117], v12 offset:61440
    v_mfma_f32_16x16x32_bf16 v[192:195], v[64:67], v[36:39], v[192:195]
    ds_read_b64_tr_b16 v[118:119], v12 offset:61952
    v_mfma_f32_16x16x32_bf16 v[180:183], v[68:71], v[32:35], v[180:183]
    ds_read_b64_tr_b16 v[120:121], v13 offset:61440
    v_mfma_f32_16x16x32_bf16 v[196:199], v[68:71], v[36:39], v[196:199]
    ds_read_b64_tr_b16 v[122:123], v13 offset:61952
    v_mfma_f32_16x16x32_bf16 v[200:203], v[32:35], v[72:75], v[200:203]
    ds_read_b128 v[124:127], v8 offset:18432
    v_mfma_f32_16x16x32_bf16 v[204:207], v[36:39], v[72:75], v[204:207]
    ds_read_b128 v[128:131], v9 offset:20480
    v_mfma_f32_16x16x32_bf16 v[208:211], v[32:35], v[76:79], v[208:211]
    ds_read_b128 v[132:135], v8 offset:22528
    v_mfma_f32_16x16x32_bf16 v[212:215], v[36:39], v[76:79], v[212:215]
    s_waitcnt lgkmcnt(15)
    v_mfma_f32_16x16x32_bf16 v[216:219], v[32:35], v[80:83], v[216:219]
    v_mfma_f32_16x16x32_bf16 v[220:223], v[36:39], v[80:83], v[220:223]
    v_mfma_f32_16x16x32_bf16 v[136:139], v[84:87], v[92:95], v[136:139]
    v_mfma_f32_16x16x32_bf16 v[140:143], v[88:91], v[92:95], v[140:143]
    v_mfma_f32_16x16x32_bf16 v[224:227], v[16:19], v[92:95], v[224:227]
    v_mfma_f32_16x16x32_bf16 v[144:147], v[84:87], v[96:99], v[144:147]
    v_mfma_f32_16x16x32_bf16 v[148:151], v[88:91], v[96:99], v[148:151]
    s_waitcnt lgkmcnt(13)
    v_mfma_f32_16x16x32_bf16 v[152:155], v[84:87], v[100:103], v[152:155]
    v_mfma_f32_16x16x32_bf16 v[156:159], v[88:91], v[100:103], v[156:159]
    s_waitcnt lgkmcnt(11)
    v_mfma_f32_16x16x32_bf16 v[160:163], v[84:87], v[104:107], v[160:163]
    v_mfma_f32_16x16x32_bf16 v[164:167], v[88:91], v[104:107], v[164:167]
    s_waitcnt lgkmcnt(9)
    v_mfma_f32_16x16x32_bf16 v[168:171], v[108:111], v[84:87], v[168:171]
    v_mfma_f32_16x16x32_bf16 v[184:187], v[108:111], v[88:91], v[184:187]
    v_mfma_f32_16x16x32_bf16 v[228:231], v[16:19], v[108:111], v[228:231]
    s_waitcnt lgkmcnt(7)
    v_mfma_f32_16x16x32_bf16 v[172:175], v[112:115], v[84:87], v[172:175]
    v_mfma_f32_16x16x32_bf16 v[188:191], v[112:115], v[88:91], v[188:191]
    s_waitcnt lgkmcnt(5)
    v_mfma_f32_16x16x32_bf16 v[176:179], v[116:119], v[84:87], v[176:179]
    v_mfma_f32_16x16x32_bf16 v[192:195], v[116:119], v[88:91], v[192:195]
    s_waitcnt lgkmcnt(3)
    v_mfma_f32_16x16x32_bf16 v[180:183], v[120:123], v[84:87], v[180:183]
    v_mfma_f32_16x16x32_bf16 v[196:199], v[120:123], v[88:91], v[196:199]
    s_waitcnt lgkmcnt(2)
    v_mfma_f32_16x16x32_bf16 v[200:203], v[84:87], v[124:127], v[200:203]
    v_mfma_f32_16x16x32_bf16 v[204:207], v[88:91], v[124:127], v[204:207]
    s_waitcnt lgkmcnt(1)
    v_mfma_f32_16x16x32_bf16 v[208:211], v[84:87], v[128:131], v[208:211]
    v_mfma_f32_16x16x32_bf16 v[212:215], v[88:91], v[128:131], v[212:215]
    s_waitcnt lgkmcnt(0)
    v_mfma_f32_16x16x32_bf16 v[216:219], v[84:87], v[132:135], v[216:219]
    v_mfma_f32_16x16x32_bf16 v[220:223], v[88:91], v[132:135], v[220:223]
    s_lshl_b32 s3, s19, 7
    s_add_u32 s3, s3, 155648
    v_lshl_add_u32 v28, v27, 5, s3
    v_lshlrev_b32 v25, 2, v26
    s_lshl_b32 s18, s19, 6
    s_add_u32 s18, s18, 157696
    v_add_u32 v24, s18, v25
    v_lshl_add_u32 v23, v27, 4, s18
    v_lshrrev_b32 v22, 2, v26
    v_and_b32 v21, 3, v26
    v_lshl_add_u32 v22, v22, 3, v21
    v_lshl_add_u32 v22, v22, 2, s3
    v_mov_b32 v30, 0xbdd2d3e8
    v_mov_b32 v31, 0xc0135761
    ds_write_b32 v24, v224
    ds_write_b32 v24, v228 offset:256
    s_lshl_b32 s48, s60, 2
    s_add_u32 s48, s48, s19
    s_lshl_b32 s49, s48, 13
    s_mul_i32 s50, s62, 2097152
    s_add_u32 s50, s50, s49
    s_add_u32 s50, s50, 2097152
    s_waitcnt lgkmcnt(0)
    s_barrier
    ds_read_b128 v[32:35], v28 offset:0
    ds_read_b128 v[40:43], v28 offset:512
    ds_read_b128 v[36:39], v28 offset:16
    ds_read_b128 v[44:47], v28 offset:528
    v_add_u32 v25, 156672, v25
    ds_read_b32 v56, v25 offset:0
    ds_read_b32 v58, v25 offset:64
    ds_read_b32 v60, v25 offset:128
    v_xor_b32 v21, 0, v24
    ds_read_b32 v48, v21
    v_xor_b32 v21, 64, v24
    ds_read_b32 v50, v21
    v_xor_b32 v21, 128, v24
    ds_read_b32 v52, v21
    v_xor_b32 v21, 192, v24
    ds_read_b32 v54, v21
    ds_read2_b32 v[80:81], v22 offset0:0 offset1:128
    ds_read2_b32 v[82:83], v22 offset0:4 offset1:132
    v_xor_b32 v21, 0, v23
    ds_read_b128 v[84:87], v21 offset:256
    v_xor_b32 v21, 64, v23
    ds_read_b128 v[88:91], v21 offset:256
    v_xor_b32 v21, 128, v23
    ds_read_b128 v[92:95], v21 offset:256
    v_xor_b32 v21, 192, v23
    ds_read_b128 v[96:99], v21 offset:256
    s_mov_b32 s94, 0xaaaaaaaa
    s_mov_b32 s95, 0xaaaaaaaa
    s_mov_b32 s96, 0xcccccccc
    s_mov_b32 s97, 0xcccccccc
    s_waitcnt lgkmcnt(10)
    s_lshl_b32 s3, s62, 31
    v_xor_b32 v116, s3, v32
    v_xor_b32 v117, s3, v33
    v_xor_b32 v118, s3, v34
    v_xor_b32 v119, s3, v35
    v_xor_b32 v120, s3, v36
    v_xor_b32 v121, s3, v37
    v_xor_b32 v122, s3, v38
    v_xor_b32 v123, s3, v39
    s_add_u32 s3, s63, 0
    s_lshr_b32 s18, s3, 3
    s_lshl_b32 s18, s18, 19
    s_and_b32 s3, s3, 7
    s_lshl_b32 s3, s3, 10
    s_add_u32 s3, s3, s18
    s_add_u32 s3, s3, s50
    v_pk_fma_f32 v[200:201], v[40:41], v[56:57], v[200:201] op_sel_hi:[1,0,1] neg_lo:[0,1,0] neg_hi:[0,1,0]
    v_pk_fma_f32 v[202:203], v[42:43], v[56:57], v[202:203] op_sel_hi:[1,0,1] neg_lo:[0,1,0] neg_hi:[0,1,0]
    v_pk_fma_f32 v[204:205], v[44:45], v[56:57], v[204:205] op_sel_hi:[1,0,1] neg_lo:[0,1,0] neg_hi:[0,1,0]
    v_pk_fma_f32 v[206:207], v[46:47], v[56:57], v[206:207] op_sel_hi:[1,0,1] neg_lo:[0,1,0] neg_hi:[0,1,0]
    v_pk_mul_f32 v[200:201], v[200:201], v[116:117]
    v_pk_mul_f32 v[202:203], v[202:203], v[118:119]
    v_pk_mul_f32 v[204:205], v[204:205], v[120:121]
    v_pk_mul_f32 v[206:207], v[206:207], v[122:123]
    v_cvt_pk_bf16_f32 v200, v200, v201
    v_cvt_pk_bf16_f32 v201, v202, v203
    v_cvt_pk_bf16_f32 v202, v204, v205
    v_cvt_pk_bf16_f32 v203, v206, v207
    buffer_store_dwordx4 v[200:203], v14, s[32:35], s3 offen sc1
    s_add_u32 s3, s63, 1
    s_lshr_b32 s18, s3, 3
    s_lshl_b32 s18, s18, 19
    s_and_b32 s3, s3, 7
    s_lshl_b32 s3, s3, 10
    s_add_u32 s3, s3, s18
    s_add_u32 s3, s3, s50
    v_pk_fma_f32 v[208:209], v[40:41], v[58:59], v[208:209] op_sel_hi:[1,0,1] neg_lo:[0,1,0] neg_hi:[0,1,0]
    v_pk_fma_f32 v[210:211], v[42:43], v[58:59], v[210:211] op_sel_hi:[1,0,1] neg_lo:[0,1,0] neg_hi:[0,1,0]
    v_pk_fma_f32 v[212:213], v[44:45], v[58:59], v[212:213] op_sel_hi:[1,0,1] neg_lo:[0,1,0] neg_hi:[0,1,0]
    v_pk_fma_f32 v[214:215], v[46:47], v[58:59], v[214:215] op_sel_hi:[1,0,1] neg_lo:[0,1,0] neg_hi:[0,1,0]
    v_pk_mul_f32 v[208:209], v[208:209], v[116:117]
    v_pk_mul_f32 v[210:211], v[210:211], v[118:119]
    v_pk_mul_f32 v[212:213], v[212:213], v[120:121]
    v_pk_mul_f32 v[214:215], v[214:215], v[122:123]
    v_cvt_pk_bf16_f32 v208, v208, v209
    v_cvt_pk_bf16_f32 v209, v210, v211
    v_cvt_pk_bf16_f32 v210, v212, v213
    v_cvt_pk_bf16_f32 v211, v214, v215
    buffer_store_dwordx4 v[208:211], v14, s[32:35], s3 offen sc1
    s_add_u32 s3, s63, 2
    s_lshr_b32 s18, s3, 3
    s_lshl_b32 s18, s18, 19
    s_and_b32 s3, s3, 7
    s_lshl_b32 s3, s3, 10
    s_add_u32 s3, s3, s18
    s_add_u32 s3, s3, s50
    v_pk_fma_f32 v[216:217], v[40:41], v[60:61], v[216:217] op_sel_hi:[1,0,1] neg_lo:[0,1,0] neg_hi:[0,1,0]
    v_pk_fma_f32 v[218:219], v[42:43], v[60:61], v[218:219] op_sel_hi:[1,0,1] neg_lo:[0,1,0] neg_hi:[0,1,0]
    v_pk_fma_f32 v[220:221], v[44:45], v[60:61], v[220:221] op_sel_hi:[1,0,1] neg_lo:[0,1,0] neg_hi:[0,1,0]
    v_pk_fma_f32 v[222:223], v[46:47], v[60:61], v[222:223] op_sel_hi:[1,0,1] neg_lo:[0,1,0] neg_hi:[0,1,0]
    v_pk_mul_f32 v[216:217], v[216:217], v[116:117]
    v_pk_mul_f32 v[218:219], v[218:219], v[118:119]
    v_pk_mul_f32 v[220:221], v[220:221], v[120:121]
    v_pk_mul_f32 v[222:223], v[222:223], v[122:123]
    v_cvt_pk_bf16_f32 v216, v216, v217
    v_cvt_pk_bf16_f32 v217, v218, v219
    v_cvt_pk_bf16_f32 v218, v220, v221
    v_cvt_pk_bf16_f32 v219, v222, v223
    buffer_store_dwordx4 v[216:219], v14, s[32:35], s3 offen sc1
    s_waitcnt lgkmcnt(6)
    v_pk_fma_f32 v[136:137], v[40:41], v[48:49], v[136:137] op_sel_hi:[1,0,1] neg_lo:[0,1,0] neg_hi:[0,1,0]
    v_pk_fma_f32 v[138:139], v[42:43], v[48:49], v[138:139] op_sel_hi:[1,0,1] neg_lo:[0,1,0] neg_hi:[0,1,0]
    v_pk_fma_f32 v[140:141], v[44:45], v[48:49], v[140:141] op_sel_hi:[1,0,1] neg_lo:[0,1,0] neg_hi:[0,1,0]
    v_pk_fma_f32 v[142:143], v[46:47], v[48:49], v[142:143] op_sel_hi:[1,0,1] neg_lo:[0,1,0] neg_hi:[0,1,0]
    v_pk_mul_f32 v[136:137], v[136:137], v[32:33]
    v_pk_mul_f32 v[138:139], v[138:139], v[34:35]
    v_pk_mul_f32 v[140:141], v[140:141], v[36:37]
    v_pk_mul_f32 v[142:143], v[142:143], v[38:39]
    v_pk_mul_f32 v[100:101], v[136:137], v[136:137]
    v_pk_mul_f32 v[102:103], v[138:139], v[138:139]
    v_pk_mul_f32 v[104:105], v[140:141], v[140:141]
    v_pk_mul_f32 v[106:107], v[142:143], v[142:143]
    v_pk_fma_f32 v[100:101], v[100:101], v[30:31], v[30:31] op_sel:[0,0,1] op_sel_hi:[1,0,1]
    v_pk_fma_f32 v[102:103], v[102:103], v[30:31], v[30:31] op_sel:[0,0,1] op_sel_hi:[1,0,1]
    v_pk_fma_f32 v[104:105], v[104:105], v[30:31], v[30:31] op_sel:[0,0,1] op_sel_hi:[1,0,1]
    v_pk_fma_f32 v[106:107], v[106:107], v[30:31], v[30:31] op_sel:[0,0,1] op_sel_hi:[1,0,1]
    v_pk_mul_f32 v[100:101], v[100:101], v[136:137]
    v_pk_mul_f32 v[102:103], v[102:103], v[138:139]
    v_pk_mul_f32 v[104:105], v[104:105], v[140:141]
    v_pk_mul_f32 v[106:107], v[106:107], v[142:143]
    v_exp_f32 v100, v100
    v_exp_f32 v101, v101
    v_exp_f32 v102, v102
    v_exp_f32 v103, v103
    v_exp_f32 v104, v104
    v_exp_f32 v105, v105
    v_exp_f32 v106, v106
    v_exp_f32 v107, v107
    v_pk_add_f32 v[100:101], v[100:101], 1.0 op_sel_hi:[1,0]
    v_pk_add_f32 v[102:103], v[102:103], 1.0 op_sel_hi:[1,0]
    v_pk_add_f32 v[104:105], v[104:105], 1.0 op_sel_hi:[1,0]
    v_pk_add_f32 v[106:107], v[106:107], 1.0 op_sel_hi:[1,0]
    v_rcp_f32 v100, v100
    v_rcp_f32 v101, v101
    v_rcp_f32 v102, v102
    v_rcp_f32 v103, v103
    v_rcp_f32 v104, v104
    v_rcp_f32 v105, v105
    v_rcp_f32 v106, v106
    v_rcp_f32 v107, v107
    v_pk_mul_f32 v[136:137], v[100:101], v[136:137]
    v_pk_mul_f32 v[138:139], v[102:103], v[138:139]
    v_pk_mul_f32 v[140:141], v[104:105], v[140:141]
    v_pk_mul_f32 v[142:143], v[106:107], v[142:143]
    v_pk_mul_f32 v[124:125], v[136:137], v[136:137]
    v_pk_mul_f32 v[126:127], v[138:139], v[138:139]
    v_pk_mul_f32 v[128:129], v[140:141], v[140:141]
    v_pk_mul_f32 v[130:131], v[142:143], v[142:143]
    v_pk_fma_f32 v[144:145], v[40:41], v[50:51], v[144:145] op_sel_hi:[1,0,1] neg_lo:[0,1,0] neg_hi:[0,1,0]
    v_pk_fma_f32 v[146:147], v[42:43], v[50:51], v[146:147] op_sel_hi:[1,0,1] neg_lo:[0,1,0] neg_hi:[0,1,0]
    v_pk_fma_f32 v[148:149], v[44:45], v[50:51], v[148:149] op_sel_hi:[1,0,1] neg_lo:[0,1,0] neg_hi:[0,1,0]
    v_pk_fma_f32 v[150:151], v[46:47], v[50:51], v[150:151] op_sel_hi:[1,0,1] neg_lo:[0,1,0] neg_hi:[0,1,0]
    v_pk_mul_f32 v[144:145], v[144:145], v[32:33]
    v_pk_mul_f32 v[146:147], v[146:147], v[34:35]
    v_pk_mul_f32 v[148:149], v[148:149], v[36:37]
    v_pk_mul_f32 v[150:151], v[150:151], v[38:39]
    v_pk_mul_f32 v[108:109], v[144:145], v[144:145]
    v_pk_mul_f32 v[110:111], v[146:147], v[146:147]
    v_pk_mul_f32 v[112:113], v[148:149], v[148:149]
    v_pk_mul_f32 v[114:115], v[150:151], v[150:151]
    v_pk_fma_f32 v[108:109], v[108:109], v[30:31], v[30:31] op_sel:[0,0,1] op_sel_hi:[1,0,1]
    v_pk_fma_f32 v[110:111], v[110:111], v[30:31], v[30:31] op_sel:[0,0,1] op_sel_hi:[1,0,1]
    v_pk_fma_f32 v[112:113], v[112:113], v[30:31], v[30:31] op_sel:[0,0,1] op_sel_hi:[1,0,1]
    v_pk_fma_f32 v[114:115], v[114:115], v[30:31], v[30:31] op_sel:[0,0,1] op_sel_hi:[1,0,1]
    v_pk_mul_f32 v[108:109], v[108:109], v[144:145]
    v_pk_mul_f32 v[110:111], v[110:111], v[146:147]
    v_pk_mul_f32 v[112:113], v[112:113], v[148:149]
    v_pk_mul_f32 v[114:115], v[114:115], v[150:151]
    v_exp_f32 v108, v108
    v_exp_f32 v109, v109
    v_exp_f32 v110, v110
    v_exp_f32 v111, v111
    v_exp_f32 v112, v112
    v_exp_f32 v113, v113
    v_exp_f32 v114, v114
    v_exp_f32 v115, v115
    v_pk_add_f32 v[108:109], v[108:109], 1.0 op_sel_hi:[1,0]
    v_pk_add_f32 v[110:111], v[110:111], 1.0 op_sel_hi:[1,0]
    v_pk_add_f32 v[112:113], v[112:113], 1.0 op_sel_hi:[1,0]
    v_pk_add_f32 v[114:115], v[114:115], 1.0 op_sel_hi:[1,0]
    v_rcp_f32 v108, v108
    v_rcp_f32 v109, v109
    v_rcp_f32 v110, v110
    v_rcp_f32 v111, v111
    v_rcp_f32 v112, v112
    v_rcp_f32 v113, v113
    v_rcp_f32 v114, v114
    v_rcp_f32 v115, v115
    v_pk_mul_f32 v[144:145], v[108:109], v[144:145]
    v_pk_mul_f32 v[146:147], v[110:111], v[146:147]
    v_pk_mul_f32 v[148:149], v[112:113], v[148:149]
    v_pk_mul_f32 v[150:151], v[114:115], v[150:151]
    v_pk_fma_f32 v[124:125], v[144:145], v[144:145], v[124:125]
    v_pk_add_f32 v[116:117], v[136:137], v[144:145]
    v_pk_fma_f32 v[126:127], v[146:147], v[146:147], v[126:127]
    v_pk_add_f32 v[118:119], v[138:139], v[146:147]
    v_pk_fma_f32 v[128:129], v[148:149], v[148:149], v[128:129]
    v_pk_add_f32 v[120:121], v[140:141], v[148:149]
    v_pk_fma_f32 v[130:131], v[150:151], v[150:151], v[130:131]
    v_pk_add_f32 v[122:123], v[142:143], v[150:151]
    v_pk_fma_f32 v[152:153], v[40:41], v[52:53], v[152:153] op_sel_hi:[1,0,1] neg_lo:[0,1,0] neg_hi:[0,1,0]
    v_pk_fma_f32 v[154:155], v[42:43], v[52:53], v[154:155] op_sel_hi:[1,0,1] neg_lo:[0,1,0] neg_hi:[0,1,0]
    v_pk_fma_f32 v[156:157], v[44:45], v[52:53], v[156:157] op_sel_hi:[1,0,1] neg_lo:[0,1,0] neg_hi:[0,1,0]
    v_pk_fma_f32 v[158:159], v[46:47], v[52:53], v[158:159] op_sel_hi:[1,0,1] neg_lo:[0,1,0] neg_hi:[0,1,0]
    v_pk_mul_f32 v[152:153], v[152:153], v[32:33]
    v_pk_mul_f32 v[154:155], v[154:155], v[34:35]
    v_pk_mul_f32 v[156:157], v[156:157], v[36:37]
    v_pk_mul_f32 v[158:159], v[158:159], v[38:39]
    v_pk_mul_f32 v[100:101], v[152:153], v[152:153]
    v_pk_mul_f32 v[102:103], v[154:155], v[154:155]
    v_pk_mul_f32 v[104:105], v[156:157], v[156:157]
    v_pk_mul_f32 v[106:107], v[158:159], v[158:159]
    v_pk_fma_f32 v[100:101], v[100:101], v[30:31], v[30:31] op_sel:[0,0,1] op_sel_hi:[1,0,1]
    v_pk_fma_f32 v[102:103], v[102:103], v[30:31], v[30:31] op_sel:[0,0,1] op_sel_hi:[1,0,1]
    v_pk_fma_f32 v[104:105], v[104:105], v[30:31], v[30:31] op_sel:[0,0,1] op_sel_hi:[1,0,1]
    v_pk_fma_f32 v[106:107], v[106:107], v[30:31], v[30:31] op_sel:[0,0,1] op_sel_hi:[1,0,1]
    v_pk_mul_f32 v[100:101], v[100:101], v[152:153]
    v_pk_mul_f32 v[102:103], v[102:103], v[154:155]
    v_pk_mul_f32 v[104:105], v[104:105], v[156:157]
    v_pk_mul_f32 v[106:107], v[106:107], v[158:159]
    v_exp_f32 v100, v100
    v_exp_f32 v101, v101
    v_exp_f32 v102, v102
    v_exp_f32 v103, v103
    v_exp_f32 v104, v104
    v_exp_f32 v105, v105
    v_exp_f32 v106, v106
    v_exp_f32 v107, v107
    v_pk_add_f32 v[100:101], v[100:101], 1.0 op_sel_hi:[1,0]
    v_pk_add_f32 v[102:103], v[102:103], 1.0 op_sel_hi:[1,0]
    v_pk_add_f32 v[104:105], v[104:105], 1.0 op_sel_hi:[1,0]
    v_pk_add_f32 v[106:107], v[106:107], 1.0 op_sel_hi:[1,0]
    v_rcp_f32 v100, v100
    v_rcp_f32 v101, v101
    v_rcp_f32 v102, v102
    v_rcp_f32 v103, v103
    v_rcp_f32 v104, v104
    v_rcp_f32 v105, v105
    v_rcp_f32 v106, v106
    v_rcp_f32 v107, v107
    v_pk_mul_f32 v[152:153], v[100:101], v[152:153]
    v_pk_mul_f32 v[154:155], v[102:103], v[154:155]
    v_pk_mul_f32 v[156:157], v[104:105], v[156:157]
    v_pk_mul_f32 v[158:159], v[106:107], v[158:159]
    v_pk_fma_f32 v[124:125], v[152:153], v[152:153], v[124:125]
    v_pk_add_f32 v[116:117], v[116:117], v[152:153]
    v_pk_fma_f32 v[126:127], v[154:155], v[154:155], v[126:127]
    v_pk_add_f32 v[118:119], v[118:119], v[154:155]
    v_pk_fma_f32 v[128:129], v[156:157], v[156:157], v[128:129]
    v_pk_add_f32 v[120:121], v[120:121], v[156:157]
    v_pk_fma_f32 v[130:131], v[158:159], v[158:159], v[130:131]
    v_pk_add_f32 v[122:123], v[122:123], v[158:159]
    v_pk_fma_f32 v[160:161], v[40:41], v[54:55], v[160:161] op_sel_hi:[1,0,1] neg_lo:[0,1,0] neg_hi:[0,1,0]
    v_pk_fma_f32 v[162:163], v[42:43], v[54:55], v[162:163] op_sel_hi:[1,0,1] neg_lo:[0,1,0] neg_hi:[0,1,0]
    v_pk_fma_f32 v[164:165], v[44:45], v[54:55], v[164:165] op_sel_hi:[1,0,1] neg_lo:[0,1,0] neg_hi:[0,1,0]
    v_pk_fma_f32 v[166:167], v[46:47], v[54:55], v[166:167] op_sel_hi:[1,0,1] neg_lo:[0,1,0] neg_hi:[0,1,0]
    v_pk_mul_f32 v[160:161], v[160:161], v[32:33]
    v_pk_mul_f32 v[162:163], v[162:163], v[34:35]
    v_pk_mul_f32 v[164:165], v[164:165], v[36:37]
    v_pk_mul_f32 v[166:167], v[166:167], v[38:39]
    v_pk_mul_f32 v[108:109], v[160:161], v[160:161]
    v_pk_mul_f32 v[110:111], v[162:163], v[162:163]
    v_pk_mul_f32 v[112:113], v[164:165], v[164:165]
    v_pk_mul_f32 v[114:115], v[166:167], v[166:167]
    v_pk_fma_f32 v[108:109], v[108:109], v[30:31], v[30:31] op_sel:[0,0,1] op_sel_hi:[1,0,1]
    v_pk_fma_f32 v[110:111], v[110:111], v[30:31], v[30:31] op_sel:[0,0,1] op_sel_hi:[1,0,1]
    v_pk_fma_f32 v[112:113], v[112:113], v[30:31], v[30:31] op_sel:[0,0,1] op_sel_hi:[1,0,1]
    v_pk_fma_f32 v[114:115], v[114:115], v[30:31], v[30:31] op_sel:[0,0,1] op_sel_hi:[1,0,1]
    v_pk_mul_f32 v[108:109], v[108:109], v[160:161]
    v_pk_mul_f32 v[110:111], v[110:111], v[162:163]
    v_pk_mul_f32 v[112:113], v[112:113], v[164:165]
    v_pk_mul_f32 v[114:115], v[114:115], v[166:167]
    v_exp_f32 v108, v108
    v_exp_f32 v109, v109
    v_exp_f32 v110, v110
    v_exp_f32 v111, v111
    v_exp_f32 v112, v112
    v_exp_f32 v113, v113
    v_exp_f32 v114, v114
    v_exp_f32 v115, v115
    v_pk_add_f32 v[108:109], v[108:109], 1.0 op_sel_hi:[1,0]
    v_pk_add_f32 v[110:111], v[110:111], 1.0 op_sel_hi:[1,0]
    v_pk_add_f32 v[112:113], v[112:113], 1.0 op_sel_hi:[1,0]
    v_pk_add_f32 v[114:115], v[114:115], 1.0 op_sel_hi:[1,0]
    v_rcp_f32 v108, v108
    v_rcp_f32 v109, v109
    v_rcp_f32 v110, v110
    v_rcp_f32 v111, v111
    v_rcp_f32 v112, v112
    v_rcp_f32 v113, v113
    v_rcp_f32 v114, v114
    v_rcp_f32 v115, v115
    v_pk_mul_f32 v[160:161], v[108:109], v[160:161]
    v_pk_mul_f32 v[162:163], v[110:111], v[162:163]
    v_pk_mul_f32 v[164:165], v[112:113], v[164:165]
    v_pk_mul_f32 v[166:167], v[114:115], v[166:167]
    v_pk_fma_f32 v[124:125], v[160:161], v[160:161], v[124:125]
    v_pk_add_f32 v[116:117], v[116:117], v[160:161]
    v_pk_fma_f32 v[126:127], v[162:163], v[162:163], v[126:127]
    v_pk_add_f32 v[118:119], v[118:119], v[162:163]
    v_pk_fma_f32 v[128:129], v[164:165], v[164:165], v[128:129]
    v_pk_add_f32 v[120:121], v[120:121], v[164:165]
    v_pk_fma_f32 v[130:131], v[166:167], v[166:167], v[130:131]
    v_pk_add_f32 v[122:123], v[122:123], v[166:167]
    s_nop 1
    v_add_f32_dpp v116, v116, v116 row_ror:8 row_mask:0xf bank_mask:0x3
    v_add_f32_dpp v117, v117, v117 row_ror:8 row_mask:0xf bank_mask:0x3
    v_add_f32_dpp v118, v118, v118 row_ror:8 row_mask:0xf bank_mask:0x3
    v_add_f32_dpp v119, v119, v119 row_ror:8 row_mask:0xf bank_mask:0x3
    v_add_f32_dpp v120, v120, v120 row_ror:8 row_mask:0xf bank_mask:0x3
    v_add_f32_dpp v121, v121, v121 row_ror:8 row_mask:0xf bank_mask:0x3
    v_add_f32_dpp v122, v122, v122 row_ror:8 row_mask:0xf bank_mask:0x3
    v_add_f32_dpp v123, v123, v123 row_ror:8 row_mask:0xf bank_mask:0x3
    v_add_f32_dpp v116, v124, v124 row_ror:8 row_mask:0xf bank_mask:0xc
    v_add_f32_dpp v117, v125, v125 row_ror:8 row_mask:0xf bank_mask:0xc
    v_add_f32_dpp v118, v126, v126 row_ror:8 row_mask:0xf bank_mask:0xc
    v_add_f32_dpp v119, v127, v127 row_ror:8 row_mask:0xf bank_mask:0xc
    v_add_f32_dpp v120, v128, v128 row_ror:8 row_mask:0xf bank_mask:0xc
    v_add_f32_dpp v121, v129, v129 row_ror:8 row_mask:0xf bank_mask:0xc
    v_add_f32_dpp v122, v130, v130 row_ror:8 row_mask:0xf bank_mask:0xc
    v_add_f32_dpp v123, v131, v131 row_ror:8 row_mask:0xf bank_mask:0xc
    v_add_f32_dpp v116, v116, v116 row_half_mirror row_mask:0xf bank_mask:0x5
    v_add_f32_dpp v117, v117, v117 row_half_mirror row_mask:0xf bank_mask:0x5
    v_add_f32_dpp v118, v118, v118 row_half_mirror row_mask:0xf bank_mask:0x5
    v_add_f32_dpp v119, v119, v119 row_half_mirror row_mask:0xf bank_mask:0x5
    v_add_f32_dpp v116, v120, v120 row_half_mirror row_mask:0xf bank_mask:0xa
    v_add_f32_dpp v117, v121, v121 row_half_mirror row_mask:0xf bank_mask:0xa
    v_add_f32_dpp v118, v122, v122 row_half_mirror row_mask:0xf bank_mask:0xa
    v_add_f32_dpp v119, v123, v123 row_half_mirror row_mask:0xf bank_mask:0xa
    v_add_f32_dpp v116, v116, v116 quad_perm:[1,0,3,2] row_mask:0xf bank_mask:0xf
    v_add_f32_dpp v117, v117, v117 quad_perm:[1,0,3,2] row_mask:0xf bank_mask:0xf
    v_add_f32_dpp v118, v118, v118 quad_perm:[1,0,3,2] row_mask:0xf bank_mask:0xf
    v_add_f32_dpp v119, v119, v119 quad_perm:[1,0,3,2] row_mask:0xf bank_mask:0xf
    v_add_f32_dpp v116, v116, v116 quad_perm:[2,3,0,1] row_mask:0xf bank_mask:0xf
    v_add_f32_dpp v117, v117, v117 quad_perm:[2,3,0,1] row_mask:0xf bank_mask:0xf
    v_add_f32_dpp v118, v118, v118 quad_perm:[2,3,0,1] row_mask:0xf bank_mask:0xf
    v_add_f32_dpp v119, v119, v119 quad_perm:[2,3,0,1] row_mask:0xf bank_mask:0xf
    v_cndmask_b32 v116, v116, v117, s[94:95]
    v_cndmask_b32 v118, v118, v119, s[94:95]
    v_cndmask_b32 v116, v116, v118, s[96:97]
    v_lshlrev_b32 v28, 2, v1
    s_lshl_b32 s3, s19, 8
    v_or_b32 v116, 1, v116
    v_add_u32 v28, s3, v28
    buffer_store_dword v116, v28, s[32:35], s69 offen sc1
    s_waitcnt lgkmcnt(0)
    s_waitcnt vmcnt(1)
    s_mov_b64 exec, 1
    buffer_store_dword v16, v253, s[32:35], 0 offen offset:128 sc1
    s_mov_b64 exec, -1
    s_mul_i32 s52, s48, 56
    s_lshl_b32 s3, s61, 1
    s_add_u32 s52, s52, s3
    s_lshr_b32 s3, s19, 1
    s_add_u32 s53, s52, s3
    s_xor_b32 s3, s3, 1
    s_add_u32 s54, s52, s3
    s_lshl_b32 s53, s53, 10
    s_lshl_b32 s54, s54, 10
    s_add_u32 s53, s53, 6291456
    s_add_u32 s54, s54, 6291456
    v_add_u32 v22, 28672, v14
    s_lshl_b32 s56, s60, 14
    s_add_u32 s56, s56, 28311552
    s_add_u32 s57, s56, 4096
    s_add_u32 s58, s56, 8192
    s_add_u32 s59, s56, 12288
    v_mov_b32 v232, 0
    v_mov_b32 v233, 0
    v_mov_b32 v234, 0
    v_mov_b32 v235, 0
    v_mov_b32 v236, 0
    v_mov_b32 v237, 0
    v_mov_b32 v238, 0
    v_mov_b32 v239, 0
    v_mov_b32 v240, 0
    v_mov_b32 v241, 0
    v_mov_b32 v242, 0
    v_mov_b32 v243, 0
    v_mov_b32 v244, 0
    v_mov_b32 v245, 0
    s_lshr_b32 s52, s61, 1
    s_lshl_b32 s52, s52, 19
    s_and_b32 s3, s61, 1
    s_lshl_b32 s3, s3, 12
    s_add_u32 s52, s52, s3
    s_add_u32 s52, s52, s49
    s_add_u32 s52, s52, 14680064
    s_mov_b32 s18, 131072
    s_and_b32 s3, s19, 1
    s_cmp_eq_u32 s3, 0
    v_pk_fma_f32 v[168:169], v[84:85], v[80:81], v[168:169] op_sel:[0,1,0] op_sel_hi:[1,1,1] neg_lo:[0,1,0] neg_hi:[0,1,0]
    v_pk_fma_f32 v[170:171], v[86:87], v[80:81], v[170:171] op_sel:[0,1,0] op_sel_hi:[1,1,1] neg_lo:[0,1,0] neg_hi:[0,1,0]
    v_pk_fma_f32 v[172:173], v[88:89], v[80:81], v[172:173] op_sel:[0,1,0] op_sel_hi:[1,1,1] neg_lo:[0,1,0] neg_hi:[0,1,0]
    v_pk_fma_f32 v[174:175], v[90:91], v[80:81], v[174:175] op_sel:[0,1,0] op_sel_hi:[1,1,1] neg_lo:[0,1,0] neg_hi:[0,1,0]
    v_pk_mul_f32 v[168:169], v[168:169], v[80:81] op_sel_hi:[1,0]
    v_pk_mul_f32 v[170:171], v[170:171], v[80:81] op_sel_hi:[1,0]
    v_pk_mul_f32 v[172:173], v[172:173], v[80:81] op_sel_hi:[1,0]
    v_pk_mul_f32 v[174:175], v[174:175], v[80:81] op_sel_hi:[1,0]
    v_pk_mul_f32 v[100:101], v[168:169], v[168:169]
    v_pk_mul_f32 v[102:103], v[170:171], v[170:171]
    v_pk_mul_f32 v[104:105], v[172:173], v[172:173]
    v_pk_mul_f32 v[106:107], v[174:175], v[174:175]
    v_pk_fma_f32 v[100:101], v[100:101], v[30:31], v[30:31] op_sel:[0,0,1] op_sel_hi:[1,0,1]
    v_pk_fma_f32 v[102:103], v[102:103], v[30:31], v[30:31] op_sel:[0,0,1] op_sel_hi:[1,0,1]
    v_pk_fma_f32 v[104:105], v[104:105], v[30:31], v[30:31] op_sel:[0,0,1] op_sel_hi:[1,0,1]
    v_pk_fma_f32 v[106:107], v[106:107], v[30:31], v[30:31] op_sel:[0,0,1] op_sel_hi:[1,0,1]
    v_pk_mul_f32 v[100:101], v[100:101], v[168:169]
    v_pk_mul_f32 v[102:103], v[102:103], v[170:171]
    v_pk_mul_f32 v[104:105], v[104:105], v[172:173]
    v_pk_mul_f32 v[106:107], v[106:107], v[174:175]
    v_exp_f32 v100, v100
    v_exp_f32 v101, v101
    v_exp_f32 v102, v102
    v_exp_f32 v103, v103
    v_exp_f32 v104, v104
    v_exp_f32 v105, v105
    v_exp_f32 v106, v106
    v_exp_f32 v107, v107
    v_pk_add_f32 v[100:101], v[100:101], 1.0 op_sel_hi:[1,0]
    v_pk_add_f32 v[102:103], v[102:103], 1.0 op_sel_hi:[1,0]
    v_pk_add_f32 v[104:105], v[104:105], 1.0 op_sel_hi:[1,0]
    v_pk_add_f32 v[106:107], v[106:107], 1.0 op_sel_hi:[1,0]
    v_rcp_f32 v100, v100
    v_rcp_f32 v101, v101
    v_rcp_f32 v102, v102
    v_rcp_f32 v103, v103
    v_rcp_f32 v104, v104
    v_rcp_f32 v105, v105
    v_rcp_f32 v106, v106
    v_rcp_f32 v107, v107
    v_pk_mul_f32 v[168:169], v[100:101], v[168:169]
    v_pk_mul_f32 v[170:171], v[102:103], v[170:171]
    v_pk_mul_f32 v[172:173], v[104:105], v[172:173]
    v_pk_mul_f32 v[174:175], v[106:107], v[174:175]
    v_cvt_pk_bf16_f32 v168, v168, v169
    v_cvt_pk_bf16_f32 v169, v170, v171
    v_cvt_pk_bf16_f32 v170, v172, v173
    v_cvt_pk_bf16_f32 v171, v174, v175
    s_cbranch_scc1 L_nsw0
    v_swap_b32 v168, v170
    v_swap_b32 v169, v171
L_nsw0:
    buffer_store_dwordx4 v[168:171], v14, s[32:35], s53 offen sc1
    v_pk_fma_f32 v[176:177], v[92:93], v[80:81], v[176:177] op_sel:[0,1,0] op_sel_hi:[1,1,1] neg_lo:[0,1,0] neg_hi:[0,1,0]
    v_pk_fma_f32 v[178:179], v[94:95], v[80:81], v[178:179] op_sel:[0,1,0] op_sel_hi:[1,1,1] neg_lo:[0,1,0] neg_hi:[0,1,0]
    v_pk_fma_f32 v[180:181], v[96:97], v[80:81], v[180:181] op_sel:[0,1,0] op_sel_hi:[1,1,1] neg_lo:[0,1,0] neg_hi:[0,1,0]
    v_pk_fma_f32 v[182:183], v[98:99], v[80:81], v[182:183] op_sel:[0,1,0] op_sel_hi:[1,1,1] neg_lo:[0,1,0] neg_hi:[0,1,0]
    v_pk_mul_f32 v[176:177], v[176:177], v[80:81] op_sel_hi:[1,0]
    v_pk_mul_f32 v[178:179], v[178:179], v[80:81] op_sel_hi:[1,0]
    v_pk_mul_f32 v[180:181], v[180:181], v[80:81] op_sel_hi:[1,0]
    v_pk_mul_f32 v[182:183], v[182:183], v[80:81] op_sel_hi:[1,0]
    v_pk_mul_f32 v[108:109], v[176:177], v[176:177]
    v_pk_mul_f32 v[110:111], v[178:179], v[178:179]
    v_pk_mul_f32 v[112:113], v[180:181], v[180:181]
    v_pk_mul_f32 v[114:115], v[182:183], v[182:183]
    v_pk_fma_f32 v[108:109], v[108:109], v[30:31], v[30:31] op_sel:[0,0,1] op_sel_hi:[1,0,1]
    v_pk_fma_f32 v[110:111], v[110:111], v[30:31], v[30:31] op_sel:[0,0,1] op_sel_hi:[1,0,1]
    v_pk_fma_f32 v[112:113], v[112:113], v[30:31], v[30:31] op_sel:[0,0,1] op_sel_hi:[1,0,1]
    v_pk_fma_f32 v[114:115], v[114:115], v[30:31], v[30:31] op_sel:[0,0,1] op_sel_hi:[1,0,1]
    v_pk_mul_f32 v[108:109], v[108:109], v[176:177]
    v_pk_mul_f32 v[110:111], v[110:111], v[178:179]
    v_pk_mul_f32 v[112:113], v[112:113], v[180:181]
    v_pk_mul_f32 v[114:115], v[114:115], v[182:183]
    v_exp_f32 v108, v108
    v_exp_f32 v109, v109
    v_exp_f32 v110, v110
    v_exp_f32 v111, v111
    v_exp_f32 v112, v112
    v_exp_f32 v113, v113
    v_exp_f32 v114, v114
    v_exp_f32 v115, v115
    v_pk_add_f32 v[108:109], v[108:109], 1.0 op_sel_hi:[1,0]
    v_pk_add_f32 v[110:111], v[110:111], 1.0 op_sel_hi:[1,0]
    v_pk_add_f32 v[112:113], v[112:113], 1.0 op_sel_hi:[1,0]
    v_pk_add_f32 v[114:115], v[114:115], 1.0 op_sel_hi:[1,0]
    v_rcp_f32 v108, v108
    v_rcp_f32 v109, v109
    v_rcp_f32 v110, v110
    v_rcp_f32 v111, v111
    v_rcp_f32 v112, v112
    v_rcp_f32 v113, v113
    v_rcp_f32 v114, v114
    v_rcp_f32 v115, v115
    v_pk_mul_f32 v[176:177], v[108:109], v[176:177]
    v_pk_mul_f32 v[178:179], v[110:111], v[178:179]
    v_pk_mul_f32 v[180:181], v[112:113], v[180:181]
    v_pk_mul_f32 v[182:183], v[114:115], v[182:183]
    v_cvt_pk_bf16_f32 v176, v176, v177
    v_cvt_pk_bf16_f32 v177, v178, v179
    v_cvt_pk_bf16_f32 v178, v180, v181
    v_cvt_pk_bf16_f32 v179, v182, v183
    s_cbranch_scc1 L_nsw1
    v_swap_b32 v176, v178
    v_swap_b32 v177, v179
L_nsw1:
    buffer_store_dwordx4 v[176:179], v14, s[32:35], s54 offen sc1
    v_pk_fma_f32 v[184:185], v[84:85], v[82:83], v[184:185] op_sel:[0,1,0] op_sel_hi:[1,1,1] neg_lo:[0,1,0] neg_hi:[0,1,0]
    v_pk_fma_f32 v[186:187], v[86:87], v[82:83], v[186:187] op_sel:[0,1,0] op_sel_hi:[1,1,1] neg_lo:[0,1,0] neg_hi:[0,1,0]
    v_pk_fma_f32 v[188:189], v[88:89], v[82:83], v[188:189] op_sel:[0,1,0] op_sel_hi:[1,1,1] neg_lo:[0,1,0] neg_hi:[0,1,0]
    v_pk_fma_f32 v[190:191], v[90:91], v[82:83], v[190:191] op_sel:[0,1,0] op_sel_hi:[1,1,1] neg_lo:[0,1,0] neg_hi:[0,1,0]
    v_pk_mul_f32 v[184:185], v[184:185], v[82:83] op_sel_hi:[1,0]
    v_pk_mul_f32 v[186:187], v[186:187], v[82:83] op_sel_hi:[1,0]
    v_pk_mul_f32 v[188:189], v[188:189], v[82:83] op_sel_hi:[1,0]
    v_pk_mul_f32 v[190:191], v[190:191], v[82:83] op_sel_hi:[1,0]
    v_pk_mul_f32 v[100:101], v[184:185], v[184:185]
    v_pk_mul_f32 v[102:103], v[186:187], v[186:187]
    v_pk_mul_f32 v[104:105], v[188:189], v[188:189]
    v_pk_mul_f32 v[106:107], v[190:191], v[190:191]
    v_pk_fma_f32 v[100:101], v[100:101], v[30:31], v[30:31] op_sel:[0,0,1] op_sel_hi:[1,0,1]
    v_pk_fma_f32 v[102:103], v[102:103], v[30:31], v[30:31] op_sel:[0,0,1] op_sel_hi:[1,0,1]
    v_pk_fma_f32 v[104:105], v[104:105], v[30:31], v[30:31] op_sel:[0,0,1] op_sel_hi:[1,0,1]
    v_pk_fma_f32 v[106:107], v[106:107], v[30:31], v[30:31] op_sel:[0,0,1] op_sel_hi:[1,0,1]
    v_pk_mul_f32 v[100:101], v[100:101], v[184:185]
    v_pk_mul_f32 v[102:103], v[102:103], v[186:187]
    v_pk_mul_f32 v[104:105], v[104:105], v[188:189]
    v_pk_mul_f32 v[106:107], v[106:107], v[190:191]
    v_exp_f32 v100, v100
    v_exp_f32 v101, v101
    v_exp_f32 v102, v102
    v_exp_f32 v103, v103
    v_exp_f32 v104, v104
    v_exp_f32 v105, v105
    v_exp_f32 v106, v106
    v_exp_f32 v107, v107
    v_pk_add_f32 v[100:101], v[100:101], 1.0 op_sel_hi:[1,0]
    v_pk_add_f32 v[102:103], v[102:103], 1.0 op_sel_hi:[1,0]
    v_pk_add_f32 v[104:105], v[104:105], 1.0 op_sel_hi:[1,0]
    v_pk_add_f32 v[106:107], v[106:107], 1.0 op_sel_hi:[1,0]
    v_rcp_f32 v100, v100
    v_rcp_f32 v101, v101
    v_rcp_f32 v102, v102
    v_rcp_f32 v103, v103
    v_rcp_f32 v104, v104
    v_rcp_f32 v105, v105
    v_rcp_f32 v106, v106
    v_rcp_f32 v107, v107
    v_pk_mul_f32 v[184:185], v[100:101], v[184:185]
    v_pk_mul_f32 v[186:187], v[102:103], v[186:187]
    v_pk_mul_f32 v[188:189], v[104:105], v[188:189]
    v_pk_mul_f32 v[190:191], v[106:107], v[190:191]
    v_cvt_pk_bf16_f32 v184, v184, v185
    v_cvt_pk_bf16_f32 v185, v186, v187
    v_cvt_pk_bf16_f32 v186, v188, v189
    v_cvt_pk_bf16_f32 v187, v190, v191
    s_cbranch_scc1 L_nsw2
    v_swap_b32 v184, v186
    v_swap_b32 v185, v187
L_nsw2:
    buffer_store_dwordx4 v[184:187], v22, s[32:35], s53 offen sc1
    buffer_load_dword v232, v28, s[32:35], s56 offen offset:0 sc1
    buffer_load_dword v233, v28, s[32:35], s56 offen offset:1024 sc1
    buffer_load_dword v234, v28, s[32:35], s56 offen offset:2048 sc1
    buffer_load_dword v235, v28, s[32:35], s56 offen offset:3072 sc1
    buffer_load_dword v236, v28, s[32:35], s57 offen offset:0 sc1
    buffer_load_dword v237, v28, s[32:35], s57 offen offset:1024 sc1
    buffer_load_dword v238, v28, s[32:35], s57 offen offset:2048 sc1
    buffer_load_dword v239, v28, s[32:35], s57 offen offset:3072 sc1
    buffer_load_dword v240, v28, s[32:35], s58 offen offset:0 sc1
    buffer_load_dword v241, v28, s[32:35], s58 offen offset:1024 sc1
    buffer_load_dword v242, v28, s[32:35], s58 offen offset:2048 sc1
    buffer_load_dword v243, v28, s[32:35], s58 offen offset:3072 sc1
    buffer_load_dword v244, v28, s[32:35], s59 offen offset:0 sc1
    buffer_load_dword v245, v28, s[32:35], s59 offen offset:1024 sc1
    v_mov_b32 v21, 158220
    v_mov_b32 v20, 1
    s_mov_b64 exec, 1
    ds_add_u32 v21, v20
    s_mov_b64 exec, -1
    v_pk_fma_f32 v[192:193], v[92:93], v[82:83], v[192:193] op_sel:[0,1,0] op_sel_hi:[1,1,1] neg_lo:[0,1,0] neg_hi:[0,1,0]
    v_pk_fma_f32 v[194:195], v[94:95], v[82:83], v[194:195] op_sel:[0,1,0] op_sel_hi:[1,1,1] neg_lo:[0,1,0] neg_hi:[0,1,0]
    v_pk_fma_f32 v[196:197], v[96:97], v[82:83], v[196:197] op_sel:[0,1,0] op_sel_hi:[1,1,1] neg_lo:[0,1,0] neg_hi:[0,1,0]
    v_pk_fma_f32 v[198:199], v[98:99], v[82:83], v[198:199] op_sel:[0,1,0] op_sel_hi:[1,1,1] neg_lo:[0,1,0] neg_hi:[0,1,0]
    v_pk_mul_f32 v[192:193], v[192:193], v[82:83] op_sel_hi:[1,0]
    v_pk_mul_f32 v[194:195], v[194:195], v[82:83] op_sel_hi:[1,0]
    v_pk_mul_f32 v[196:197], v[196:197], v[82:83] op_sel_hi:[1,0]
    v_pk_mul_f32 v[198:199], v[198:199], v[82:83] op_sel_hi:[1,0]
    v_pk_mul_f32 v[108:109], v[192:193], v[192:193]
    v_pk_mul_f32 v[110:111], v[194:195], v[194:195]
    v_pk_mul_f32 v[112:113], v[196:197], v[196:197]
    v_pk_mul_f32 v[114:115], v[198:199], v[198:199]
    v_pk_fma_f32 v[108:109], v[108:109], v[30:31], v[30:31] op_sel:[0,0,1] op_sel_hi:[1,0,1]
    v_pk_fma_f32 v[110:111], v[110:111], v[30:31], v[30:31] op_sel:[0,0,1] op_sel_hi:[1,0,1]
    v_pk_fma_f32 v[112:113], v[112:113], v[30:31], v[30:31] op_sel:[0,0,1] op_sel_hi:[1,0,1]
    v_pk_fma_f32 v[114:115], v[114:115], v[30:31], v[30:31] op_sel:[0,0,1] op_sel_hi:[1,0,1]
    v_pk_mul_f32 v[108:109], v[108:109], v[192:193]
    v_pk_mul_f32 v[110:111], v[110:111], v[194:195]
    v_pk_mul_f32 v[112:113], v[112:113], v[196:197]
    v_pk_mul_f32 v[114:115], v[114:115], v[198:199]
    v_exp_f32 v108, v108
    v_exp_f32 v109, v109
    v_exp_f32 v110, v110
    v_exp_f32 v111, v111
    v_exp_f32 v112, v112
    v_exp_f32 v113, v113
    v_exp_f32 v114, v114
    v_exp_f32 v115, v115
    v_pk_add_f32 v[108:109], v[108:109], 1.0 op_sel_hi:[1,0]
    v_pk_add_f32 v[110:111], v[110:111], 1.0 op_sel_hi:[1,0]
    v_pk_add_f32 v[112:113], v[112:113], 1.0 op_sel_hi:[1,0]
    v_pk_add_f32 v[114:115], v[114:115], 1.0 op_sel_hi:[1,0]
    v_rcp_f32 v108, v108
    v_rcp_f32 v109, v109
    v_rcp_f32 v110, v110
    v_rcp_f32 v111, v111
    v_rcp_f32 v112, v112
    v_rcp_f32 v113, v113
    v_rcp_f32 v114, v114
    v_rcp_f32 v115, v115
    v_pk_mul_f32 v[192:193], v[108:109], v[192:193]
    v_pk_mul_f32 v[194:195], v[110:111], v[194:195]
    v_pk_mul_f32 v[196:197], v[112:113], v[196:197]
    v_pk_mul_f32 v[198:199], v[114:115], v[198:199]
    v_cvt_pk_bf16_f32 v192, v192, v193
    v_cvt_pk_bf16_f32 v193, v194, v195
    v_cvt_pk_bf16_f32 v194, v196, v197
    v_cvt_pk_bf16_f32 v195, v198, v199
    s_cbranch_scc1 L_nsw3
    v_swap_b32 v192, v194
    v_swap_b32 v193, v195
L_nsw3:
    buffer_store_dwordx4 v[192:195], v22, s[32:35], s54 offen sc1
    s_lshl_b32 s3, s19, 10
    v_xor_b32 v22, s3, v14
    s_waitcnt vmcnt(1)
    s_branch L_pchk
L_poll:
    s_waitcnt vmcnt(0)
    buffer_load_dword v232, v28, s[32:35], s56 offen offset:0 sc1
    buffer_load_dword v233, v28, s[32:35], s56 offen offset:1024 sc1
    buffer_load_dword v234, v28, s[32:35], s56 offen offset:2048 sc1
    buffer_load_dword v235, v28, s[32:35], s56 offen offset:3072 sc1
    buffer_load_dword v236, v28, s[32:35], s57 offen offset:0 sc1
    buffer_load_dword v237, v28, s[32:35], s57 offen offset:1024 sc1
    buffer_load_dword v238, v28, s[32:35], s57 offen offset:2048 sc1
    buffer_load_dword v239, v28, s[32:35], s57 offen offset:3072 sc1
    buffer_load_dword v240, v28, s[32:35], s58 offen offset:0 sc1
    buffer_load_dword v241, v28, s[32:35], s58 offen offset:1024 sc1
    buffer_load_dword v242, v28, s[32:35], s58 offen offset:2048 sc1
    buffer_load_dword v243, v28, s[32:35], s58 offen offset:3072 sc1
    buffer_load_dword v244, v28, s[32:35], s59 offen offset:0 sc1
    buffer_load_dword v245, v28, s[32:35], s59 offen offset:1024 sc1
    s_waitcnt vmcnt(0)
L_pchk:
    v_and_b32 v21, v232, v233
    v_bitop3_b32 v21, v21, v234, v235 bitop3:0x80
    v_bitop3_b32 v21, v21, v236, v237 bitop3:0x80
    v_bitop3_b32 v21, v21, v238, v239 bitop3:0x80
    v_bitop3_b32 v21, v21, v240, v241 bitop3:0x80
    v_bitop3_b32 v21, v21, v242, v243 bitop3:0x80
    v_bitop3_b32 v21, v21, v244, v245 bitop3:0x80
    v_and_b32 v21, 1, v21
    v_cmp_eq_u32 vcc, 0, v21
    s_sub_u32 s18, s18, 1
    s_cmp_eq_u64 vcc, 0
    s_cbranch_scc1 L_pok
    s_cmp_gt_i32 s18, 0
    s_cbranch_scc1 L_poll
L_pok:
    v_pk_add_f32 v[232:233], v[232:233], v[238:239]
    v_pk_add_f32 v[234:235], v[234:235], v[240:241]
    v_pk_add_f32 v[236:237], v[236:237], v[242:243]
    v_pk_add_f32 v[232:233], v[232:233], v[244:245]
    v_pk_add_f32 v[234:235], v[234:235], v[236:237]
    v_pk_add_f32 v[232:233], v[232:233], v[234:235]
    v_add_f32 v232, v232, v233
    v_mul_f32 v232, 0x3a924925, v232
    s_nop 1
    v_mov_b32_dpp v233, v232 row_ror:8 row_mask:0xf bank_mask:0xf
    v_fma_f32 v233, -v232, v232, v233
    v_add_f32 v233, 0x3727c5ac, v233
    v_rsq_f32 v233, v233
    s_nop 0
    v_mul_f32 v232, -v232, v233
    s_nop 0
    v_mov_b32_dpp v32, v233 row_newbcast:0 row_mask:0xf bank_mask:0xf
    v_mov_b32_dpp v33, v233 row_newbcast:1 row_mask:0xf bank_mask:0xf
    v_mov_b32_dpp v34, v233 row_newbcast:2 row_mask:0xf bank_mask:0xf
    v_mov_b32_dpp v35, v233 row_newbcast:3 row_mask:0xf bank_mask:0xf
    v_mov_b32_dpp v36, v233 row_newbcast:4 row_mask:0xf bank_mask:0xf
    v_mov_b32_dpp v37, v233 row_newbcast:5 row_mask:0xf bank_mask:0xf
    v_mov_b32_dpp v38, v233 row_newbcast:6 row_mask:0xf bank_mask:0xf
    v_mov_b32_dpp v39, v233 row_newbcast:7 row_mask:0xf bank_mask:0xf
    v_mov_b32_dpp v40, v232 row_newbcast:0 row_mask:0xf bank_mask:0xf
    v_mov_b32_dpp v41, v232 row_newbcast:1 row_mask:0xf bank_mask:0xf
    v_mov_b32_dpp v42, v232 row_newbcast:2 row_mask:0xf bank_mask:0xf
    v_mov_b32_dpp v43, v232 row_newbcast:3 row_mask:0xf bank_mask:0xf
    v_mov_b32_dpp v44, v232 row_newbcast:4 row_mask:0xf bank_mask:0xf
    v_mov_b32_dpp v45, v232 row_newbcast:5 row_mask:0xf bank_mask:0xf
    v_mov_b32_dpp v46, v232 row_newbcast:6 row_mask:0xf bank_mask:0xf
    v_mov_b32_dpp v47, v232 row_newbcast:7 row_mask:0xf bank_mask:0xf
    v_pk_fma_f32 v[136:137], v[136:137], v[32:33], v[40:41]
    v_pk_fma_f32 v[138:139], v[138:139], v[34:35], v[42:43]
    v_pk_fma_f32 v[140:141], v[140:141], v[36:37], v[44:45]
    v_pk_fma_f32 v[142:143], v[142:143], v[38:39], v[46:47]
    v_cvt_pk_bf16_f32 v136, v136, v137
    v_cvt_pk_bf16_f32 v137, v138, v139
    v_cvt_pk_bf16_f32 v138, v140, v141
    v_cvt_pk_bf16_f32 v139, v142, v143
    buffer_store_dwordx4 v[136:139], v22, s[32:35], s52 offen sc1
    v_pk_fma_f32 v[144:145], v[144:145], v[32:33], v[40:41]
    v_pk_fma_f32 v[146:147], v[146:147], v[34:35], v[42:43]
    v_pk_fma_f32 v[148:149], v[148:149], v[36:37], v[44:45]
    v_pk_fma_f32 v[150:151], v[150:151], v[38:39], v[46:47]
    v_cvt_pk_bf16_f32 v144, v144, v145
    v_cvt_pk_bf16_f32 v145, v146, v147
    v_cvt_pk_bf16_f32 v146, v148, v149
    v_cvt_pk_bf16_f32 v147, v150, v151
    v_xor_b32 v23, 1024, v22
    buffer_store_dwordx4 v[144:147], v23, s[32:35], s52 offen sc1
    v_pk_fma_f32 v[152:153], v[152:153], v[32:33], v[40:41]
    v_pk_fma_f32 v[154:155], v[154:155], v[34:35], v[42:43]
    v_pk_fma_f32 v[156:157], v[156:157], v[36:37], v[44:45]
    v_pk_fma_f32 v[158:159], v[158:159], v[38:39], v[46:47]
    v_cvt_pk_bf16_f32 v152, v152, v153
    v_cvt_pk_bf16_f32 v153, v154, v155
    v_cvt_pk_bf16_f32 v154, v156, v157
    v_cvt_pk_bf16_f32 v155, v158, v159
    v_xor_b32 v24, 2048, v22
    buffer_store_dwordx4 v[152:155], v24, s[32:35], s52 offen sc1
    v_pk_fma_f32 v[160:161], v[160:161], v[32:33], v[40:41]
    v_pk_fma_f32 v[162:163], v[162:163], v[34:35], v[42:43]
    v_pk_fma_f32 v[164:165], v[164:165], v[36:37], v[44:45]
    v_pk_fma_f32 v[166:167], v[166:167], v[38:39], v[46:47]
    v_cvt_pk_bf16_f32 v160, v160, v161
    v_cvt_pk_bf16_f32 v161, v162, v163
    v_cvt_pk_bf16_f32 v162, v164, v165
    v_cvt_pk_bf16_f32 v163, v166, v167
    v_xor_b32 v25, 3072, v22
    buffer_store_dwordx4 v[160:163], v25, s[32:35], s52 offen sc1
    v_mov_b32 v21, 158220
    v_mov_b32 v20, 1
    s_mov_b64 exec, 1
    ds_add_u32 v21, v20
    s_mov_b64 exec, -1
    v_mov_b32 v21, 158216
    v_mov_b32 v20, 1
    s_mov_b64 exec, 1
    s_waitcnt vmcnt(0)
    ds_add_rtn_u32 v20, v21, v20
    s_waitcnt lgkmcnt(0)
    v_readfirstlane_b32 s3, v20
    s_cmp_eq_u32 s3, 3
    s_cbranch_scc0 L_cz_fl
    buffer_store_dword v16, v252, s[32:35], 0 offen sc1
L_cz_fl:
    s_mov_b64 exec, -1
    s_branch L_c_p2
L_cab:
    s_barrier
    ds_read_b128 v[32:35], v2 offset:0
    ds_read_b128 v[40:43], v10 offset:0
    ds_read_b128 v[36:39], v3 offset:0
    ds_read_b128 v[44:47], v11 offset:2048
    ds_read_b128 v[48:51], v10 offset:4096
    ds_read_b128 v[52:55], v11 offset:6144
    ds_read_b128 v[56:59], v10 offset:8192
    ds_read_b128 v[60:63], v11 offset:10240
    ds_read_b128 v[64:67], v10 offset:12288
    ds_read_b128 v[68:71], v11 offset:14336
    ds_read_b128 v[72:75], v6 offset:0
    ds_read_b128 v[76:79], v7 offset:2048
    ds_read_b128 v[80:83], v6 offset:4096
    s_waitcnt lgkmcnt(11)
    v_mfma_f32_16x16x32_bf16 v[136:139], v[32:35], v[40:43], v[136:139]
    ds_read_b128 v[84:87], v4 offset:0
    s_waitcnt lgkmcnt(11)
    v_mfma_f32_16x16x32_bf16 v[140:143], v[36:39], v[40:43], v[140:143]
    ds_read_b128 v[92:95], v12 offset:0
    s_waitcnt lgkmcnt(11)
    v_mfma_f32_16x16x32_bf16 v[144:147], v[32:35], v[44:47], v[144:147]
    ds_read_b128 v[88:91], v5 offset:0
    v_mfma_f32_16x16x32_bf16 v[148:151], v[36:39], v[44:47], v[148:151]
    ds_read_b128 v[96:99], v13 offset:2048
    s_waitcnt lgkmcnt(12)
    v_mfma_f32_16x16x32_bf16 v[152:155], v[32:35], v[48:51], v[152:155]
    ds_read_b128 v[100:103], v12 offset:4096
    v_mfma_f32_16x16x32_bf16 v[156:159], v[36:39], v[48:51], v[156:159]
    ds_read_b128 v[104:107], v13 offset:6144
    s_waitcnt lgkmcnt(13)
    v_mfma_f32_16x16x32_bf16 v[160:163], v[32:35], v[52:55], v[160:163]
    ds_read_b128 v[108:111], v12 offset:8192
    v_mfma_f32_16x16x32_bf16 v[164:167], v[36:39], v[52:55], v[164:167]
    ds_read_b128 v[112:115], v13 offset:10240
    s_waitcnt lgkmcnt(14)
    v_mfma_f32_16x16x32_bf16 v[168:171], v[32:35], v[56:59], v[168:171]
    ds_read_b128 v[116:119], v12 offset:12288
    v_mfma_f32_16x16x32_bf16 v[172:175], v[36:39], v[56:59], v[172:175]
    ds_read_b128 v[120:123], v13 offset:14336
    s_waitcnt lgkmcnt(15)
    v_mfma_f32_16x16x32_bf16 v[176:179], v[32:35], v[60:63], v[176:179]
    ds_read_b128 v[124:127], v8 offset:0
    v_mfma_f32_16x16x32_bf16 v[180:183], v[36:39], v[60:63], v[180:183]
    ds_read_b128 v[128:131], v9 offset:2048
    s_waitcnt lgkmcnt(15)
    v_mfma_f32_16x16x32_bf16 v[184:187], v[32:35], v[64:67], v[184:187]
    ds_read_b128 v[132:135], v8 offset:4096
    v_mfma_f32_16x16x32_bf16 v[188:191], v[36:39], v[64:67], v[188:191]
    v_mfma_f32_16x16x32_bf16 v[192:195], v[32:35], v[68:71], v[192:195]
    v_mfma_f32_16x16x32_bf16 v[196:199], v[36:39], v[68:71], v[196:199]
    s_waitcnt lgkmcnt(15)
    v_mfma_f32_16x16x32_bf16 v[200:203], v[32:35], v[72:75], v[200:203]
    v_mfma_f32_16x16x32_bf16 v[204:207], v[36:39], v[72:75], v[204:207]
    s_waitcnt lgkmcnt(14)
    v_mfma_f32_16x16x32_bf16 v[208:211], v[32:35], v[76:79], v[208:211]
    v_mfma_f32_16x16x32_bf16 v[212:215], v[36:39], v[76:79], v[212:215]
    s_waitcnt lgkmcnt(13)
    v_mfma_f32_16x16x32_bf16 v[216:219], v[32:35], v[80:83], v[216:219]
    v_mfma_f32_16x16x32_bf16 v[220:223], v[36:39], v[80:83], v[220:223]
    s_waitcnt lgkmcnt(11)
    v_mfma_f32_16x16x32_bf16 v[136:139], v[84:87], v[92:95], v[136:139]
    s_waitcnt lgkmcnt(10)
    v_mfma_f32_16x16x32_bf16 v[140:143], v[88:91], v[92:95], v[140:143]
    s_waitcnt lgkmcnt(9)
    v_mfma_f32_16x16x32_bf16 v[144:147], v[84:87], v[96:99], v[144:147]
    v_mfma_f32_16x16x32_bf16 v[148:151], v[88:91], v[96:99], v[148:151]
    s_waitcnt lgkmcnt(0)
    s_barrier
    s_cmp_eq_u32 s19, 3
    s_cbranch_scc0 L_cab_nal
    buffer_load_dword v20, off, s[36:39], 0 sc1
L_cab_nal:
    ds_read_b128 v[32:35], v2 offset:16384
    v_mfma_f32_16x16x32_bf16 v[152:155], v[84:87], v[100:103], v[152:155]
    ds_read_b128 v[40:43], v10 offset:16384
    v_mfma_f32_16x16x32_bf16 v[156:159], v[88:91], v[100:103], v[156:159]
    ds_read_b128 v[36:39], v3 offset:16384
    v_mfma_f32_16x16x32_bf16 v[160:163], v[84:87], v[104:107], v[160:163]
    ds_read_b128 v[44:47], v11 offset:18432
    v_mfma_f32_16x16x32_bf16 v[164:167], v[88:91], v[104:107], v[164:167]
    ds_read_b128 v[48:51], v10 offset:20480
    v_mfma_f32_16x16x32_bf16 v[168:171], v[84:87], v[108:111], v[168:171]
    ds_read_b128 v[52:55], v11 offset:22528
    v_mfma_f32_16x16x32_bf16 v[172:175], v[88:91], v[108:111], v[172:175]
    ds_read_b128 v[56:59], v10 offset:24576
    v_mfma_f32_16x16x32_bf16 v[176:179], v[84:87], v[112:115], v[176:179]
    ds_read_b128 v[60:63], v11 offset:26624
    v_mfma_f32_16x16x32_bf16 v[180:183], v[88:91], v[112:115], v[180:183]
    ds_read_b128 v[64:67], v10 offset:28672
    v_mfma_f32_16x16x32_bf16 v[184:187], v[84:87], v[116:119], v[184:187]
    ds_read_b128 v[68:71], v11 offset:30720
    v_mfma_f32_16x16x32_bf16 v[188:191], v[88:91], v[116:119], v[188:191]
    ds_read_b128 v[72:75], v6 offset:6144
    v_mfma_f32_16x16x32_bf16 v[192:195], v[84:87], v[120:123], v[192:195]
    ds_read_b128 v[76:79], v7 offset:8192
    v_mfma_f32_16x16x32_bf16 v[196:199], v[88:91], v[120:123], v[196:199]
    ds_read_b128 v[80:83], v6 offset:10240
    v_mfma_f32_16x16x32_bf16 v[200:203], v[84:87], v[124:127], v[200:203]
    v_mfma_f32_16x16x32_bf16 v[204:207], v[88:91], v[124:127], v[204:207]
    v_mfma_f32_16x16x32_bf16 v[208:211], v[84:87], v[128:131], v[208:211]
    v_mfma_f32_16x16x32_bf16 v[212:215], v[88:91], v[128:131], v[212:215]
    v_mfma_f32_16x16x32_bf16 v[216:219], v[84:87], v[132:135], v[216:219]
    v_mfma_f32_16x16x32_bf16 v[220:223], v[88:91], v[132:135], v[220:223]
    s_waitcnt lgkmcnt(11)
    v_mfma_f32_16x16x32_bf16 v[136:139], v[32:35], v[40:43], v[136:139]
    ds_read_b128 v[84:87], v4 offset:16384
    s_waitcnt lgkmcnt(11)
    v_mfma_f32_16x16x32_bf16 v[140:143], v[36:39], v[40:43], v[140:143]
    ds_read_b128 v[92:95], v12 offset:16384
    s_waitcnt lgkmcnt(11)
    v_mfma_f32_16x16x32_bf16 v[144:147], v[32:35], v[44:47], v[144:147]
    ds_read_b128 v[88:91], v5 offset:16384
    v_mfma_f32_16x16x32_bf16 v[148:151], v[36:39], v[44:47], v[148:151]
    ds_read_b128 v[96:99], v13 offset:18432
    s_waitcnt lgkmcnt(12)
    v_mfma_f32_16x16x32_bf16 v[152:155], v[32:35], v[48:51], v[152:155]
    ds_read_b128 v[100:103], v12 offset:20480
    v_mfma_f32_16x16x32_bf16 v[156:159], v[36:39], v[48:51], v[156:159]
    ds_read_b128 v[104:107], v13 offset:22528
    s_waitcnt lgkmcnt(13)
    v_mfma_f32_16x16x32_bf16 v[160:163], v[32:35], v[52:55], v[160:163]
    ds_read_b128 v[108:111], v12 offset:24576
    v_mfma_f32_16x16x32_bf16 v[164:167], v[36:39], v[52:55], v[164:167]
    ds_read_b128 v[112:115], v13 offset:26624
    s_waitcnt lgkmcnt(14)
    v_mfma_f32_16x16x32_bf16 v[168:171], v[32:35], v[56:59], v[168:171]
    ds_read_b128 v[116:119], v12 offset:28672
    v_mfma_f32_16x16x32_bf16 v[172:175], v[36:39], v[56:59], v[172:175]
    ds_read_b128 v[120:123], v13 offset:30720
    s_waitcnt lgkmcnt(15)
    v_mfma_f32_16x16x32_bf16 v[176:179], v[32:35], v[60:63], v[176:179]
    ds_read_b128 v[124:127], v8 offset:6144
    v_mfma_f32_16x16x32_bf16 v[180:183], v[36:39], v[60:63], v[180:183]
    ds_read_b128 v[128:131], v9 offset:8192
    s_waitcnt lgkmcnt(15)
    v_mfma_f32_16x16x32_bf16 v[184:187], v[32:35], v[64:67], v[184:187]
    ds_read_b128 v[132:135], v8 offset:10240
    v_mfma_f32_16x16x32_bf16 v[188:191], v[36:39], v[64:67], v[188:191]
    v_mfma_f32_16x16x32_bf16 v[192:195], v[32:35], v[68:71], v[192:195]
    v_mfma_f32_16x16x32_bf16 v[196:199], v[36:39], v[68:71], v[196:199]
    s_waitcnt lgkmcnt(15)
    v_mfma_f32_16x16x32_bf16 v[200:203], v[32:35], v[72:75], v[200:203]
    v_mfma_f32_16x16x32_bf16 v[204:207], v[36:39], v[72:75], v[204:207]
    s_waitcnt lgkmcnt(14)
    v_mfma_f32_16x16x32_bf16 v[208:211], v[32:35], v[76:79], v[208:211]
    v_mfma_f32_16x16x32_bf16 v[212:215], v[36:39], v[76:79], v[212:215]
    s_waitcnt lgkmcnt(13)
    v_mfma_f32_16x16x32_bf16 v[216:219], v[32:35], v[80:83], v[216:219]
    v_mfma_f32_16x16x32_bf16 v[220:223], v[36:39], v[80:83], v[220:223]
    s_waitcnt lgkmcnt(11)
    v_mfma_f32_16x16x32_bf16 v[136:139], v[84:87], v[92:95], v[136:139]
    s_waitcnt lgkmcnt(10)
    v_mfma_f32_16x16x32_bf16 v[140:143], v[88:91], v[92:95], v[140:143]
    s_waitcnt lgkmcnt(9)
    v_mfma_f32_16x16x32_bf16 v[144:147], v[84:87], v[96:99], v[144:147]
    v_mfma_f32_16x16x32_bf16 v[148:151], v[88:91], v[96:99], v[148:151]
    s_waitcnt lgkmcnt(0)
    s_waitcnt vmcnt(0)
    s_cmp_eq_u32 s19, 3
    s_cbranch_scc0 L_cab_nan
    s_mov_b32 s18, 131072
L_cab_an0:
    v_readfirstlane_b32 s3, v20
    s_sub_u32 s18, s18, 1
    s_cmp_lg_u32 s3, 0
    s_cbranch_scc1 L_cab_nan
    s_cmp_le_i32 s18, 0
    s_cbranch_scc1 L_cab_nan
    buffer_load_dword v20, off, s[36:39], 0 sc1
    s_waitcnt vmcnt(0)
    s_branch L_cab_an0
L_cab_nan:
    s_barrier
    s_cmp_eq_u32 s19, 3
    s_cbranch_scc0 L_cab_npb
    v_readfirstlane_b32 s18, v20
    s_lshr_b32 s3, s65, 8
    s_sub_u32 s3, s3, s18
    s_and_b32 s3, s3, 7
    s_add_u32 s3, s3, 1
    v_mov_b32 v24, s3
    s_lshl_b32 s3, s3, 8
    s_and_b32 s65, s65, 255
    s_or_b32 s65, s65, s3
    s_and_b32 s3, s65, 255
    s_lshl_b32 s3, s3, 2
    s_add_u32 s3, s3, 29097984
    s_mov_b64 exec, 1
    buffer_store_dword v24, off, s[32:35], s3 sc1
    s_mov_b64 exec, -1
L_cab_npb:
    ds_read_b128 v[32:35], v2 offset:32768
    v_mfma_f32_16x16x32_bf16 v[152:155], v[84:87], v[100:103], v[152:155]
    ds_read_b128 v[40:43], v10 offset:32768
    v_mfma_f32_16x16x32_bf16 v[156:159], v[88:91], v[100:103], v[156:159]
    ds_read_b128 v[36:39], v3 offset:32768
    v_mfma_f32_16x16x32_bf16 v[160:163], v[84:87], v[104:107], v[160:163]
    ds_read_b128 v[44:47], v11 offset:34816
    v_mfma_f32_16x16x32_bf16 v[164:167], v[88:91], v[104:107], v[164:167]
    ds_read_b128 v[48:51], v10 offset:36864
    v_mfma_f32_16x16x32_bf16 v[168:171], v[84:87], v[108:111], v[168:171]
    ds_read_b128 v[52:55], v11 offset:38912
    v_mfma_f32_16x16x32_bf16 v[172:175], v[88:91], v[108:111], v[172:175]
    ds_read_b128 v[56:59], v10 offset:40960
    v_mfma_f32_16x16x32_bf16 v[176:179], v[84:87], v[112:115], v[176:179]
    ds_read_b128 v[60:63], v11 offset:43008
    v_mfma_f32_16x16x32_bf16 v[180:183], v[88:91], v[112:115], v[180:183]
    ds_read_b128 v[64:67], v10 offset:45056
    v_mfma_f32_16x16x32_bf16 v[184:187], v[84:87], v[116:119], v[184:187]
    ds_read_b128 v[68:71], v11 offset:47104
    v_mfma_f32_16x16x32_bf16 v[188:191], v[88:91], v[116:119], v[188:191]
    ds_read_b128 v[72:75], v6 offset:12288
    v_mfma_f32_16x16x32_bf16 v[192:195], v[84:87], v[120:123], v[192:195]
    ds_read_b128 v[76:79], v7 offset:14336
    v_mfma_f32_16x16x32_bf16 v[196:199], v[88:91], v[120:123], v[196:199]
    ds_read_b128 v[80:83], v6 offset:16384
    v_mfma_f32_16x16x32_bf16 v[200:203], v[84:87], v[124:127], v[200:203]
    v_mfma_f32_16x16x32_bf16 v[204:207], v[88:91], v[124:127], v[204:207]
    v_mfma_f32_16x16x32_bf16 v[208:211], v[84:87], v[128:131], v[208:211]
    v_mfma_f32_16x16x32_bf16 v[212:215], v[88:91], v[128:131], v[212:215]
    v_mfma_f32_16x16x32_bf16 v[216:219], v[84:87], v[132:135], v[216:219]
    v_mfma_f32_16x16x32_bf16 v[220:223], v[88:91], v[132:135], v[220:223]
    s_waitcnt lgkmcnt(11)
    v_mfma_f32_16x16x32_bf16 v[136:139], v[32:35], v[40:43], v[136:139]
    ds_read_b128 v[84:87], v4 offset:32768
    s_waitcnt lgkmcnt(11)
    v_mfma_f32_16x16x32_bf16 v[140:143], v[36:39], v[40:43], v[140:143]
    ds_read_b128 v[92:95], v12 offset:32768
    s_waitcnt lgkmcnt(11)
    v_mfma_f32_16x16x32_bf16 v[144:147], v[32:35], v[44:47], v[144:147]
    ds_read_b128 v[88:91], v5 offset:32768
    v_mfma_f32_16x16x32_bf16 v[148:151], v[36:39], v[44:47], v[148:151]
    ds_read_b128 v[96:99], v13 offset:34816
    s_waitcnt lgkmcnt(12)
    v_mfma_f32_16x16x32_bf16 v[152:155], v[32:35], v[48:51], v[152:155]
    ds_read_b128 v[100:103], v12 offset:36864
    v_mfma_f32_16x16x32_bf16 v[156:159], v[36:39], v[48:51], v[156:159]
    ds_read_b128 v[104:107], v13 offset:38912
    s_waitcnt lgkmcnt(13)
    v_mfma_f32_16x16x32_bf16 v[160:163], v[32:35], v[52:55], v[160:163]
    ds_read_b128 v[108:111], v12 offset:40960
    v_mfma_f32_16x16x32_bf16 v[164:167], v[36:39], v[52:55], v[164:167]
    ds_read_b128 v[112:115], v13 offset:43008
    s_waitcnt lgkmcnt(14)
    v_mfma_f32_16x16x32_bf16 v[168:171], v[32:35], v[56:59], v[168:171]
    ds_read_b128 v[116:119], v12 offset:45056
    v_mfma_f32_16x16x32_bf16 v[172:175], v[36:39], v[56:59], v[172:175]
    ds_read_b128 v[120:123], v13 offset:47104
    s_waitcnt lgkmcnt(15)
    v_mfma_f32_16x16x32_bf16 v[176:179], v[32:35], v[60:63], v[176:179]
    ds_read_b128 v[124:127], v8 offset:12288
    v_mfma_f32_16x16x32_bf16 v[180:183], v[36:39], v[60:63], v[180:183]
    ds_read_b128 v[128:131], v9 offset:14336
    s_waitcnt lgkmcnt(15)
    v_mfma_f32_16x16x32_bf16 v[184:187], v[32:35], v[64:67], v[184:187]
    ds_read_b128 v[132:135], v8 offset:16384
    v_mfma_f32_16x16x32_bf16 v[188:191], v[36:39], v[64:67], v[188:191]
    v_mfma_f32_16x16x32_bf16 v[192:195], v[32:35], v[68:71], v[192:195]
    v_mfma_f32_16x16x32_bf16 v[196:199], v[36:39], v[68:71], v[196:199]
    s_waitcnt lgkmcnt(15)
    v_mfma_f32_16x16x32_bf16 v[200:203], v[32:35], v[72:75], v[200:203]
    v_mfma_f32_16x16x32_bf16 v[204:207], v[36:39], v[72:75], v[204:207]
    s_waitcnt lgkmcnt(14)
    v_mfma_f32_16x16x32_bf16 v[208:211], v[32:35], v[76:79], v[208:211]
    v_mfma_f32_16x16x32_bf16 v[212:215], v[36:39], v[76:79], v[212:215]
    s_waitcnt lgkmcnt(13)
    v_mfma_f32_16x16x32_bf16 v[216:219], v[32:35], v[80:83], v[216:219]
    v_mfma_f32_16x16x32_bf16 v[220:223], v[36:39], v[80:83], v[220:223]
    s_waitcnt lgkmcnt(11)
    v_mfma_f32_16x16x32_bf16 v[136:139], v[84:87], v[92:95], v[136:139]
    s_waitcnt lgkmcnt(10)
    v_mfma_f32_16x16x32_bf16 v[140:143], v[88:91], v[92:95], v[140:143]
    s_waitcnt lgkmcnt(9)
    v_mfma_f32_16x16x32_bf16 v[144:147], v[84:87], v[96:99], v[144:147]
    v_mfma_f32_16x16x32_bf16 v[148:151], v[88:91], v[96:99], v[148:151]
    s_waitcnt lgkmcnt(0)
    s_barrier
    ds_read_b128 v[32:35], v2 offset:49152
    v_mfma_f32_16x16x32_bf16 v[152:155], v[84:87], v[100:103], v[152:155]
    ds_read_b128 v[40:43], v10 offset:49152
    v_mfma_f32_16x16x32_bf16 v[156:159], v[88:91], v[100:103], v[156:159]
    ds_read_b128 v[36:39], v3 offset:49152
    v_mfma_f32_16x16x32_bf16 v[160:163], v[84:87], v[104:107], v[160:163]
    ds_read_b128 v[44:47], v11 offset:51200
    v_mfma_f32_16x16x32_bf16 v[164:167], v[88:91], v[104:107], v[164:167]
    ds_read_b128 v[48:51], v10 offset:53248
    v_mfma_f32_16x16x32_bf16 v[168:171], v[84:87], v[108:111], v[168:171]
    ds_read_b128 v[52:55], v11 offset:55296
    v_mfma_f32_16x16x32_bf16 v[172:175], v[88:91], v[108:111], v[172:175]
    ds_read_b128 v[56:59], v10 offset:57344
    v_mfma_f32_16x16x32_bf16 v[176:179], v[84:87], v[112:115], v[176:179]
    ds_read_b128 v[60:63], v11 offset:59392
    v_mfma_f32_16x16x32_bf16 v[180:183], v[88:91], v[112:115], v[180:183]
    ds_read_b128 v[64:67], v10 offset:61440
    v_mfma_f32_16x16x32_bf16 v[184:187], v[84:87], v[116:119], v[184:187]
    ds_read_b128 v[68:71], v11 offset:63488
    v_mfma_f32_16x16x32_bf16 v[188:191], v[88:91], v[116:119], v[188:191]
    ds_read_b128 v[72:75], v6 offset:18432
    v_mfma_f32_16x16x32_bf16 v[192:195], v[84:87], v[120:123], v[192:195]
    ds_read_b128 v[76:79], v7 offset:20480
    v_mfma_f32_16x16x32_bf16 v[196:199], v[88:91], v[120:123], v[196:199]
    ds_read_b128 v[80:83], v6 offset:22528
    v_mfma_f32_16x16x32_bf16 v[200:203], v[84:87], v[124:127], v[200:203]
    v_mfma_f32_16x16x32_bf16 v[204:207], v[88:91], v[124:127], v[204:207]
    v_mfma_f32_16x16x32_bf16 v[208:211], v[84:87], v[128:131], v[208:211]
    v_mfma_f32_16x16x32_bf16 v[212:215], v[88:91], v[128:131], v[212:215]
    v_mfma_f32_16x16x32_bf16 v[216:219], v[84:87], v[132:135], v[216:219]
    v_mfma_f32_16x16x32_bf16 v[220:223], v[88:91], v[132:135], v[220:223]
    s_waitcnt lgkmcnt(11)
    v_mfma_f32_16x16x32_bf16 v[136:139], v[32:35], v[40:43], v[136:139]
    ds_read_b128 v[84:87], v4 offset:49152
    s_waitcnt lgkmcnt(11)
    v_mfma_f32_16x16x32_bf16 v[140:143], v[36:39], v[40:43], v[140:143]
    ds_read_b128 v[92:95], v12 offset:49152
    s_waitcnt lgkmcnt(11)
    v_mfma_f32_16x16x32_bf16 v[144:147], v[32:35], v[44:47], v[144:147]
    ds_read_b128 v[88:91], v5 offset:49152
    v_mfma_f32_16x16x32_bf16 v[148:151], v[36:39], v[44:47], v[148:151]
    ds_read_b128 v[96:99], v13 offset:51200
    s_waitcnt lgkmcnt(12)
    v_mfma_f32_16x16x32_bf16 v[152:155], v[32:35], v[48:51], v[152:155]
    ds_read_b128 v[100:103], v12 offset:53248
    v_mfma_f32_16x16x32_bf16 v[156:159], v[36:39], v[48:51], v[156:159]
    ds_read_b128 v[104:107], v13 offset:55296
    s_waitcnt lgkmcnt(13)
    v_mfma_f32_16x16x32_bf16 v[160:163], v[32:35], v[52:55], v[160:163]
    ds_read_b128 v[108:111], v12 offset:57344
    v_mfma_f32_16x16x32_bf16 v[164:167], v[36:39], v[52:55], v[164:167]
    ds_read_b128 v[112:115], v13 offset:59392
    s_waitcnt lgkmcnt(14)
    v_mfma_f32_16x16x32_bf16 v[168:171], v[32:35], v[56:59], v[168:171]
    ds_read_b128 v[116:119], v12 offset:61440
    v_mfma_f32_16x16x32_bf16 v[172:175], v[36:39], v[56:59], v[172:175]
    ds_read_b128 v[120:123], v13 offset:63488
    s_waitcnt lgkmcnt(15)
    v_mfma_f32_16x16x32_bf16 v[176:179], v[32:35], v[60:63], v[176:179]
    ds_read_b128 v[124:127], v8 offset:18432
    v_mfma_f32_16x16x32_bf16 v[180:183], v[36:39], v[60:63], v[180:183]
    ds_read_b128 v[128:131], v9 offset:20480
    s_waitcnt lgkmcnt(15)
    v_mfma_f32_16x16x32_bf16 v[184:187], v[32:35], v[64:67], v[184:187]
    ds_read_b128 v[132:135], v8 offset:22528
    v_mfma_f32_16x16x32_bf16 v[188:191], v[36:39], v[64:67], v[188:191]
    v_mfma_f32_16x16x32_bf16 v[192:195], v[32:35], v[68:71], v[192:195]
    v_mfma_f32_16x16x32_bf16 v[196:199], v[36:39], v[68:71], v[196:199]
    s_waitcnt lgkmcnt(15)
    v_mfma_f32_16x16x32_bf16 v[200:203], v[32:35], v[72:75], v[200:203]
    v_mfma_f32_16x16x32_bf16 v[204:207], v[36:39], v[72:75], v[204:207]
    s_waitcnt lgkmcnt(14)
    v_mfma_f32_16x16x32_bf16 v[208:211], v[32:35], v[76:79], v[208:211]
    v_mfma_f32_16x16x32_bf16 v[212:215], v[36:39], v[76:79], v[212:215]
    s_waitcnt lgkmcnt(13)
    v_mfma_f32_16x16x32_bf16 v[216:219], v[32:35], v[80:83], v[216:219]
    v_mfma_f32_16x16x32_bf16 v[220:223], v[36:39], v[80:83], v[220:223]
    s_waitcnt lgkmcnt(11)
    v_mfma_f32_16x16x32_bf16 v[136:139], v[84:87], v[92:95], v[136:139]
    s_waitcnt lgkmcnt(10)
    v_mfma_f32_16x16x32_bf16 v[140:143], v[88:91], v[92:95], v[140:143]
    s_waitcnt lgkmcnt(9)
    v_mfma_f32_16x16x32_bf16 v[144:147], v[84:87], v[96:99], v[144:147]
    v_mfma_f32_16x16x32_bf16 v[148:151], v[88:91], v[96:99], v[148:151]
    s_waitcnt lgkmcnt(0)
    s_barrier
    ds_read_b128 v[32:35], v2 offset:0
    v_mfma_f32_16x16x32_bf16 v[152:155], v[84:87], v[100:103], v[152:155]
    ds_read_b128 v[40:43], v10 offset:0
    v_mfma_f32_16x16x32_bf16 v[156:159], v[88:91], v[100:103], v[156:159]
    ds_read_b128 v[36:39], v3 offset:0
    v_mfma_f32_16x16x32_bf16 v[160:163], v[84:87], v[104:107], v[160:163]
    ds_read_b128 v[44:47], v11 offset:2048
    v_mfma_f32_16x16x32_bf16 v[164:167], v[88:91], v[104:107], v[164:167]
    ds_read_b128 v[48:51], v10 offset:4096
    v_mfma_f32_16x16x32_bf16 v[168:171], v[84:87], v[108:111], v[168:171]
    ds_read_b128 v[52:55], v11 offset:6144
    v_mfma_f32_16x16x32_bf16 v[172:175], v[88:91], v[108:111], v[172:175]
    ds_read_b128 v[56:59], v10 offset:8192
    v_mfma_f32_16x16x32_bf16 v[176:179], v[84:87], v[112:115], v[176:179]
    ds_read_b128 v[60:63], v11 offset:10240
    v_mfma_f32_16x16x32_bf16 v[180:183], v[88:91], v[112:115], v[180:183]
    ds_read_b128 v[64:67], v10 offset:12288
    v_mfma_f32_16x16x32_bf16 v[184:187], v[84:87], v[116:119], v[184:187]
    ds_read_b128 v[68:71], v11 offset:14336
    v_mfma_f32_16x16x32_bf16 v[188:191], v[88:91], v[116:119], v[188:191]
    ds_read_b128 v[72:75], v6 offset:0
    v_mfma_f32_16x16x32_bf16 v[192:195], v[84:87], v[120:123], v[192:195]
    ds_read_b128 v[76:79], v7 offset:2048
    v_mfma_f32_16x16x32_bf16 v[196:199], v[88:91], v[120:123], v[196:199]
    ds_read_b128 v[80:83], v6 offset:4096
    v_mfma_f32_16x16x32_bf16 v[200:203], v[84:87], v[124:127], v[200:203]
    v_mfma_f32_16x16x32_bf16 v[204:207], v[88:91], v[124:127], v[204:207]
    v_mfma_f32_16x16x32_bf16 v[208:211], v[84:87], v[128:131], v[208:211]
    v_mfma_f32_16x16x32_bf16 v[212:215], v[88:91], v[128:131], v[212:215]
    v_mfma_f32_16x16x32_bf16 v[216:219], v[84:87], v[132:135], v[216:219]
    v_mfma_f32_16x16x32_bf16 v[220:223], v[88:91], v[132:135], v[220:223]
    s_waitcnt lgkmcnt(11)
    v_mfma_f32_16x16x32_bf16 v[136:139], v[32:35], v[40:43], v[136:139]
    ds_read_b128 v[84:87], v4 offset:0
    s_waitcnt lgkmcnt(11)
    v_mfma_f32_16x16x32_bf16 v[140:143], v[36:39], v[40:43], v[140:143]
    ds_read_b128 v[92:95], v12 offset:0
    s_waitcnt lgkmcnt(11)
    v_mfma_f32_16x16x32_bf16 v[144:147], v[32:35], v[44:47], v[144:147]
    ds_read_b128 v[88:91], v5 offset:0
    v_mfma_f32_16x16x32_bf16 v[148:151], v[36:39], v[44:47], v[148:151]
    ds_read_b128 v[96:99], v13 offset:2048
    s_waitcnt lgkmcnt(12)
    v_mfma_f32_16x16x32_bf16 v[152:155], v[32:35], v[48:51], v[152:155]
    ds_read_b128 v[100:103], v12 offset:4096
    v_mfma_f32_16x16x32_bf16 v[156:159], v[36:39], v[48:51], v[156:159]
    ds_read_b128 v[104:107], v13 offset:6144
    s_waitcnt lgkmcnt(13)
    v_mfma_f32_16x16x32_bf16 v[160:163], v[32:35], v[52:55], v[160:163]
    ds_read_b128 v[108:111], v12 offset:8192
    v_mfma_f32_16x16x32_bf16 v[164:167], v[36:39], v[52:55], v[164:167]
    ds_read_b128 v[112:115], v13 offset:10240
    s_waitcnt lgkmcnt(14)
    v_mfma_f32_16x16x32_bf16 v[168:171], v[32:35], v[56:59], v[168:171]
    ds_read_b128 v[116:119], v12 offset:12288
    v_mfma_f32_16x16x32_bf16 v[172:175], v[36:39], v[56:59], v[172:175]
    ds_read_b128 v[120:123], v13 offset:14336
    s_waitcnt lgkmcnt(15)
    v_mfma_f32_16x16x32_bf16 v[176:179], v[32:35], v[60:63], v[176:179]
    ds_read_b128 v[124:127], v8 offset:0
    v_mfma_f32_16x16x32_bf16 v[180:183], v[36:39], v[60:63], v[180:183]
    ds_read_b128 v[128:131], v9 offset:2048
    s_waitcnt lgkmcnt(15)
    v_mfma_f32_16x16x32_bf16 v[184:187], v[32:35], v[64:67], v[184:187]
    ds_read_b128 v[132:135], v8 offset:4096
    v_mfma_f32_16x16x32_bf16 v[188:191], v[36:39], v[64:67], v[188:191]
    v_mfma_f32_16x16x32_bf16 v[192:195], v[32:35], v[68:71], v[192:195]
    v_mfma_f32_16x16x32_bf16 v[196:199], v[36:39], v[68:71], v[196:199]
    s_waitcnt lgkmcnt(15)
    v_mfma_f32_16x16x32_bf16 v[200:203], v[32:35], v[72:75], v[200:203]
    v_mfma_f32_16x16x32_bf16 v[204:207], v[36:39], v[72:75], v[204:207]
    s_waitcnt lgkmcnt(14)
    v_mfma_f32_16x16x32_bf16 v[208:211], v[32:35], v[76:79], v[208:211]
    v_mfma_f32_16x16x32_bf16 v[212:215], v[36:39], v[76:79], v[212:215]
    s_waitcnt lgkmcnt(13)
    v_mfma_f32_16x16x32_bf16 v[216:219], v[32:35], v[80:83], v[216:219]
    v_mfma_f32_16x16x32_bf16 v[220:223], v[36:39], v[80:83], v[220:223]
    s_waitcnt lgkmcnt(11)
    v_mfma_f32_16x16x32_bf16 v[136:139], v[84:87], v[92:95], v[136:139]
    s_waitcnt lgkmcnt(10)
    v_mfma_f32_16x16x32_bf16 v[140:143], v[88:91], v[92:95], v[140:143]
    s_waitcnt lgkmcnt(9)
    v_mfma_f32_16x16x32_bf16 v[144:147], v[84:87], v[96:99], v[144:147]
    v_mfma_f32_16x16x32_bf16 v[148:151], v[88:91], v[96:99], v[148:151]
    s_waitcnt lgkmcnt(0)
    s_cmp_eq_u32 s19, 3
    s_cbranch_scc0 L_cab_ntl
    s_mov_b32 s3, 29097984
    buffer_load_dwordx4 v[20:23], v14, s[32:35], s3 offen
L_cab_ntl:
    s_barrier
    ds_read_b128 v[32:35], v2 offset:16384
    v_mfma_f32_16x16x32_bf16 v[152:155], v[84:87], v[100:103], v[152:155]
    ds_read_b128 v[40:43], v10 offset:16384
    v_mfma_f32_16x16x32_bf16 v[156:159], v[88:91], v[100:103], v[156:159]
    ds_read_b128 v[36:39], v3 offset:16384
    v_mfma_f32_16x16x32_bf16 v[160:163], v[84:87], v[104:107], v[160:163]
    ds_read_b128 v[44:47], v11 offset:18432
    v_mfma_f32_16x16x32_bf16 v[164:167], v[88:91], v[104:107], v[164:167]
    ds_read_b128 v[48:51], v10 offset:20480
    v_mfma_f32_16x16x32_bf16 v[168:171], v[84:87], v[108:111], v[168:171]
    ds_read_b128 v[52:55], v11 offset:22528
    v_mfma_f32_16x16x32_bf16 v[172:175], v[88:91], v[108:111], v[172:175]
    ds_read_b128 v[56:59], v10 offset:24576
    v_mfma_f32_16x16x32_bf16 v[176:179], v[84:87], v[112:115], v[176:179]
    ds_read_b128 v[60:63], v11 offset:26624
    v_mfma_f32_16x16x32_bf16 v[180:183], v[88:91], v[112:115], v[180:183]
    ds_read_b128 v[64:67], v10 offset:28672
    v_mfma_f32_16x16x32_bf16 v[184:187], v[84:87], v[116:119], v[184:187]
    ds_read_b128 v[68:71], v11 offset:30720
    v_mfma_f32_16x16x32_bf16 v[188:191], v[88:91], v[116:119], v[188:191]
    ds_read_b128 v[72:75], v6 offset:6144
    v_mfma_f32_16x16x32_bf16 v[192:195], v[84:87], v[120:123], v[192:195]
    ds_read_b128 v[76:79], v7 offset:8192
    v_mfma_f32_16x16x32_bf16 v[196:199], v[88:91], v[120:123], v[196:199]
    ds_read_b128 v[80:83], v6 offset:10240
    v_mfma_f32_16x16x32_bf16 v[200:203], v[84:87], v[124:127], v[200:203]
    v_mfma_f32_16x16x32_bf16 v[204:207], v[88:91], v[124:127], v[204:207]
    v_mfma_f32_16x16x32_bf16 v[208:211], v[84:87], v[128:131], v[208:211]
    v_mfma_f32_16x16x32_bf16 v[212:215], v[88:91], v[128:131], v[212:215]
    v_mfma_f32_16x16x32_bf16 v[216:219], v[84:87], v[132:135], v[216:219]
    v_mfma_f32_16x16x32_bf16 v[220:223], v[88:91], v[132:135], v[220:223]
    s_waitcnt lgkmcnt(11)
    v_mfma_f32_16x16x32_bf16 v[136:139], v[32:35], v[40:43], v[136:139]
    ds_read_b128 v[84:87], v4 offset:16384
    s_waitcnt lgkmcnt(11)
    v_mfma_f32_16x16x32_bf16 v[140:143], v[36:39], v[40:43], v[140:143]
    ds_read_b128 v[92:95], v12 offset:16384
    s_waitcnt lgkmcnt(11)
    v_mfma_f32_16x16x32_bf16 v[144:147], v[32:35], v[44:47], v[144:147]
    ds_read_b128 v[88:91], v5 offset:16384
    v_mfma_f32_16x16x32_bf16 v[148:151], v[36:39], v[44:47], v[148:151]
    ds_read_b128 v[96:99], v13 offset:18432
    s_waitcnt lgkmcnt(12)
    v_mfma_f32_16x16x32_bf16 v[152:155], v[32:35], v[48:51], v[152:155]
    ds_read_b128 v[100:103], v12 offset:20480
    v_mfma_f32_16x16x32_bf16 v[156:159], v[36:39], v[48:51], v[156:159]
    ds_read_b128 v[104:107], v13 offset:22528
    s_waitcnt lgkmcnt(13)
    v_mfma_f32_16x16x32_bf16 v[160:163], v[32:35], v[52:55], v[160:163]
    ds_read_b128 v[108:111], v12 offset:24576
    v_mfma_f32_16x16x32_bf16 v[164:167], v[36:39], v[52:55], v[164:167]
    ds_read_b128 v[112:115], v13 offset:26624
    s_waitcnt lgkmcnt(14)
    v_mfma_f32_16x16x32_bf16 v[168:171], v[32:35], v[56:59], v[168:171]
    ds_read_b128 v[116:119], v12 offset:28672
    v_mfma_f32_16x16x32_bf16 v[172:175], v[36:39], v[56:59], v[172:175]
    ds_read_b128 v[120:123], v13 offset:30720
    s_waitcnt lgkmcnt(15)
    v_mfma_f32_16x16x32_bf16 v[176:179], v[32:35], v[60:63], v[176:179]
    ds_read_b128 v[124:127], v8 offset:6144
    v_mfma_f32_16x16x32_bf16 v[180:183], v[36:39], v[60:63], v[180:183]
    ds_read_b128 v[128:131], v9 offset:8192
    s_waitcnt lgkmcnt(15)
    v_mfma_f32_16x16x32_bf16 v[184:187], v[32:35], v[64:67], v[184:187]
    ds_read_b128 v[132:135], v8 offset:10240
    v_mfma_f32_16x16x32_bf16 v[188:191], v[36:39], v[64:67], v[188:191]
    v_mfma_f32_16x16x32_bf16 v[192:195], v[32:35], v[68:71], v[192:195]
    v_mfma_f32_16x16x32_bf16 v[196:199], v[36:39], v[68:71], v[196:199]
    s_waitcnt lgkmcnt(15)
    v_mfma_f32_16x16x32_bf16 v[200:203], v[32:35], v[72:75], v[200:203]
    v_mfma_f32_16x16x32_bf16 v[204:207], v[36:39], v[72:75], v[204:207]
    s_waitcnt lgkmcnt(14)
    v_mfma_f32_16x16x32_bf16 v[208:211], v[32:35], v[76:79], v[208:211]
    v_mfma_f32_16x16x32_bf16 v[212:215], v[36:39], v[76:79], v[212:215]
    s_waitcnt lgkmcnt(13)
    v_mfma_f32_16x16x32_bf16 v[216:219], v[32:35], v[80:83], v[216:219]
    v_mfma_f32_16x16x32_bf16 v[220:223], v[36:39], v[80:83], v[220:223]
    s_waitcnt lgkmcnt(11)
    v_mfma_f32_16x16x32_bf16 v[136:139], v[84:87], v[92:95], v[136:139]
    s_waitcnt lgkmcnt(10)
    v_mfma_f32_16x16x32_bf16 v[140:143], v[88:91], v[92:95], v[140:143]
    s_waitcnt lgkmcnt(9)
    v_mfma_f32_16x16x32_bf16 v[144:147], v[84:87], v[96:99], v[144:147]
    v_mfma_f32_16x16x32_bf16 v[148:151], v[88:91], v[96:99], v[148:151]
    s_waitcnt lgkmcnt(0)
    s_cmp_eq_u32 s19, 3
    s_cbranch_scc0 L_cab_nrk
    s_mov_b32 s18, 131072
L_cab_rk0:
    s_waitcnt vmcnt(0)
    v_min_u32 v24, v20, v21
    v_min3_u32 v24, v24, v22, v23
    v_cmp_eq_u32 vcc, 0, v24
    s_sub_u32 s18, s18, 1
    s_cmp_eq_u64 vcc, 0
    s_cbranch_scc1 L_cab_rk1
    s_cmp_le_i32 s18, 0
    s_cbranch_scc1 L_cab_rk1
    s_sleep 2
    s_mov_b32 s3, 29097984
    buffer_load_dwordx4 v[20:23], v14, s[32:35], s3 offen sc1
    s_branch L_cab_rk0
L_cab_rk1:
    s_mov_b32 s66, 0
    s_mov_b32 s48, 0
    s_mov_b32 s49, 0
    s_lshr_b32 s18, s65, 8
    v_lshl_add_u32 v24, v20, 8, v28
    v_cmp_gt_u32 s[50:51], s18, v20
    v_add_u32 v24, 0, v24
    v_cmp_eq_u32 s[52:53], s18, v20
    v_cmp_gt_u32 vcc, s65, v24
    s_bcnt1_i32_b64 s3, s[50:51]
    s_add_u32 s48, s48, s3
    s_bcnt1_i32_b64 s3, s[52:53]
    s_add_u32 s49, s49, s3
    s_bcnt1_i32_b64 s3, vcc
    s_add_u32 s66, s66, s3
    v_lshl_add_u32 v24, v21, 8, v28
    v_cmp_gt_u32 s[50:51], s18, v21
    v_add_u32 v24, 1, v24
    v_cmp_eq_u32 s[52:53], s18, v21
    v_cmp_gt_u32 vcc, s65, v24
    s_bcnt1_i32_b64 s3, s[50:51]
    s_add_u32 s48, s48, s3
    s_bcnt1_i32_b64 s3, s[52:53]
    s_add_u32 s49, s49, s3
    s_bcnt1_i32_b64 s3, vcc
    s_add_u32 s66, s66, s3
    v_lshl_add_u32 v24, v22, 8, v28
    v_cmp_gt_u32 s[50:51], s18, v22
    v_add_u32 v24, 2, v24
    v_cmp_eq_u32 s[52:53], s18, v22
    v_cmp_gt_u32 vcc, s65, v24
    s_bcnt1_i32_b64 s3, s[50:51]
    s_add_u32 s48, s48, s3
    s_bcnt1_i32_b64 s3, s[52:53]
    s_add_u32 s49, s49, s3
    s_bcnt1_i32_b64 s3, vcc
    s_add_u32 s66, s66, s3
    v_lshl_add_u32 v24, v23, 8, v28
    v_cmp_gt_u32 s[50:51], s18, v23
    v_add_u32 v24, 3, v24
    v_cmp_eq_u32 s[52:53], s18, v23
    v_cmp_gt_u32 vcc, s65, v24
    s_bcnt1_i32_b64 s3, s[50:51]
    s_add_u32 s48, s48, s3
    s_bcnt1_i32_b64 s3, s[52:53]
    s_add_u32 s49, s49, s3
    s_bcnt1_i32_b64 s3, vcc
    s_add_u32 s66, s66, s3
    s_and_b32 s48, s48, 31
    s_xor_b32 s49, s49, 32
    s_or_b32 s48, s48, s49
    s_cmp_eq_u32 s48, 0
    s_cselect_b32 s3, 0, 0
    s_or_b32 s66, s66, s3
    v_mov_b32 v20, s66
    v_mov_b32 v21, 0
    v_mov_b32 v22, 0
    v_mov_b32 v23, 0
    v_mov_b32 v24, 158208
    ds_write_b128 v24, v[20:23]
    s_waitcnt lgkmcnt(0)
L_cab_nrk:
    s_barrier
    ds_read_b128 v[32:35], v2 offset:32768
    v_mfma_f32_16x16x32_bf16 v[152:155], v[84:87], v[100:103], v[152:155]
    ds_read_b128 v[40:43], v10 offset:32768
    v_mfma_f32_16x16x32_bf16 v[156:159], v[88:91], v[100:103], v[156:159]
    ds_read_b128 v[36:39], v3 offset:32768
    v_mfma_f32_16x16x32_bf16 v[160:163], v[84:87], v[104:107], v[160:163]
    ds_read_b128 v[44:47], v11 offset:34816
    v_mfma_f32_16x16x32_bf16 v[164:167], v[88:91], v[104:107], v[164:167]
    ds_read_b128 v[48:51], v10 offset:36864
    v_mfma_f32_16x16x32_bf16 v[168:171], v[84:87], v[108:111], v[168:171]
    ds_read_b128 v[52:55], v11 offset:38912
    v_mfma_f32_16x16x32_bf16 v[172:175], v[88:91], v[108:111], v[172:175]
    ds_read_b128 v[56:59], v10 offset:40960
    v_mfma_f32_16x16x32_bf16 v[176:179], v[84:87], v[112:115], v[176:179]
    ds_read_b128 v[60:63], v11 offset:43008
    v_mfma_f32_16x16x32_bf16 v[180:183], v[88:91], v[112:115], v[180:183]
    ds_read_b128 v[64:67], v10 offset:45056
    v_mfma_f32_16x16x32_bf16 v[184:187], v[84:87], v[116:119], v[184:187]
    ds_read_b128 v[68:71], v11 offset:47104
    v_mfma_f32_16x16x32_bf16 v[188:191], v[88:91], v[116:119], v[188:191]
    ds_read_b128 v[72:75], v6 offset:12288
    v_mfma_f32_16x16x32_bf16 v[192:195], v[84:87], v[120:123], v[192:195]
    ds_read_b128 v[76:79], v7 offset:14336
    v_mfma_f32_16x16x32_bf16 v[196:199], v[88:91], v[120:123], v[196:199]
    ds_read_b128 v[80:83], v6 offset:16384
    v_mfma_f32_16x16x32_bf16 v[200:203], v[84:87], v[124:127], v[200:203]
    v_mfma_f32_16x16x32_bf16 v[204:207], v[88:91], v[124:127], v[204:207]
    v_mfma_f32_16x16x32_bf16 v[208:211], v[84:87], v[128:131], v[208:211]
    v_mfma_f32_16x16x32_bf16 v[212:215], v[88:91], v[128:131], v[212:215]
    v_mfma_f32_16x16x32_bf16 v[216:219], v[84:87], v[132:135], v[216:219]
    v_mfma_f32_16x16x32_bf16 v[220:223], v[88:91], v[132:135], v[220:223]
    s_waitcnt lgkmcnt(11)
    v_mfma_f32_16x16x32_bf16 v[136:139], v[32:35], v[40:43], v[136:139]
    ds_read_b128 v[84:87], v4 offset:32768
    s_waitcnt lgkmcnt(11)
    v_mfma_f32_16x16x32_bf16 v[140:143], v[36:39], v[40:43], v[140:143]
    ds_read_b128 v[92:95], v12 offset:32768
    s_waitcnt lgkmcnt(11)
    v_mfma_f32_16x16x32_bf16 v[144:147], v[32:35], v[44:47], v[144:147]
    ds_read_b128 v[88:91], v5 offset:32768
    v_mfma_f32_16x16x32_bf16 v[148:151], v[36:39], v[44:47], v[148:151]
    ds_read_b128 v[96:99], v13 offset:34816
    s_waitcnt lgkmcnt(12)
    v_mfma_f32_16x16x32_bf16 v[152:155], v[32:35], v[48:51], v[152:155]
    ds_read_b128 v[100:103], v12 offset:36864
    v_mfma_f32_16x16x32_bf16 v[156:159], v[36:39], v[48:51], v[156:159]
    ds_read_b128 v[104:107], v13 offset:38912
    s_waitcnt lgkmcnt(13)
    v_mfma_f32_16x16x32_bf16 v[160:163], v[32:35], v[52:55], v[160:163]
    ds_read_b128 v[108:111], v12 offset:40960
    v_mfma_f32_16x16x32_bf16 v[164:167], v[36:39], v[52:55], v[164:167]
    ds_read_b128 v[112:115], v13 offset:43008
    s_waitcnt lgkmcnt(14)
    v_mfma_f32_16x16x32_bf16 v[168:171], v[32:35], v[56:59], v[168:171]
    ds_read_b128 v[116:119], v12 offset:45056
    v_mfma_f32_16x16x32_bf16 v[172:175], v[36:39], v[56:59], v[172:175]
    ds_read_b128 v[120:123], v13 offset:47104
    s_waitcnt lgkmcnt(15)
    v_mfma_f32_16x16x32_bf16 v[176:179], v[32:35], v[60:63], v[176:179]
    ds_read_b128 v[124:127], v8 offset:12288
    v_mfma_f32_16x16x32_bf16 v[180:183], v[36:39], v[60:63], v[180:183]
    ds_read_b128 v[128:131], v9 offset:14336
    s_waitcnt lgkmcnt(15)
    v_mfma_f32_16x16x32_bf16 v[184:187], v[32:35], v[64:67], v[184:187]
    ds_read_b128 v[132:135], v8 offset:16384
    v_mfma_f32_16x16x32_bf16 v[188:191], v[36:39], v[64:67], v[188:191]
    v_mfma_f32_16x16x32_bf16 v[192:195], v[32:35], v[68:71], v[192:195]
    v_mfma_f32_16x16x32_bf16 v[196:199], v[36:39], v[68:71], v[196:199]
    s_waitcnt lgkmcnt(15)
    v_mfma_f32_16x16x32_bf16 v[200:203], v[32:35], v[72:75], v[200:203]
    v_mfma_f32_16x16x32_bf16 v[204:207], v[36:39], v[72:75], v[204:207]
    s_waitcnt lgkmcnt(14)
    v_mfma_f32_16x16x32_bf16 v[208:211], v[32:35], v[76:79], v[208:211]
    v_mfma_f32_16x16x32_bf16 v[212:215], v[36:39], v[76:79], v[212:215]
    s_waitcnt lgkmcnt(13)
    v_mfma_f32_16x16x32_bf16 v[216:219], v[32:35], v[80:83], v[216:219]
    v_mfma_f32_16x16x32_bf16 v[220:223], v[36:39], v[80:83], v[220:223]
    s_waitcnt lgkmcnt(11)
    v_mfma_f32_16x16x32_bf16 v[136:139], v[84:87], v[92:95], v[136:139]
    s_waitcnt lgkmcnt(10)
    v_mfma_f32_16x16x32_bf16 v[140:143], v[88:91], v[92:95], v[140:143]
    s_waitcnt lgkmcnt(9)
    v_mfma_f32_16x16x32_bf16 v[144:147], v[84:87], v[96:99], v[144:147]
    v_mfma_f32_16x16x32_bf16 v[148:151], v[88:91], v[96:99], v[148:151]
    s_waitcnt lgkmcnt(0)
    s_barrier
    ds_read_b128 v[32:35], v2 offset:49152
    v_mfma_f32_16x16x32_bf16 v[152:155], v[84:87], v[100:103], v[152:155]
    ds_read_b128 v[40:43], v10 offset:49152
    v_mfma_f32_16x16x32_bf16 v[156:159], v[88:91], v[100:103], v[156:159]
    ds_read_b128 v[36:39], v3 offset:49152
    v_mfma_f32_16x16x32_bf16 v[160:163], v[84:87], v[104:107], v[160:163]
    ds_read_b128 v[44:47], v11 offset:51200
    v_mfma_f32_16x16x32_bf16 v[164:167], v[88:91], v[104:107], v[164:167]
    ds_read_b128 v[48:51], v10 offset:53248
    v_mfma_f32_16x16x32_bf16 v[168:171], v[84:87], v[108:111], v[168:171]
    ds_read_b128 v[52:55], v11 offset:55296
    v_mfma_f32_16x16x32_bf16 v[172:175], v[88:91], v[108:111], v[172:175]
    ds_read_b128 v[56:59], v10 offset:57344
    v_mfma_f32_16x16x32_bf16 v[176:179], v[84:87], v[112:115], v[176:179]
    ds_read_b128 v[60:63], v11 offset:59392
    v_mfma_f32_16x16x32_bf16 v[180:183], v[88:91], v[112:115], v[180:183]
    ds_read_b128 v[64:67], v10 offset:61440
    v_mfma_f32_16x16x32_bf16 v[184:187], v[84:87], v[116:119], v[184:187]
    ds_read_b128 v[68:71], v11 offset:63488
    v_mfma_f32_16x16x32_bf16 v[188:191], v[88:91], v[116:119], v[188:191]
    ds_read_b128 v[72:75], v6 offset:18432
    v_mfma_f32_16x16x32_bf16 v[192:195], v[84:87], v[120:123], v[192:195]
    ds_read_b128 v[76:79], v7 offset:20480
    v_mfma_f32_16x16x32_bf16 v[196:199], v[88:91], v[120:123], v[196:199]
    ds_read_b128 v[80:83], v6 offset:22528
    v_mfma_f32_16x16x32_bf16 v[200:203], v[84:87], v[124:127], v[200:203]
    v_mfma_f32_16x16x32_bf16 v[204:207], v[88:91], v[124:127], v[204:207]
    v_mfma_f32_16x16x32_bf16 v[208:211], v[84:87], v[128:131], v[208:211]
    v_mfma_f32_16x16x32_bf16 v[212:215], v[88:91], v[128:131], v[212:215]
    v_mfma_f32_16x16x32_bf16 v[216:219], v[84:87], v[132:135], v[216:219]
    v_mfma_f32_16x16x32_bf16 v[220:223], v[88:91], v[132:135], v[220:223]
    s_waitcnt lgkmcnt(11)
    v_mfma_f32_16x16x32_bf16 v[136:139], v[32:35], v[40:43], v[136:139]
    ds_read_b128 v[84:87], v4 offset:49152
    s_waitcnt lgkmcnt(11)
    v_mfma_f32_16x16x32_bf16 v[140:143], v[36:39], v[40:43], v[140:143]
    ds_read_b128 v[92:95], v12 offset:49152
    s_waitcnt lgkmcnt(11)
    v_mfma_f32_16x16x32_bf16 v[144:147], v[32:35], v[44:47], v[144:147]
    ds_read_b128 v[88:91], v5 offset:49152
    v_mfma_f32_16x16x32_bf16 v[148:151], v[36:39], v[44:47], v[148:151]
    ds_read_b128 v[96:99], v13 offset:51200
    s_waitcnt lgkmcnt(12)
    v_mfma_f32_16x16x32_bf16 v[152:155], v[32:35], v[48:51], v[152:155]
    ds_read_b128 v[100:103], v12 offset:53248
    v_mfma_f32_16x16x32_bf16 v[156:159], v[36:39], v[48:51], v[156:159]
    ds_read_b128 v[104:107], v13 offset:55296
    s_waitcnt lgkmcnt(13)
    v_mfma_f32_16x16x32_bf16 v[160:163], v[32:35], v[52:55], v[160:163]
    ds_read_b128 v[108:111], v12 offset:57344
    v_mfma_f32_16x16x32_bf16 v[164:167], v[36:39], v[52:55], v[164:167]
    ds_read_b128 v[112:115], v13 offset:59392
    s_waitcnt lgkmcnt(14)
    v_mfma_f32_16x16x32_bf16 v[168:171], v[32:35], v[56:59], v[168:171]
    ds_read_b128 v[116:119], v12 offset:61440
    v_mfma_f32_16x16x32_bf16 v[172:175], v[36:39], v[56:59], v[172:175]
    ds_read_b128 v[120:123], v13 offset:63488
    s_waitcnt lgkmcnt(15)
    v_mfma_f32_16x16x32_bf16 v[176:179], v[32:35], v[60:63], v[176:179]
    ds_read_b128 v[124:127], v8 offset:18432
    v_mfma_f32_16x16x32_bf16 v[180:183], v[36:39], v[60:63], v[180:183]
    ds_read_b128 v[128:131], v9 offset:20480
    s_waitcnt lgkmcnt(15)
    v_mfma_f32_16x16x32_bf16 v[184:187], v[32:35], v[64:67], v[184:187]
    ds_read_b128 v[132:135], v8 offset:22528
    v_mfma_f32_16x16x32_bf16 v[188:191], v[36:39], v[64:67], v[188:191]
    v_mfma_f32_16x16x32_bf16 v[192:195], v[32:35], v[68:71], v[192:195]
    v_mfma_f32_16x16x32_bf16 v[196:199], v[36:39], v[68:71], v[196:199]
    s_waitcnt lgkmcnt(15)
    v_mfma_f32_16x16x32_bf16 v[200:203], v[32:35], v[72:75], v[200:203]
    v_mfma_f32_16x16x32_bf16 v[204:207], v[36:39], v[72:75], v[204:207]
    s_waitcnt lgkmcnt(14)
    v_mfma_f32_16x16x32_bf16 v[208:211], v[32:35], v[76:79], v[208:211]
    v_mfma_f32_16x16x32_bf16 v[212:215], v[36:39], v[76:79], v[212:215]
    s_waitcnt lgkmcnt(13)
    v_mfma_f32_16x16x32_bf16 v[216:219], v[32:35], v[80:83], v[216:219]
    v_mfma_f32_16x16x32_bf16 v[220:223], v[36:39], v[80:83], v[220:223]
    s_waitcnt lgkmcnt(11)
    v_mfma_f32_16x16x32_bf16 v[136:139], v[84:87], v[92:95], v[136:139]
    s_waitcnt lgkmcnt(10)
    v_mfma_f32_16x16x32_bf16 v[140:143], v[88:91], v[92:95], v[140:143]
    s_waitcnt lgkmcnt(9)
    v_mfma_f32_16x16x32_bf16 v[144:147], v[84:87], v[96:99], v[144:147]
    v_mfma_f32_16x16x32_bf16 v[148:151], v[88:91], v[96:99], v[148:151]
    s_waitcnt lgkmcnt(8)
    v_mfma_f32_16x16x32_bf16 v[152:155], v[84:87], v[100:103], v[152:155]
    v_mfma_f32_16x16x32_bf16 v[156:159], v[88:91], v[100:103], v[156:159]
    s_waitcnt lgkmcnt(7)
    v_mfma_f32_16x16x32_bf16 v[160:163], v[84:87], v[104:107], v[160:163]
    v_mfma_f32_16x16x32_bf16 v[164:167], v[88:91], v[104:107], v[164:167]
    s_waitcnt lgkmcnt(6)
    v_mfma_f32_16x16x32_bf16 v[168:171], v[84:87], v[108:111], v[168:171]
    v_mfma_f32_16x16x32_bf16 v[172:175], v[88:91], v[108:111], v[172:175]
    s_waitcnt lgkmcnt(5)
    v_mfma_f32_16x16x32_bf16 v[176:179], v[84:87], v[112:115], v[176:179]
    v_mfma_f32_16x16x32_bf16 v[180:183], v[88:91], v[112:115], v[180:183]
    s_waitcnt lgkmcnt(4)
    v_mfma_f32_16x16x32_bf16 v[184:187], v[84:87], v[116:119], v[184:187]
    v_mfma_f32_16x16x32_bf16 v[188:191], v[88:91], v[116:119], v[188:191]
    s_waitcnt lgkmcnt(3)
    v_mfma_f32_16x16x32_bf16 v[192:195], v[84:87], v[120:123], v[192:195]
    v_mfma_f32_16x16x32_bf16 v[196:199], v[88:91], v[120:123], v[196:199]
    s_waitcnt lgkmcnt(2)
    v_mfma_f32_16x16x32_bf16 v[200:203], v[84:87], v[124:127], v[200:203]
    v_mfma_f32_16x16x32_bf16 v[204:207], v[88:91], v[124:127], v[204:207]
    s_waitcnt lgkmcnt(1)
    v_mfma_f32_16x16x32_bf16 v[208:211], v[84:87], v[128:131], v[208:211]
    v_mfma_f32_16x16x32_bf16 v[212:215], v[88:91], v[128:131], v[212:215]
    s_waitcnt lgkmcnt(0)
    v_mfma_f32_16x16x32_bf16 v[216:219], v[84:87], v[132:135], v[216:219]
    v_mfma_f32_16x16x32_bf16 v[220:223], v[88:91], v[132:135], v[220:223]
    s_lshl_b32 s3, s19, 7
    s_add_u32 s3, s3, 155648
    v_lshl_add_u32 v28, v27, 5, s3
    v_lshlrev_b32 v25, 2, v26
    s_lshl_b32 s48, s60, 2
    s_add_u32 s48, s48, s19
    s_lshl_b32 s49, s48, 13
    s_mul_i32 s50, s62, 2097152
    s_add_u32 s50, s50, s49
    s_add_u32 s50, s50, 2097152
    s_waitcnt lgkmcnt(0)
    s_barrier
    ds_read_b128 v[32:35], v28 offset:0
    ds_read_b128 v[40:43], v28 offset:512
    ds_read_b128 v[36:39], v28 offset:16
    ds_read_b128 v[44:47], v28 offset:528
    v_add_u32 v25, 156672, v25
    ds_read_b32 v56, v25 offset:0
    ds_read_b32 v58, v25 offset:64
    ds_read_b32 v60, v25 offset:128
    ds_read_b32 v62, v25 offset:192
    ds_read_b32 v64, v25 offset:256
    ds_read_b32 v66, v25 offset:320
    ds_read_b32 v68, v25 offset:384
    ds_read_b32 v70, v25 offset:448
    ds_read_b32 v72, v25 offset:512
    ds_read_b32 v74, v25 offset:576
    ds_read_b32 v76, v25 offset:640
    s_waitcnt lgkmcnt(0)
    s_nop 4
    s_lshl_b32 s3, s62, 31
    v_xor_b32 v116, s3, v32
    v_xor_b32 v117, s3, v33
    v_xor_b32 v118, s3, v34
    v_xor_b32 v119, s3, v35
    v_xor_b32 v120, s3, v36
    v_xor_b32 v121, s3, v37
    v_xor_b32 v122, s3, v38
    v_xor_b32 v123, s3, v39
    s_add_u32 s3, s63, 0
    s_lshr_b32 s18, s3, 3
    s_lshl_b32 s18, s18, 19
    s_and_b32 s3, s3, 7
    s_lshl_b32 s3, s3, 10
    s_add_u32 s3, s3, s18
    s_add_u32 s3, s3, s50
    v_pk_fma_f32 v[136:137], v[40:41], v[56:57], v[136:137] op_sel_hi:[1,0,1] neg_lo:[0,1,0] neg_hi:[0,1,0]
    v_pk_fma_f32 v[138:139], v[42:43], v[56:57], v[138:139] op_sel_hi:[1,0,1] neg_lo:[0,1,0] neg_hi:[0,1,0]
    v_pk_fma_f32 v[140:141], v[44:45], v[56:57], v[140:141] op_sel_hi:[1,0,1] neg_lo:[0,1,0] neg_hi:[0,1,0]
    v_pk_fma_f32 v[142:143], v[46:47], v[56:57], v[142:143] op_sel_hi:[1,0,1] neg_lo:[0,1,0] neg_hi:[0,1,0]
    v_pk_mul_f32 v[136:137], v[136:137], v[116:117]
    v_pk_mul_f32 v[138:139], v[138:139], v[118:119]
    v_pk_mul_f32 v[140:141], v[140:141], v[120:121]
    v_pk_mul_f32 v[142:143], v[142:143], v[122:123]
    v_cvt_pk_bf16_f32 v136, v136, v137
    v_cvt_pk_bf16_f32 v137, v138, v139
    v_cvt_pk_bf16_f32 v138, v140, v141
    v_cvt_pk_bf16_f32 v139, v142, v143
    buffer_store_dwordx4 v[136:139], v14, s[32:35], s3 offen sc1
    s_add_u32 s3, s63, 1
    s_lshr_b32 s18, s3, 3
    s_lshl_b32 s18, s18, 19
    s_and_b32 s3, s3, 7
    s_lshl_b32 s3, s3, 10
    s_add_u32 s3, s3, s18
    s_add_u32 s3, s3, s50
    v_pk_fma_f32 v[144:145], v[40:41], v[58:59], v[144:145] op_sel_hi:[1,0,1] neg_lo:[0,1,0] neg_hi:[0,1,0]
    v_pk_fma_f32 v[146:147], v[42:43], v[58:59], v[146:147] op_sel_hi:[1,0,1] neg_lo:[0,1,0] neg_hi:[0,1,0]
    v_pk_fma_f32 v[148:149], v[44:45], v[58:59], v[148:149] op_sel_hi:[1,0,1] neg_lo:[0,1,0] neg_hi:[0,1,0]
    v_pk_fma_f32 v[150:151], v[46:47], v[58:59], v[150:151] op_sel_hi:[1,0,1] neg_lo:[0,1,0] neg_hi:[0,1,0]
    v_pk_mul_f32 v[144:145], v[144:145], v[116:117]
    v_pk_mul_f32 v[146:147], v[146:147], v[118:119]
    v_pk_mul_f32 v[148:149], v[148:149], v[120:121]
    v_pk_mul_f32 v[150:151], v[150:151], v[122:123]
    v_cvt_pk_bf16_f32 v144, v144, v145
    v_cvt_pk_bf16_f32 v145, v146, v147
    v_cvt_pk_bf16_f32 v146, v148, v149
    v_cvt_pk_bf16_f32 v147, v150, v151
    buffer_store_dwordx4 v[144:147], v14, s[32:35], s3 offen sc1
    s_add_u32 s3, s63, 2
    s_lshr_b32 s18, s3, 3
    s_lshl_b32 s18, s18, 19
    s_and_b32 s3, s3, 7
    s_lshl_b32 s3, s3, 10
    s_add_u32 s3, s3, s18
    s_add_u32 s3, s3, s50
    v_pk_fma_f32 v[152:153], v[40:41], v[60:61], v[152:153] op_sel_hi:[1,0,1] neg_lo:[0,1,0] neg_hi:[0,1,0]
    v_pk_fma_f32 v[154:155], v[42:43], v[60:61], v[154:155] op_sel_hi:[1,0,1] neg_lo:[0,1,0] neg_hi:[0,1,0]
    v_pk_fma_f32 v[156:157], v[44:45], v[60:61], v[156:157] op_sel_hi:[1,0,1] neg_lo:[0,1,0] neg_hi:[0,1,0]
    v_pk_fma_f32 v[158:159], v[46:47], v[60:61], v[158:159] op_sel_hi:[1,0,1] neg_lo:[0,1,0] neg_hi:[0,1,0]
    v_pk_mul_f32 v[152:153], v[152:153], v[116:117]
    v_pk_mul_f32 v[154:155], v[154:155], v[118:119]
    v_pk_mul_f32 v[156:157], v[156:157], v[120:121]
    v_pk_mul_f32 v[158:159], v[158:159], v[122:123]
    v_cvt_pk_bf16_f32 v152, v152, v153
    v_cvt_pk_bf16_f32 v153, v154, v155
    v_cvt_pk_bf16_f32 v154, v156, v157
    v_cvt_pk_bf16_f32 v155, v158, v159
    buffer_store_dwordx4 v[152:155], v14, s[32:35], s3 offen sc1
    s_add_u32 s3, s63, 3
    s_lshr_b32 s18, s3, 3
    s_lshl_b32 s18, s18, 19
    s_and_b32 s3, s3, 7
    s_lshl_b32 s3, s3, 10
    s_add_u32 s3, s3, s18
    s_add_u32 s3, s3, s50
    v_pk_fma_f32 v[160:161], v[40:41], v[62:63], v[160:161] op_sel_hi:[1,0,1] neg_lo:[0,1,0] neg_hi:[0,1,0]
    v_pk_fma_f32 v[162:163], v[42:43], v[62:63], v[162:163] op_sel_hi:[1,0,1] neg_lo:[0,1,0] neg_hi:[0,1,0]
    v_pk_fma_f32 v[164:165], v[44:45], v[62:63], v[164:165] op_sel_hi:[1,0,1] neg_lo:[0,1,0] neg_hi:[0,1,0]
    v_pk_fma_f32 v[166:167], v[46:47], v[62:63], v[166:167] op_sel_hi:[1,0,1] neg_lo:[0,1,0] neg_hi:[0,1,0]
    v_pk_mul_f32 v[160:161], v[160:161], v[116:117]
    v_pk_mul_f32 v[162:163], v[162:163], v[118:119]
    v_pk_mul_f32 v[164:165], v[164:165], v[120:121]
    v_pk_mul_f32 v[166:167], v[166:167], v[122:123]
    v_cvt_pk_bf16_f32 v160, v160, v161
    v_cvt_pk_bf16_f32 v161, v162, v163
    v_cvt_pk_bf16_f32 v162, v164, v165
    v_cvt_pk_bf16_f32 v163, v166, v167
    buffer_store_dwordx4 v[160:163], v14, s[32:35], s3 offen sc1
    s_add_u32 s3, s63, 4
    s_lshr_b32 s18, s3, 3
    s_lshl_b32 s18, s18, 19
    s_and_b32 s3, s3, 7
    s_lshl_b32 s3, s3, 10
    s_add_u32 s3, s3, s18
    s_add_u32 s3, s3, s50
    v_pk_fma_f32 v[168:169], v[40:41], v[64:65], v[168:169] op_sel_hi:[1,0,1] neg_lo:[0,1,0] neg_hi:[0,1,0]
    v_pk_fma_f32 v[170:171], v[42:43], v[64:65], v[170:171] op_sel_hi:[1,0,1] neg_lo:[0,1,0] neg_hi:[0,1,0]
    v_pk_fma_f32 v[172:173], v[44:45], v[64:65], v[172:173] op_sel_hi:[1,0,1] neg_lo:[0,1,0] neg_hi:[0,1,0]
    v_pk_fma_f32 v[174:175], v[46:47], v[64:65], v[174:175] op_sel_hi:[1,0,1] neg_lo:[0,1,0] neg_hi:[0,1,0]
    v_pk_mul_f32 v[168:169], v[168:169], v[116:117]
    v_pk_mul_f32 v[170:171], v[170:171], v[118:119]
    v_pk_mul_f32 v[172:173], v[172:173], v[120:121]
    v_pk_mul_f32 v[174:175], v[174:175], v[122:123]
    v_cvt_pk_bf16_f32 v168, v168, v169
    v_cvt_pk_bf16_f32 v169, v170, v171
    v_cvt_pk_bf16_f32 v170, v172, v173
    v_cvt_pk_bf16_f32 v171, v174, v175
    buffer_store_dwordx4 v[168:171], v14, s[32:35], s3 offen sc1
    s_add_u32 s3, s63, 5
    s_lshr_b32 s18, s3, 3
    s_lshl_b32 s18, s18, 19
    s_and_b32 s3, s3, 7
    s_lshl_b32 s3, s3, 10
    s_add_u32 s3, s3, s18
    s_add_u32 s3, s3, s50
    v_pk_fma_f32 v[176:177], v[40:41], v[66:67], v[176:177] op_sel_hi:[1,0,1] neg_lo:[0,1,0] neg_hi:[0,1,0]
    v_pk_fma_f32 v[178:179], v[42:43], v[66:67], v[178:179] op_sel_hi:[1,0,1] neg_lo:[0,1,0] neg_hi:[0,1,0]
    v_pk_fma_f32 v[180:181], v[44:45], v[66:67], v[180:181] op_sel_hi:[1,0,1] neg_lo:[0,1,0] neg_hi:[0,1,0]
    v_pk_fma_f32 v[182:183], v[46:47], v[66:67], v[182:183] op_sel_hi:[1,0,1] neg_lo:[0,1,0] neg_hi:[0,1,0]
    v_pk_mul_f32 v[176:177], v[176:177], v[116:117]
    v_pk_mul_f32 v[178:179], v[178:179], v[118:119]
    v_pk_mul_f32 v[180:181], v[180:181], v[120:121]
    v_pk_mul_f32 v[182:183], v[182:183], v[122:123]
    v_cvt_pk_bf16_f32 v176, v176, v177
    v_cvt_pk_bf16_f32 v177, v178, v179
    v_cvt_pk_bf16_f32 v178, v180, v181
    v_cvt_pk_bf16_f32 v179, v182, v183
    buffer_store_dwordx4 v[176:179], v14, s[32:35], s3 offen sc1
    s_add_u32 s3, s63, 6
    s_lshr_b32 s18, s3, 3
    s_lshl_b32 s18, s18, 19
    s_and_b32 s3, s3, 7
    s_lshl_b32 s3, s3, 10
    s_add_u32 s3, s3, s18
    s_add_u32 s3, s3, s50
    v_pk_fma_f32 v[184:185], v[40:41], v[68:69], v[184:185] op_sel_hi:[1,0,1] neg_lo:[0,1,0] neg_hi:[0,1,0]
    v_pk_fma_f32 v[186:187], v[42:43], v[68:69], v[186:187] op_sel_hi:[1,0,1] neg_lo:[0,1,0] neg_hi:[0,1,0]
    v_pk_fma_f32 v[188:189], v[44:45], v[68:69], v[188:189] op_sel_hi:[1,0,1] neg_lo:[0,1,0] neg_hi:[0,1,0]
    v_pk_fma_f32 v[190:191], v[46:47], v[68:69], v[190:191] op_sel_hi:[1,0,1] neg_lo:[0,1,0] neg_hi:[0,1,0]
    v_pk_mul_f32 v[184:185], v[184:185], v[116:117]
    v_pk_mul_f32 v[186:187], v[186:187], v[118:119]
    v_pk_mul_f32 v[188:189], v[188:189], v[120:121]
    v_pk_mul_f32 v[190:191], v[190:191], v[122:123]
    v_cvt_pk_bf16_f32 v184, v184, v185
    v_cvt_pk_bf16_f32 v185, v186, v187
    v_cvt_pk_bf16_f32 v186, v188, v189
    v_cvt_pk_bf16_f32 v187, v190, v191
    buffer_store_dwordx4 v[184:187], v14, s[32:35], s3 offen sc1
    s_add_u32 s3, s63, 7
    s_lshr_b32 s18, s3, 3
    s_lshl_b32 s18, s18, 19
    s_and_b32 s3, s3, 7
    s_lshl_b32 s3, s3, 10
    s_add_u32 s3, s3, s18
    s_add_u32 s3, s3, s50
    v_pk_fma_f32 v[192:193], v[40:41], v[70:71], v[192:193] op_sel_hi:[1,0,1] neg_lo:[0,1,0] neg_hi:[0,1,0]
    v_pk_fma_f32 v[194:195], v[42:43], v[70:71], v[194:195] op_sel_hi:[1,0,1] neg_lo:[0,1,0] neg_hi:[0,1,0]
    v_pk_fma_f32 v[196:197], v[44:45], v[70:71], v[196:197] op_sel_hi:[1,0,1] neg_lo:[0,1,0] neg_hi:[0,1,0]
    v_pk_fma_f32 v[198:199], v[46:47], v[70:71], v[198:199] op_sel_hi:[1,0,1] neg_lo:[0,1,0] neg_hi:[0,1,0]
    v_pk_mul_f32 v[192:193], v[192:193], v[116:117]
    v_pk_mul_f32 v[194:195], v[194:195], v[118:119]
    v_pk_mul_f32 v[196:197], v[196:197], v[120:121]
    v_pk_mul_f32 v[198:199], v[198:199], v[122:123]
    v_cvt_pk_bf16_f32 v192, v192, v193
    v_cvt_pk_bf16_f32 v193, v194, v195
    v_cvt_pk_bf16_f32 v194, v196, v197
    v_cvt_pk_bf16_f32 v195, v198, v199
    buffer_store_dwordx4 v[192:195], v14, s[32:35], s3 offen sc1
    s_add_u32 s3, s63, 8
    s_lshr_b32 s18, s3, 3
    s_lshl_b32 s18, s18, 19
    s_and_b32 s3, s3, 7
    s_lshl_b32 s3, s3, 10
    s_add_u32 s3, s3, s18
    s_add_u32 s3, s3, s50
    v_pk_fma_f32 v[200:201], v[40:41], v[72:73], v[200:201] op_sel_hi:[1,0,1] neg_lo:[0,1,0] neg_hi:[0,1,0]
    v_pk_fma_f32 v[202:203], v[42:43], v[72:73], v[202:203] op_sel_hi:[1,0,1] neg_lo:[0,1,0] neg_hi:[0,1,0]
    v_pk_fma_f32 v[204:205], v[44:45], v[72:73], v[204:205] op_sel_hi:[1,0,1] neg_lo:[0,1,0] neg_hi:[0,1,0]
    v_pk_fma_f32 v[206:207], v[46:47], v[72:73], v[206:207] op_sel_hi:[1,0,1] neg_lo:[0,1,0] neg_hi:[0,1,0]
    v_pk_mul_f32 v[200:201], v[200:201], v[116:117]
    v_pk_mul_f32 v[202:203], v[202:203], v[118:119]
    v_pk_mul_f32 v[204:205], v[204:205], v[120:121]
    v_pk_mul_f32 v[206:207], v[206:207], v[122:123]
    v_cvt_pk_bf16_f32 v200, v200, v201
    v_cvt_pk_bf16_f32 v201, v202, v203
    v_cvt_pk_bf16_f32 v202, v204, v205
    v_cvt_pk_bf16_f32 v203, v206, v207
    buffer_store_dwordx4 v[200:203], v14, s[32:35], s3 offen sc1
    s_add_u32 s3, s63, 9
    s_lshr_b32 s18, s3, 3
    s_lshl_b32 s18, s18, 19
    s_and_b32 s3, s3, 7
    s_lshl_b32 s3, s3, 10
    s_add_u32 s3, s3, s18
    s_add_u32 s3, s3, s50
    v_pk_fma_f32 v[208:209], v[40:41], v[74:75], v[208:209] op_sel_hi:[1,0,1] neg_lo:[0,1,0] neg_hi:[0,1,0]
    v_pk_fma_f32 v[210:211], v[42:43], v[74:75], v[210:211] op_sel_hi:[1,0,1] neg_lo:[0,1,0] neg_hi:[0,1,0]
    v_pk_fma_f32 v[212:213], v[44:45], v[74:75], v[212:213] op_sel_hi:[1,0,1] neg_lo:[0,1,0] neg_hi:[0,1,0]
    v_pk_fma_f32 v[214:215], v[46:47], v[74:75], v[214:215] op_sel_hi:[1,0,1] neg_lo:[0,1,0] neg_hi:[0,1,0]
    v_pk_mul_f32 v[208:209], v[208:209], v[116:117]
    v_pk_mul_f32 v[210:211], v[210:211], v[118:119]
    v_pk_mul_f32 v[212:213], v[212:213], v[120:121]
    v_pk_mul_f32 v[214:215], v[214:215], v[122:123]
    v_cvt_pk_bf16_f32 v208, v208, v209
    v_cvt_pk_bf16_f32 v209, v210, v211
    v_cvt_pk_bf16_f32 v210, v212, v213
    v_cvt_pk_bf16_f32 v211, v214, v215
    buffer_store_dwordx4 v[208:211], v14, s[32:35], s3 offen sc1
    s_add_u32 s3, s63, 10
    s_lshr_b32 s18, s3, 3
    s_lshl_b32 s18, s18, 19
    s_and_b32 s3, s3, 7
    s_lshl_b32 s3, s3, 10
    s_add_u32 s3, s3, s18
    s_add_u32 s3, s3, s50
    v_pk_fma_f32 v[216:217], v[40:41], v[76:77], v[216:217] op_sel_hi:[1,0,1] neg_lo:[0,1,0] neg_hi:[0,1,0]
    v_pk_fma_f32 v[218:219], v[42:43], v[76:77], v[218:219] op_sel_hi:[1,0,1] neg_lo:[0,1,0] neg_hi:[0,1,0]
    v_pk_fma_f32 v[220:221], v[44:45], v[76:77], v[220:221] op_sel_hi:[1,0,1] neg_lo:[0,1,0] neg_hi:[0,1,0]
    v_pk_fma_f32 v[222:223], v[46:47], v[76:77], v[222:223] op_sel_hi:[1,0,1] neg_lo:[0,1,0] neg_hi:[0,1,0]
    v_pk_mul_f32 v[216:217], v[216:217], v[116:117]
    v_pk_mul_f32 v[218:219], v[218:219], v[118:119]
    v_pk_mul_f32 v[220:221], v[220:221], v[120:121]
    v_pk_mul_f32 v[222:223], v[222:223], v[122:123]
    v_cvt_pk_bf16_f32 v216, v216, v217
    v_cvt_pk_bf16_f32 v217, v218, v219
    v_cvt_pk_bf16_f32 v218, v220, v221
    v_cvt_pk_bf16_f32 v219, v222, v223
    buffer_store_dwordx4 v[216:219], v14, s[32:35], s3 offen sc1
    v_mov_b32 v21, 158220
    v_mov_b32 v20, 2
    s_mov_b64 exec, 1
    ds_add_u32 v21, v20
    s_mov_b64 exec, -1
    v_mov_b32 v21, 158216
    v_mov_b32 v20, 1
    s_mov_b64 exec, 1
    s_waitcnt vmcnt(0)
    ds_add_rtn_u32 v20, v21, v20
    s_waitcnt lgkmcnt(0)
    v_readfirstlane_b32 s3, v20
    s_cmp_eq_u32 s3, 3
    s_cbranch_scc0 L_cab_fl
    buffer_store_dword v16, v252, s[32:35], 0 offen sc1
L_cab_fl:
    s_mov_b64 exec, -1
    s_mov_b64 exec, 1
    buffer_store_dword v16, v253, s[32:35], 0 offen offset:128 sc1
    s_mov_b64 exec, -1
L_c_p2:
    s_load_dwordx2 s[96:97], s[0:1], 80
    v_mov_b32 v8, 158208
    ds_read_b32 v9, v8
    s_and_b32 s56, s19, 1
    s_lshr_b32 s57, s19, 1
    v_bfe_u32 v17, v1, 1, 3
    v_xor_b32 v16, v27, v17
    s_lshl_b32 s3, s57, 16
    v_lshlrev_b32 v18, 7, v26
    v_add_u32 v18, s3, v18
    v_lshl_add_u32 v2, v16, 4, v18
    v_xor_b32 v3, 64, v2
    s_lshl_b32 s18, s56, 11
    s_add_u32 s3, s3, s18
    v_add_u32 v6, s3, v14
    s_lshl_b32 s3, s56, 12
    v_add_u32 v5, s3, v14
    v_add_u32 v4, 49152, v5
    s_mov_b32 s54, 0x24201c0c
    s_mov_b32 s55, 0x80008
    s_lshl_b32 s3, s57, 8
    s_add_u32 s3, s3, 159744
    v_lshl_add_u32 v7, v26, 1, s3
    ds_read_u16_d16_hi v240, v7 offset:0
    ds_read_u16_d16_hi v241, v7 offset:32
    ds_read_u16_d16_hi v242, v7 offset:64
    ds_read_u16_d16_hi v243, v7 offset:96
    ds_read_u16_d16_hi v244, v7 offset:128
    ds_read_u16_d16_hi v245, v7 offset:160
    ds_read_u16_d16_hi v246, v7 offset:192
    ds_read_u16_d16_hi v247, v7 offset:224
    s_waitcnt lgkmcnt(0)
    v_readfirstlane_b32 s66, v9
    s_mov_b32 s40, s96
    s_and_b32 s41, s97, 0xffff
    s_mov_b32 s42, 2097152
    s_mov_b32 s43, 0x00020000
    s_and_b32 s66, s66, 255
    s_and_b32 s87, s66, 31
    s_and_b32 s58, s66, 0x2f
    s_xor_b32 s58, s58, 0x20
    s_and_b32 s3, s66, 0x10
    s_lshl2_add_u32 s58, s3, s58
    s_and_b32 s3, s66, 0x40
    s_lshl1_add_u32 s58, s3, s58
    s_cmp_lt_u32 s66, 128
    s_cbranch_scc1 L_prm_3
    s_mul_i32 s3, s87, 37
    s_lshr_b32 s3, s3, 8
    s_mul_i32 s18, s3, 25
    s_add_u32 s58, s18, s87
    s_add_u32 s58, s58, 16
    s_bitcmp1_b32 s66, 5
    s_cselect_b32 s3, 0, 7
    s_add_u32 s58, s58, s3
    s_bitcmp1_b32 s66, 6
    s_cselect_b32 s3, 128, 0
    s_add_u32 s58, s58, s3
    s_lshl_b32 s18, s87, 5
    s_add_u32 s3, s3, s18
    s_add_u32 s3, s3, 4294966430
    s_bitcmp1_b32 s66, 5
    s_cselect_b32 s18, 0, 1
    s_add_u32 s3, s3, s18
    s_cmp_ge_u32 s87, 28
    s_cselect_b32 s58, s3, s58
L_prm_3:
    s_bfe_u32 s65, s58, 0x10005
    s_and_b32 s87, s58, 31
    s_bfe_u32 s84, s58, 0x10006
    s_lshr_b32 s85, s58, 7
    s_lshr_b32 s3, s87, 2
    s_lshl2_add_u32 s85, s85, s3
    s_and_b32 s86, s87, 3
    s_cmp_lt_u32 s87, 16
    s_cbranch_scc1 L_dec_4
    s_cmp_ge_u32 s87, 23
    s_cselect_b32 s3, 1, 0
    s_cselect_b32 s18, 23, 16
    s_lshr_b32 s85, s58, 5
    s_mov_b32 s65, s3
    s_sub_u32 s86, s87, s18
    s_and_b32 s3, s58, 1
    s_cmp_ge_u32 s87, 30
    s_cselect_b32 s84, 3, 2
    s_cselect_b32 s86, 7, s86
    s_cselect_b32 s65, s3, s65
L_dec_4:
    s_cmp_eq_u32 s84, 3
    s_cbranch_scc1 L_csp
    s_lshl1_add_u32 s3, s84, s65
    s_cmp_eq_u32 s3, 4
    s_cselect_b32 s3, 0xffff0000, 0
    v_and_b32 v112, s3, v240
    v_and_b32 v113, s3, v240
    v_and_b32 v128, s3, v241
    v_and_b32 v129, s3, v241
    v_and_b32 v144, s3, v242
    v_and_b32 v145, s3, v242
    v_and_b32 v160, s3, v243
    v_and_b32 v161, s3, v243
    v_and_b32 v176, s3, v244
    v_and_b32 v177, s3, v244
    v_and_b32 v192, s3, v245
    v_and_b32 v193, s3, v245
    v_and_b32 v208, s3, v246
    v_and_b32 v209, s3, v246
    v_and_b32 v224, s3, v247
    v_and_b32 v225, s3, v247
    v_pk_mov_b32 v[114:115], v[112:113], v[112:113]
    v_pk_mov_b32 v[116:117], v[112:113], v[112:113]
    v_pk_mov_b32 v[118:119], v[112:113], v[112:113]
    v_pk_mov_b32 v[120:121], v[112:113], v[112:113]
    v_pk_mov_b32 v[122:123], v[112:113], v[112:113]
    v_pk_mov_b32 v[124:125], v[112:113], v[112:113]
    v_pk_mov_b32 v[126:127], v[112:113], v[112:113]
    v_pk_mov_b32 v[130:131], v[128:129], v[128:129]
    v_pk_mov_b32 v[132:133], v[128:129], v[128:129]
    v_pk_mov_b32 v[134:135], v[128:129], v[128:129]
    v_pk_mov_b32 v[136:137], v[128:129], v[128:129]
    v_pk_mov_b32 v[138:139], v[128:129], v[128:129]
    v_pk_mov_b32 v[140:141], v[128:129], v[128:129]
    v_pk_mov_b32 v[142:143], v[128:129], v[128:129]
    v_pk_mov_b32 v[146:147], v[144:145], v[144:145]
    v_pk_mov_b32 v[148:149], v[144:145], v[144:145]
    v_pk_mov_b32 v[150:151], v[144:145], v[144:145]
    v_pk_mov_b32 v[152:153], v[144:145], v[144:145]
    v_pk_mov_b32 v[154:155], v[144:145], v[144:145]
    v_pk_mov_b32 v[156:157], v[144:145], v[144:145]
    v_pk_mov_b32 v[158:159], v[144:145], v[144:145]
    v_pk_mov_b32 v[162:163], v[160:161], v[160:161]
    v_pk_mov_b32 v[164:165], v[160:161], v[160:161]
    v_pk_mov_b32 v[166:167], v[160:161], v[160:161]
    v_pk_mov_b32 v[168:169], v[160:161], v[160:161]
    v_pk_mov_b32 v[170:171], v[160:161], v[160:161]
    v_pk_mov_b32 v[172:173], v[160:161], v[160:161]
    v_pk_mov_b32 v[174:175], v[160:161], v[160:161]
    v_pk_mov_b32 v[178:179], v[176:177], v[176:177]
    v_pk_mov_b32 v[180:181], v[176:177], v[176:177]
    v_pk_mov_b32 v[182:183], v[176:177], v[176:177]
    v_pk_mov_b32 v[184:185], v[176:177], v[176:177]
    v_pk_mov_b32 v[186:187], v[176:177], v[176:177]
    v_pk_mov_b32 v[188:189], v[176:177], v[176:177]
    v_pk_mov_b32 v[190:191], v[176:177], v[176:177]
    v_pk_mov_b32 v[194:195], v[192:193], v[192:193]
    v_pk_mov_b32 v[196:197], v[192:193], v[192:193]
    v_pk_mov_b32 v[198:199], v[192:193], v[192:193]
    v_pk_mov_b32 v[200:201], v[192:193], v[192:193]
    v_pk_mov_b32 v[202:203], v[192:193], v[192:193]
    v_pk_mov_b32 v[204:205], v[192:193], v[192:193]
    v_pk_mov_b32 v[206:207], v[192:193], v[192:193]
    v_pk_mov_b32 v[210:211], v[208:209], v[208:209]
    v_pk_mov_b32 v[212:213], v[208:209], v[208:209]
    v_pk_mov_b32 v[214:215], v[208:209], v[208:209]
    v_pk_mov_b32 v[216:217], v[208:209], v[208:209]
    v_pk_mov_b32 v[218:219], v[208:209], v[208:209]
    v_pk_mov_b32 v[220:221], v[208:209], v[208:209]
    v_pk_mov_b32 v[222:223], v[208:209], v[208:209]
    v_pk_mov_b32 v[226:227], v[224:225], v[224:225]
    v_pk_mov_b32 v[228:229], v[224:225], v[224:225]
    v_pk_mov_b32 v[230:231], v[224:225], v[224:225]
    v_pk_mov_b32 v[232:233], v[224:225], v[224:225]
    v_pk_mov_b32 v[234:235], v[224:225], v[224:225]
    v_pk_mov_b32 v[236:237], v[224:225], v[224:225]
    v_pk_mov_b32 v[238:239], v[224:225], v[224:225]
    s_lshl2_add_u32 s68, s58, s19
    s_lshl_b32 s68, s68, 7
    s_add_u32 s68, s68, 29130752
    s_lshl1_add_u32 s49, s84, s65
    s_mov_b32 s67, 1
    s_mul_i32 s49, s49, 16384
    s_add_u32 s49, s49, 33554432
    s_mul_i32 s3, s65, 28672
    s_add_u32 s3, s3, 41943040
    s_cmp_eq_u32 s84, 2
    s_cselect_b32 s49, s3, s49
    s_cselect_b32 s18, 56, 64
    s_lshl1_add_u32 s48, s85, s57
    s_lshl3_add_u32 s48, s48, 7
    s_mul_i32 s48, s48, s18
    s_lshl2_add_u32 s48, s86, s48
    s_lshl1_add_u32 s48, s56, s48
    s_lshl_b32 s48, s48, 10
    s_add_u32 s48, s48, s49
    s_lshl_b32 s49, s18, 10
    s_mov_b32 s69, 5
    s_barrier
    ds_read_b128 v[16:19], v4 offset:0
    ds_read_b128 v[32:35], v2 offset:0
    ds_read_b128 v[36:39], v2 offset:2048
    ds_read_b128 v[40:43], v2 offset:4096
    ds_read_b128 v[44:47], v2 offset:6144
    ds_read_b128 v[48:51], v2 offset:8192
    ds_read_b128 v[52:55], v2 offset:10240
    ds_read_b128 v[56:59], v2 offset:12288
    ds_read_b128 v[60:63], v2 offset:14336
    ds_read_b128 v[20:23], v4 offset:1024
    ds_read_b128 v[24:27], v4 offset:2048
    ds_read_b128 v[28:31], v4 offset:3072
L_cloop:
    s_waitcnt lgkmcnt(0)
    v_mfma_f32_16x16x32_bf16 v[112:115], v[16:19], v[32:35], v[112:115]
    ds_read_b128 v[64:67], v4 offset:8192
    v_mfma_f32_16x16x32_bf16 v[128:131], v[16:19], v[36:39], v[128:131]
    v_mfma_f32_16x16x32_bf16 v[144:147], v[16:19], v[40:43], v[144:147]
    ds_read_b128 v[80:83], v3 offset:0
    v_mfma_f32_16x16x32_bf16 v[160:163], v[16:19], v[44:47], v[160:163]
    v_mfma_f32_16x16x32_bf16 v[176:179], v[16:19], v[48:51], v[176:179]
    ds_read_b128 v[84:87], v3 offset:2048
    v_mfma_f32_16x16x32_bf16 v[192:195], v[16:19], v[52:55], v[192:195]
    v_mfma_f32_16x16x32_bf16 v[208:211], v[16:19], v[56:59], v[208:211]
    ds_read_b128 v[88:91], v3 offset:4096
    v_mfma_f32_16x16x32_bf16 v[224:227], v[16:19], v[60:63], v[224:227]
    v_mfma_f32_16x16x32_bf16 v[116:119], v[20:23], v[32:35], v[116:119]
    ds_read_b128 v[92:95], v3 offset:6144
    v_mfma_f32_16x16x32_bf16 v[132:135], v[20:23], v[36:39], v[132:135]
    v_mfma_f32_16x16x32_bf16 v[148:151], v[20:23], v[40:43], v[148:151]
    ds_read_b128 v[96:99], v3 offset:8192
    v_mfma_f32_16x16x32_bf16 v[164:167], v[20:23], v[44:47], v[164:167]
    v_mfma_f32_16x16x32_bf16 v[180:183], v[20:23], v[48:51], v[180:183]
    ds_read_b128 v[100:103], v3 offset:10240
    v_mfma_f32_16x16x32_bf16 v[196:199], v[20:23], v[52:55], v[196:199]
    v_mfma_f32_16x16x32_bf16 v[212:215], v[20:23], v[56:59], v[212:215]
    ds_read_b128 v[104:107], v3 offset:12288
    v_mfma_f32_16x16x32_bf16 v[228:231], v[20:23], v[60:63], v[228:231]
    v_mfma_f32_16x16x32_bf16 v[120:123], v[24:27], v[32:35], v[120:123]
    ds_read_b128 v[108:111], v3 offset:14336
    v_mfma_f32_16x16x32_bf16 v[136:139], v[24:27], v[36:39], v[136:139]
    v_mfma_f32_16x16x32_bf16 v[152:155], v[24:27], v[40:43], v[152:155]
    ds_read_b128 v[68:71], v4 offset:9216
    v_mfma_f32_16x16x32_bf16 v[168:171], v[24:27], v[44:47], v[168:171]
    v_mfma_f32_16x16x32_bf16 v[184:187], v[24:27], v[48:51], v[184:187]
    ds_read_b128 v[72:75], v4 offset:10240
    v_mfma_f32_16x16x32_bf16 v[200:203], v[24:27], v[52:55], v[200:203]
    v_mfma_f32_16x16x32_bf16 v[216:219], v[24:27], v[56:59], v[216:219]
    ds_read_b128 v[76:79], v4 offset:11264
    v_mfma_f32_16x16x32_bf16 v[232:235], v[24:27], v[60:63], v[232:235]
    v_mfma_f32_16x16x32_bf16 v[124:127], v[28:31], v[32:35], v[124:127]
    v_mfma_f32_16x16x32_bf16 v[140:143], v[28:31], v[36:39], v[140:143]
    v_mfma_f32_16x16x32_bf16 v[156:159], v[28:31], v[40:43], v[156:159]
    s_bfe_u32 s3, s54, s55
    s_add_u32 s55, s55, 8
    v_lshl_add_u32 v4, s3, 12, v5
    v_mfma_f32_16x16x32_bf16 v[172:175], v[28:31], v[44:47], v[172:175]
    v_mfma_f32_16x16x32_bf16 v[188:191], v[28:31], v[48:51], v[188:191]
    v_mfma_f32_16x16x32_bf16 v[204:207], v[28:31], v[52:55], v[204:207]
    v_mfma_f32_16x16x32_bf16 v[220:223], v[28:31], v[56:59], v[220:223]
    v_mfma_f32_16x16x32_bf16 v[236:239], v[28:31], v[60:63], v[236:239]
    s_waitcnt lgkmcnt(0)
    v_mfma_f32_16x16x32_bf16 v[112:115], v[64:67], v[80:83], v[112:115]
    v_mfma_f32_16x16x32_bf16 v[128:131], v[64:67], v[84:87], v[128:131]
    s_barrier
    v_mfma_f32_16x16x32_bf16 v[144:147], v[64:67], v[88:91], v[144:147]
    ds_read_b128 v[16:19], v4 offset:0
    v_mfma_f32_16x16x32_bf16 v[160:163], v[64:67], v[92:95], v[160:163]
    v_mfma_f32_16x16x32_bf16 v[176:179], v[64:67], v[96:99], v[176:179]
    ds_read_b128 v[32:35], v2 offset:16384
    v_mfma_f32_16x16x32_bf16 v[192:195], v[64:67], v[100:103], v[192:195]
    v_mfma_f32_16x16x32_bf16 v[208:211], v[64:67], v[104:107], v[208:211]
    ds_read_b128 v[36:39], v2 offset:18432
    v_mfma_f32_16x16x32_bf16 v[224:227], v[64:67], v[108:111], v[224:227]
    v_mfma_f32_16x16x32_bf16 v[116:119], v[68:71], v[80:83], v[116:119]
    ds_read_b128 v[40:43], v2 offset:20480
    v_mfma_f32_16x16x32_bf16 v[132:135], v[68:71], v[84:87], v[132:135]
    v_mfma_f32_16x16x32_bf16 v[148:151], v[68:71], v[88:91], v[148:151]
    ds_read_b128 v[44:47], v2 offset:22528
    v_mfma_f32_16x16x32_bf16 v[164:167], v[68:71], v[92:95], v[164:167]
    v_mfma_f32_16x16x32_bf16 v[180:183], v[68:71], v[96:99], v[180:183]
    ds_read_b128 v[48:51], v2 offset:24576
    v_mfma_f32_16x16x32_bf16 v[196:199], v[68:71], v[100:103], v[196:199]
    v_mfma_f32_16x16x32_bf16 v[212:215], v[68:71], v[104:107], v[212:215]
    ds_read_b128 v[52:55], v2 offset:26624
    v_mfma_f32_16x16x32_bf16 v[228:231], v[68:71], v[108:111], v[228:231]
    v_mfma_f32_16x16x32_bf16 v[120:123], v[72:75], v[80:83], v[120:123]
    ds_read_b128 v[56:59], v2 offset:28672
    v_mfma_f32_16x16x32_bf16 v[136:139], v[72:75], v[84:87], v[136:139]
    v_mfma_f32_16x16x32_bf16 v[152:155], v[72:75], v[88:91], v[152:155]
    ds_read_b128 v[60:63], v2 offset:30720
    v_mfma_f32_16x16x32_bf16 v[168:171], v[72:75], v[92:95], v[168:171]
    v_mfma_f32_16x16x32_bf16 v[184:187], v[72:75], v[96:99], v[184:187]
    ds_read_b128 v[20:23], v4 offset:1024
    v_mfma_f32_16x16x32_bf16 v[200:203], v[72:75], v[100:103], v[200:203]
    v_mfma_f32_16x16x32_bf16 v[216:219], v[72:75], v[104:107], v[216:219]
    ds_read_b128 v[24:27], v4 offset:2048
    v_mfma_f32_16x16x32_bf16 v[232:235], v[72:75], v[108:111], v[232:235]
    v_mfma_f32_16x16x32_bf16 v[124:127], v[76:79], v[80:83], v[124:127]
    ds_read_b128 v[28:31], v4 offset:3072
    v_mfma_f32_16x16x32_bf16 v[140:143], v[76:79], v[84:87], v[140:143]
    v_mfma_f32_16x16x32_bf16 v[156:159], v[76:79], v[88:91], v[156:159]
    v_mfma_f32_16x16x32_bf16 v[172:175], v[76:79], v[92:95], v[172:175]
    v_mfma_f32_16x16x32_bf16 v[188:191], v[76:79], v[96:99], v[188:191]
    v_mfma_f32_16x16x32_bf16 v[204:207], v[76:79], v[100:103], v[204:207]
    v_mfma_f32_16x16x32_bf16 v[220:223], v[76:79], v[104:107], v[220:223]
    v_mfma_f32_16x16x32_bf16 v[236:239], v[76:79], v[108:111], v[236:239]
    s_waitcnt lgkmcnt(0)
    v_mfma_f32_16x16x32_bf16 v[112:115], v[16:19], v[32:35], v[112:115]
    ds_read_b128 v[64:67], v4 offset:8192
    v_mfma_f32_16x16x32_bf16 v[128:131], v[16:19], v[36:39], v[128:131]
    v_mfma_f32_16x16x32_bf16 v[144:147], v[16:19], v[40:43], v[144:147]
    ds_read_b128 v[80:83], v3 offset:16384
    v_mfma_f32_16x16x32_bf16 v[160:163], v[16:19], v[44:47], v[160:163]
    v_mfma_f32_16x16x32_bf16 v[176:179], v[16:19], v[48:51], v[176:179]
    ds_read_b128 v[84:87], v3 offset:18432
    v_mfma_f32_16x16x32_bf16 v[192:195], v[16:19], v[52:55], v[192:195]
    v_mfma_f32_16x16x32_bf16 v[208:211], v[16:19], v[56:59], v[208:211]
    ds_read_b128 v[88:91], v3 offset:20480
    v_mfma_f32_16x16x32_bf16 v[224:227], v[16:19], v[60:63], v[224:227]
    v_mfma_f32_16x16x32_bf16 v[116:119], v[20:23], v[32:35], v[116:119]
    ds_read_b128 v[92:95], v3 offset:22528
    v_mfma_f32_16x16x32_bf16 v[132:135], v[20:23], v[36:39], v[132:135]
    v_mfma_f32_16x16x32_bf16 v[148:151], v[20:23], v[40:43], v[148:151]
    ds_read_b128 v[96:99], v3 offset:24576
    v_mfma_f32_16x16x32_bf16 v[164:167], v[20:23], v[44:47], v[164:167]
    v_mfma_f32_16x16x32_bf16 v[180:183], v[20:23], v[48:51], v[180:183]
    ds_read_b128 v[100:103], v3 offset:26624
    v_mfma_f32_16x16x32_bf16 v[196:199], v[20:23], v[52:55], v[196:199]
    v_mfma_f32_16x16x32_bf16 v[212:215], v[20:23], v[56:59], v[212:215]
    ds_read_b128 v[104:107], v3 offset:28672
    v_mfma_f32_16x16x32_bf16 v[228:231], v[20:23], v[60:63], v[228:231]
    v_mfma_f32_16x16x32_bf16 v[120:123], v[24:27], v[32:35], v[120:123]
    ds_read_b128 v[108:111], v3 offset:30720
    v_mfma_f32_16x16x32_bf16 v[136:139], v[24:27], v[36:39], v[136:139]
    v_mfma_f32_16x16x32_bf16 v[152:155], v[24:27], v[40:43], v[152:155]
    ds_read_b128 v[68:71], v4 offset:9216
    v_mfma_f32_16x16x32_bf16 v[168:171], v[24:27], v[44:47], v[168:171]
    v_mfma_f32_16x16x32_bf16 v[184:187], v[24:27], v[48:51], v[184:187]
    ds_read_b128 v[72:75], v4 offset:10240
    v_mfma_f32_16x16x32_bf16 v[200:203], v[24:27], v[52:55], v[200:203]
    v_mfma_f32_16x16x32_bf16 v[216:219], v[24:27], v[56:59], v[216:219]
    ds_read_b128 v[76:79], v4 offset:11264
    v_mfma_f32_16x16x32_bf16 v[232:235], v[24:27], v[60:63], v[232:235]
    v_mfma_f32_16x16x32_bf16 v[124:127], v[28:31], v[32:35], v[124:127]
    v_mfma_f32_16x16x32_bf16 v[140:143], v[28:31], v[36:39], v[140:143]
    v_mfma_f32_16x16x32_bf16 v[156:159], v[28:31], v[40:43], v[156:159]
    s_bfe_u32 s3, s54, s55
    s_add_u32 s55, s55, 8
    v_lshl_add_u32 v4, s3, 12, v5
    v_mfma_f32_16x16x32_bf16 v[172:175], v[28:31], v[44:47], v[172:175]
    v_mfma_f32_16x16x32_bf16 v[188:191], v[28:31], v[48:51], v[188:191]
    v_mfma_f32_16x16x32_bf16 v[204:207], v[28:31], v[52:55], v[204:207]
    v_mfma_f32_16x16x32_bf16 v[220:223], v[28:31], v[56:59], v[220:223]
    v_mfma_f32_16x16x32_bf16 v[236:239], v[28:31], v[60:63], v[236:239]
    s_waitcnt lgkmcnt(0)
    v_mfma_f32_16x16x32_bf16 v[112:115], v[64:67], v[80:83], v[112:115]
    v_mfma_f32_16x16x32_bf16 v[128:131], v[64:67], v[84:87], v[128:131]
    s_barrier
    v_mfma_f32_16x16x32_bf16 v[144:147], v[64:67], v[88:91], v[144:147]
    ds_read_b128 v[16:19], v4 offset:0
    v_mfma_f32_16x16x32_bf16 v[160:163], v[64:67], v[92:95], v[160:163]
    v_mfma_f32_16x16x32_bf16 v[176:179], v[64:67], v[96:99], v[176:179]
    ds_read_b128 v[32:35], v2 offset:32768
    v_mfma_f32_16x16x32_bf16 v[192:195], v[64:67], v[100:103], v[192:195]
    v_mfma_f32_16x16x32_bf16 v[208:211], v[64:67], v[104:107], v[208:211]
    ds_read_b128 v[36:39], v2 offset:34816
    v_mfma_f32_16x16x32_bf16 v[224:227], v[64:67], v[108:111], v[224:227]
    v_mfma_f32_16x16x32_bf16 v[116:119], v[68:71], v[80:83], v[116:119]
    ds_read_b128 v[40:43], v2 offset:36864
    v_mfma_f32_16x16x32_bf16 v[132:135], v[68:71], v[84:87], v[132:135]
    v_mfma_f32_16x16x32_bf16 v[148:151], v[68:71], v[88:91], v[148:151]
    ds_read_b128 v[44:47], v2 offset:38912
    v_mfma_f32_16x16x32_bf16 v[164:167], v[68:71], v[92:95], v[164:167]
    v_mfma_f32_16x16x32_bf16 v[180:183], v[68:71], v[96:99], v[180:183]
    ds_read_b128 v[48:51], v2 offset:40960
    v_mfma_f32_16x16x32_bf16 v[196:199], v[68:71], v[100:103], v[196:199]
    v_mfma_f32_16x16x32_bf16 v[212:215], v[68:71], v[104:107], v[212:215]
    ds_read_b128 v[52:55], v2 offset:43008
    v_mfma_f32_16x16x32_bf16 v[228:231], v[68:71], v[108:111], v[228:231]
    v_mfma_f32_16x16x32_bf16 v[120:123], v[72:75], v[80:83], v[120:123]
    ds_read_b128 v[56:59], v2 offset:45056
    v_mfma_f32_16x16x32_bf16 v[136:139], v[72:75], v[84:87], v[136:139]
    v_mfma_f32_16x16x32_bf16 v[152:155], v[72:75], v[88:91], v[152:155]
    ds_read_b128 v[60:63], v2 offset:47104
    v_mfma_f32_16x16x32_bf16 v[168:171], v[72:75], v[92:95], v[168:171]
    v_mfma_f32_16x16x32_bf16 v[184:187], v[72:75], v[96:99], v[184:187]
    ds_read_b128 v[20:23], v4 offset:1024
    v_mfma_f32_16x16x32_bf16 v[200:203], v[72:75], v[100:103], v[200:203]
    v_mfma_f32_16x16x32_bf16 v[216:219], v[72:75], v[104:107], v[216:219]
    ds_read_b128 v[24:27], v4 offset:2048
    v_mfma_f32_16x16x32_bf16 v[232:235], v[72:75], v[108:111], v[232:235]
    v_mfma_f32_16x16x32_bf16 v[124:127], v[76:79], v[80:83], v[124:127]
    ds_read_b128 v[28:31], v4 offset:3072
    v_mfma_f32_16x16x32_bf16 v[140:143], v[76:79], v[84:87], v[140:143]
    v_mfma_f32_16x16x32_bf16 v[156:159], v[76:79], v[88:91], v[156:159]
    v_mfma_f32_16x16x32_bf16 v[172:175], v[76:79], v[92:95], v[172:175]
    v_mfma_f32_16x16x32_bf16 v[188:191], v[76:79], v[96:99], v[188:191]
    v_mfma_f32_16x16x32_bf16 v[204:207], v[76:79], v[100:103], v[204:207]
    v_mfma_f32_16x16x32_bf16 v[220:223], v[76:79], v[104:107], v[220:223]
    v_mfma_f32_16x16x32_bf16 v[236:239], v[76:79], v[108:111], v[236:239]
    s_waitcnt lgkmcnt(0)
    v_mfma_f32_16x16x32_bf16 v[112:115], v[16:19], v[32:35], v[112:115]
    ds_read_b128 v[64:67], v4 offset:8192
    v_mfma_f32_16x16x32_bf16 v[128:131], v[16:19], v[36:39], v[128:131]
    v_mfma_f32_16x16x32_bf16 v[144:147], v[16:19], v[40:43], v[144:147]
    ds_read_b128 v[80:83], v3 offset:32768
    v_mfma_f32_16x16x32_bf16 v[160:163], v[16:19], v[44:47], v[160:163]
    v_mfma_f32_16x16x32_bf16 v[176:179], v[16:19], v[48:51], v[176:179]
    ds_read_b128 v[84:87], v3 offset:34816
    v_mfma_f32_16x16x32_bf16 v[192:195], v[16:19], v[52:55], v[192:195]
    v_mfma_f32_16x16x32_bf16 v[208:211], v[16:19], v[56:59], v[208:211]
    ds_read_b128 v[88:91], v3 offset:36864
    v_mfma_f32_16x16x32_bf16 v[224:227], v[16:19], v[60:63], v[224:227]
    v_mfma_f32_16x16x32_bf16 v[116:119], v[20:23], v[32:35], v[116:119]
    ds_read_b128 v[92:95], v3 offset:38912
    v_mfma_f32_16x16x32_bf16 v[132:135], v[20:23], v[36:39], v[132:135]
    v_mfma_f32_16x16x32_bf16 v[148:151], v[20:23], v[40:43], v[148:151]
    ds_read_b128 v[96:99], v3 offset:40960
    v_mfma_f32_16x16x32_bf16 v[164:167], v[20:23], v[44:47], v[164:167]
    v_mfma_f32_16x16x32_bf16 v[180:183], v[20:23], v[48:51], v[180:183]
    ds_read_b128 v[100:103], v3 offset:43008
    v_mfma_f32_16x16x32_bf16 v[196:199], v[20:23], v[52:55], v[196:199]
    v_mfma_f32_16x16x32_bf16 v[212:215], v[20:23], v[56:59], v[212:215]
    ds_read_b128 v[104:107], v3 offset:45056
    v_mfma_f32_16x16x32_bf16 v[228:231], v[20:23], v[60:63], v[228:231]
    v_mfma_f32_16x16x32_bf16 v[120:123], v[24:27], v[32:35], v[120:123]
    ds_read_b128 v[108:111], v3 offset:47104
    v_mfma_f32_16x16x32_bf16 v[136:139], v[24:27], v[36:39], v[136:139]
    v_mfma_f32_16x16x32_bf16 v[152:155], v[24:27], v[40:43], v[152:155]
    ds_read_b128 v[68:71], v4 offset:9216
    v_mfma_f32_16x16x32_bf16 v[168:171], v[24:27], v[44:47], v[168:171]
    v_mfma_f32_16x16x32_bf16 v[184:187], v[24:27], v[48:51], v[184:187]
    ds_read_b128 v[72:75], v4 offset:10240
    v_mfma_f32_16x16x32_bf16 v[200:203], v[24:27], v[52:55], v[200:203]
    v_mfma_f32_16x16x32_bf16 v[216:219], v[24:27], v[56:59], v[216:219]
    ds_read_b128 v[76:79], v4 offset:11264
    v_mfma_f32_16x16x32_bf16 v[232:235], v[24:27], v[60:63], v[232:235]
    v_mfma_f32_16x16x32_bf16 v[124:127], v[28:31], v[32:35], v[124:127]
    v_mfma_f32_16x16x32_bf16 v[140:143], v[28:31], v[36:39], v[140:143]
    v_mfma_f32_16x16x32_bf16 v[156:159], v[28:31], v[40:43], v[156:159]
    s_bfe_u32 s3, s54, s55
    s_add_u32 s55, s55, 8
    v_lshl_add_u32 v4, s3, 12, v5
    v_mfma_f32_16x16x32_bf16 v[172:175], v[28:31], v[44:47], v[172:175]
    v_mfma_f32_16x16x32_bf16 v[188:191], v[28:31], v[48:51], v[188:191]
    v_mfma_f32_16x16x32_bf16 v[204:207], v[28:31], v[52:55], v[204:207]
    v_mfma_f32_16x16x32_bf16 v[220:223], v[28:31], v[56:59], v[220:223]
    v_mfma_f32_16x16x32_bf16 v[236:239], v[28:31], v[60:63], v[236:239]
    s_waitcnt lgkmcnt(0)
    v_mfma_f32_16x16x32_bf16 v[112:115], v[64:67], v[80:83], v[112:115]
    v_mfma_f32_16x16x32_bf16 v[128:131], v[64:67], v[84:87], v[128:131]
    s_barrier
    v_mfma_f32_16x16x32_bf16 v[144:147], v[64:67], v[88:91], v[144:147]
    ds_read_b128 v[16:19], v4 offset:0
    v_mfma_f32_16x16x32_bf16 v[160:163], v[64:67], v[92:95], v[160:163]
    v_mfma_f32_16x16x32_bf16 v[176:179], v[64:67], v[96:99], v[176:179]
    ds_read_b128 v[32:35], v2 offset:0
    v_mfma_f32_16x16x32_bf16 v[192:195], v[64:67], v[100:103], v[192:195]
    v_mfma_f32_16x16x32_bf16 v[208:211], v[64:67], v[104:107], v[208:211]
    ds_read_b128 v[36:39], v2 offset:2048
    v_mfma_f32_16x16x32_bf16 v[224:227], v[64:67], v[108:111], v[224:227]
    v_mfma_f32_16x16x32_bf16 v[116:119], v[68:71], v[80:83], v[116:119]
    ds_read_b128 v[40:43], v2 offset:4096
    v_mfma_f32_16x16x32_bf16 v[132:135], v[68:71], v[84:87], v[132:135]
    v_mfma_f32_16x16x32_bf16 v[148:151], v[68:71], v[88:91], v[148:151]
    ds_read_b128 v[44:47], v2 offset:6144
    v_mfma_f32_16x16x32_bf16 v[164:167], v[68:71], v[92:95], v[164:167]
    v_mfma_f32_16x16x32_bf16 v[180:183], v[68:71], v[96:99], v[180:183]
    ds_read_b128 v[48:51], v2 offset:8192
    v_mfma_f32_16x16x32_bf16 v[196:199], v[68:71], v[100:103], v[196:199]
    v_mfma_f32_16x16x32_bf16 v[212:215], v[68:71], v[104:107], v[212:215]
    ds_read_b128 v[52:55], v2 offset:10240
    v_mfma_f32_16x16x32_bf16 v[228:231], v[68:71], v[108:111], v[228:231]
    v_mfma_f32_16x16x32_bf16 v[120:123], v[72:75], v[80:83], v[120:123]
    ds_read_b128 v[56:59], v2 offset:12288
    v_mfma_f32_16x16x32_bf16 v[136:139], v[72:75], v[84:87], v[136:139]
    v_mfma_f32_16x16x32_bf16 v[152:155], v[72:75], v[88:91], v[152:155]
    ds_read_b128 v[60:63], v2 offset:14336
    v_mfma_f32_16x16x32_bf16 v[168:171], v[72:75], v[92:95], v[168:171]
    v_mfma_f32_16x16x32_bf16 v[184:187], v[72:75], v[96:99], v[184:187]
    ds_read_b128 v[20:23], v4 offset:1024
    v_mfma_f32_16x16x32_bf16 v[200:203], v[72:75], v[100:103], v[200:203]
    v_mfma_f32_16x16x32_bf16 v[216:219], v[72:75], v[104:107], v[216:219]
    ds_read_b128 v[24:27], v4 offset:2048
    v_mfma_f32_16x16x32_bf16 v[232:235], v[72:75], v[108:111], v[232:235]
    v_mfma_f32_16x16x32_bf16 v[124:127], v[76:79], v[80:83], v[124:127]
    ds_read_b128 v[28:31], v4 offset:3072
    v_mfma_f32_16x16x32_bf16 v[140:143], v[76:79], v[84:87], v[140:143]
    v_mfma_f32_16x16x32_bf16 v[156:159], v[76:79], v[88:91], v[156:159]
    v_mfma_f32_16x16x32_bf16 v[172:175], v[76:79], v[92:95], v[172:175]
    v_mfma_f32_16x16x32_bf16 v[188:191], v[76:79], v[96:99], v[188:191]
    v_mfma_f32_16x16x32_bf16 v[204:207], v[76:79], v[100:103], v[204:207]
    v_mfma_f32_16x16x32_bf16 v[220:223], v[76:79], v[104:107], v[220:223]
    v_mfma_f32_16x16x32_bf16 v[236:239], v[76:79], v[108:111], v[236:239]
    s_sub_u32 s69, s69, 1
    s_cmp_lg_u32 s69, 0
    s_cbranch_scc1 L_cloop
L_late:
    s_cmp_eq_u32 s84, 2
    s_cbranch_scc1 L_epg
    s_waitcnt lgkmcnt(0)
    v_mfma_f32_16x16x32_bf16 v[232:235], v[24:27], v[60:63], v[232:235]
    ds_read_b128 v[72:75], v4 offset:10240
    v_mfma_f32_16x16x32_bf16 v[236:239], v[28:31], v[60:63], v[236:239]
    ds_read_b128 v[76:79], v4 offset:11264
    v_mfma_f32_16x16x32_bf16 v[224:227], v[16:19], v[60:63], v[224:227]
    ds_read_b128 v[64:67], v4 offset:8192
    v_mfma_f32_16x16x32_bf16 v[228:231], v[20:23], v[60:63], v[228:231]
    ds_read_b128 v[68:71], v4 offset:9216
    v_mfma_f32_16x16x32_bf16 v[216:219], v[24:27], v[56:59], v[216:219]
    ds_read_b128 v[108:111], v3 offset:14336
    v_mfma_f32_16x16x32_bf16 v[220:223], v[28:31], v[56:59], v[220:223]
    ds_read_b128 v[104:107], v3 offset:12288
    v_mfma_f32_16x16x32_bf16 v[208:211], v[16:19], v[56:59], v[208:211]
    ds_read_b128 v[100:103], v3 offset:10240
    v_mfma_f32_16x16x32_bf16 v[212:215], v[20:23], v[56:59], v[212:215]
    ds_read_b128 v[96:99], v3 offset:8192
    v_mfma_f32_16x16x32_bf16 v[200:203], v[24:27], v[52:55], v[200:203]
    ds_read_b128 v[92:95], v3 offset:6144
    v_mfma_f32_16x16x32_bf16 v[204:207], v[28:31], v[52:55], v[204:207]
    ds_read_b128 v[88:91], v3 offset:4096
    v_mfma_f32_16x16x32_bf16 v[192:195], v[16:19], v[52:55], v[192:195]
    ds_read_b128 v[84:87], v3 offset:2048
    v_mfma_f32_16x16x32_bf16 v[196:199], v[20:23], v[52:55], v[196:199]
    ds_read_b128 v[80:83], v3 offset:0
    v_mfma_f32_16x16x32_bf16 v[184:187], v[24:27], v[48:51], v[184:187]
    v_mfma_f32_16x16x32_bf16 v[188:191], v[28:31], v[48:51], v[188:191]
    v_mfma_f32_16x16x32_bf16 v[176:179], v[16:19], v[48:51], v[176:179]
    v_mfma_f32_16x16x32_bf16 v[180:183], v[20:23], v[48:51], v[180:183]
    s_waitcnt lgkmcnt(7)
    v_mfma_f32_16x16x32_bf16 v[232:235], v[72:75], v[108:111], v[232:235]
    v_mfma_f32_16x16x32_bf16 v[236:239], v[76:79], v[108:111], v[236:239]
    v_mfma_f32_16x16x32_bf16 v[224:227], v[64:67], v[108:111], v[224:227]
    v_mfma_f32_16x16x32_bf16 v[228:231], v[68:71], v[108:111], v[228:231]
    v_mfma_f32_16x16x32_bf16 v[168:171], v[24:27], v[44:47], v[168:171]
    v_mfma_f32_16x16x32_bf16 v[172:175], v[28:31], v[44:47], v[172:175]
    v_mfma_f32_16x16x32_bf16 v[160:163], v[16:19], v[44:47], v[160:163]
    v_mfma_f32_16x16x32_bf16 v[164:167], v[20:23], v[44:47], v[164:167]
    s_waitcnt lgkmcnt(6)
    v_mfma_f32_16x16x32_bf16 v[216:219], v[72:75], v[104:107], v[216:219]
    v_mfma_f32_16x16x32_bf16 v[220:223], v[76:79], v[104:107], v[220:223]
    v_mfma_f32_16x16x32_bf16 v[208:211], v[64:67], v[104:107], v[208:211]
    v_mfma_f32_16x16x32_bf16 v[212:215], v[68:71], v[104:107], v[212:215]
    v_mfma_f32_16x16x32_bf16 v[152:155], v[24:27], v[40:43], v[152:155]
    v_cvt_pk_bf16_f32 v239, v238, v239
    v_cvt_pk_bf16_f32 v238, v236, v237
    v_cvt_pk_bf16_f32 v237, v234, v235
    v_cvt_pk_bf16_f32 v236, v232, v233
    v_mfma_f32_16x16x32_bf16 v[156:159], v[28:31], v[40:43], v[156:159]
    buffer_store_dwordx4 v[236:239], v14, s[32:35], s48 offen offset:1024 sc1
    v_cvt_pk_bf16_f32 v235, v230, v231
    v_cvt_pk_bf16_f32 v234, v228, v229
    v_cvt_pk_bf16_f32 v233, v226, v227
    v_mfma_f32_16x16x32_bf16 v[144:147], v[16:19], v[40:43], v[144:147]
    v_cvt_pk_bf16_f32 v232, v224, v225
    buffer_store_dwordx4 v[232:235], v14, s[32:35], s48 offen offset:0 sc1
    s_sub_u32 s48, s48, s49
    v_cvt_pk_bf16_f32 v231, v222, v223
    v_cvt_pk_bf16_f32 v230, v220, v221
    v_mfma_f32_16x16x32_bf16 v[148:151], v[20:23], v[40:43], v[148:151]
    v_cvt_pk_bf16_f32 v229, v218, v219
    v_cvt_pk_bf16_f32 v228, v216, v217
    buffer_store_dwordx4 v[228:231], v14, s[32:35], s48 offen offset:1024 sc1
    v_cvt_pk_bf16_f32 v227, v214, v215
    s_waitcnt lgkmcnt(5)
    v_mfma_f32_16x16x32_bf16 v[200:203], v[72:75], v[100:103], v[200:203]
    v_cvt_pk_bf16_f32 v226, v212, v213
    v_cvt_pk_bf16_f32 v225, v210, v211
    v_cvt_pk_bf16_f32 v224, v208, v209
    buffer_store_dwordx4 v[224:227], v14, s[32:35], s48 offen offset:0 sc1
    s_sub_u32 s48, s48, s49
    v_mfma_f32_16x16x32_bf16 v[204:207], v[76:79], v[100:103], v[204:207]
    v_mfma_f32_16x16x32_bf16 v[192:195], v[64:67], v[100:103], v[192:195]
    v_mfma_f32_16x16x32_bf16 v[196:199], v[68:71], v[100:103], v[196:199]
    v_mfma_f32_16x16x32_bf16 v[136:139], v[24:27], v[36:39], v[136:139]
    s_waitcnt lgkmcnt(0)
    s_barrier
    v_mfma_f32_16x16x32_bf16 v[140:143], v[28:31], v[36:39], v[140:143]
    v_mfma_f32_16x16x32_bf16 v[128:131], v[16:19], v[36:39], v[128:131]
    v_mfma_f32_16x16x32_bf16 v[132:135], v[20:23], v[36:39], v[132:135]
    v_mfma_f32_16x16x32_bf16 v[184:187], v[72:75], v[96:99], v[184:187]
    v_mfma_f32_16x16x32_bf16 v[188:191], v[76:79], v[96:99], v[188:191]
    v_mfma_f32_16x16x32_bf16 v[176:179], v[64:67], v[96:99], v[176:179]
    v_mfma_f32_16x16x32_bf16 v[180:183], v[68:71], v[96:99], v[180:183]
    v_cvt_pk_bf16_f32 v223, v206, v207
    v_cvt_pk_bf16_f32 v222, v204, v205
    v_cvt_pk_bf16_f32 v221, v202, v203
    v_cvt_pk_bf16_f32 v220, v200, v201
    v_mfma_f32_16x16x32_bf16 v[120:123], v[24:27], v[32:35], v[120:123]
    buffer_store_dwordx4 v[220:223], v14, s[32:35], s48 offen offset:1024 sc1
    v_cvt_pk_bf16_f32 v219, v198, v199
    v_cvt_pk_bf16_f32 v218, v196, v197
    v_cvt_pk_bf16_f32 v217, v194, v195
    v_mfma_f32_16x16x32_bf16 v[124:127], v[28:31], v[32:35], v[124:127]
    v_cvt_pk_bf16_f32 v216, v192, v193
    buffer_store_dwordx4 v[216:219], v14, s[32:35], s48 offen offset:0 sc1
    s_sub_u32 s48, s48, s49
    v_cvt_pk_bf16_f32 v215, v190, v191
    v_cvt_pk_bf16_f32 v214, v188, v189
    v_mfma_f32_16x16x32_bf16 v[112:115], v[16:19], v[32:35], v[112:115]
    v_cvt_pk_bf16_f32 v213, v186, v187
    v_cvt_pk_bf16_f32 v212, v184, v185
    buffer_store_dwordx4 v[212:215], v14, s[32:35], s48 offen offset:1024 sc1
    v_cvt_pk_bf16_f32 v211, v182, v183
    v_mfma_f32_16x16x32_bf16 v[116:119], v[20:23], v[32:35], v[116:119]
    v_cvt_pk_bf16_f32 v210, v180, v181
    v_cvt_pk_bf16_f32 v209, v178, v179
    v_cvt_pk_bf16_f32 v208, v176, v177
    buffer_store_dwordx4 v[208:211], v14, s[32:35], s48 offen offset:0 sc1
    s_sub_u32 s48, s48, s49
    v_mfma_f32_16x16x32_bf16 v[168:171], v[72:75], v[92:95], v[168:171]
    v_mfma_f32_16x16x32_bf16 v[172:175], v[76:79], v[92:95], v[172:175]
    v_mfma_f32_16x16x32_bf16 v[160:163], v[64:67], v[92:95], v[160:163]
    v_mfma_f32_16x16x32_bf16 v[164:167], v[68:71], v[92:95], v[164:167]
    v_mfma_f32_16x16x32_bf16 v[152:155], v[72:75], v[88:91], v[152:155]
    v_mfma_f32_16x16x32_bf16 v[156:159], v[76:79], v[88:91], v[156:159]
    v_mfma_f32_16x16x32_bf16 v[144:147], v[64:67], v[88:91], v[144:147]
    v_mfma_f32_16x16x32_bf16 v[148:151], v[68:71], v[88:91], v[148:151]
    v_mfma_f32_16x16x32_bf16 v[136:139], v[72:75], v[84:87], v[136:139]
    v_mfma_f32_16x16x32_bf16 v[140:143], v[76:79], v[84:87], v[140:143]
    v_mfma_f32_16x16x32_bf16 v[128:131], v[64:67], v[84:87], v[128:131]
    v_mfma_f32_16x16x32_bf16 v[132:135], v[68:71], v[84:87], v[132:135]
    v_mfma_f32_16x16x32_bf16 v[120:123], v[72:75], v[80:83], v[120:123]
    v_mfma_f32_16x16x32_bf16 v[124:127], v[76:79], v[80:83], v[124:127]
    v_cvt_pk_bf16_f32 v207, v174, v175
    v_cvt_pk_bf16_f32 v206, v172, v173
    v_cvt_pk_bf16_f32 v205, v170, v171
    v_cvt_pk_bf16_f32 v204, v168, v169
    v_mfma_f32_16x16x32_bf16 v[112:115], v[64:67], v[80:83], v[112:115]
    buffer_store_dwordx4 v[204:207], v14, s[32:35], s48 offen offset:1024 sc1
    v_cvt_pk_bf16_f32 v203, v166, v167
    v_cvt_pk_bf16_f32 v202, v164, v165
    v_cvt_pk_bf16_f32 v201, v162, v163
    v_mfma_f32_16x16x32_bf16 v[116:119], v[68:71], v[80:83], v[116:119]
    v_cvt_pk_bf16_f32 v200, v160, v161
    buffer_store_dwordx4 v[200:203], v14, s[32:35], s48 offen offset:0 sc1
    s_sub_u32 s48, s48, s49
    v_cvt_pk_bf16_f32 v199, v158, v159
    v_cvt_pk_bf16_f32 v198, v156, v157
    v_cvt_pk_bf16_f32 v197, v154, v155
    v_cvt_pk_bf16_f32 v196, v152, v153
    buffer_store_dwordx4 v[196:199], v14, s[32:35], s48 offen offset:1024 sc1
    v_cvt_pk_bf16_f32 v195, v150, v151
    v_cvt_pk_bf16_f32 v194, v148, v149
    v_cvt_pk_bf16_f32 v193, v146, v147
    v_cvt_pk_bf16_f32 v192, v144, v145
    buffer_store_dwordx4 v[192:195], v14, s[32:35], s48 offen offset:0 sc1
    s_sub_u32 s48, s48, s49
    v_cvt_pk_bf16_f32 v191, v142, v143
    v_cvt_pk_bf16_f32 v190, v140, v141
    v_cvt_pk_bf16_f32 v189, v138, v139
    v_cvt_pk_bf16_f32 v188, v136, v137
    buffer_store_dwordx4 v[188:191], v14, s[32:35], s48 offen offset:1024 sc1
    v_cvt_pk_bf16_f32 v187, v134, v135
    v_cvt_pk_bf16_f32 v186, v132, v133
    v_cvt_pk_bf16_f32 v185, v130, v131
    v_cvt_pk_bf16_f32 v184, v128, v129
    buffer_store_dwordx4 v[184:187], v14, s[32:35], s48 offen offset:0 sc1
    s_sub_u32 s48, s48, s49
    v_cvt_pk_bf16_f32 v183, v126, v127
    v_cvt_pk_bf16_f32 v182, v124, v125
    v_cvt_pk_bf16_f32 v181, v122, v123
    v_cvt_pk_bf16_f32 v180, v120, v121
    buffer_store_dwordx4 v[180:183], v14, s[32:35], s48 offen offset:1024 sc1
    v_cvt_pk_bf16_f32 v179, v118, v119
    v_cvt_pk_bf16_f32 v178, v116, v117
    v_cvt_pk_bf16_f32 v177, v114, v115
    v_cvt_pk_bf16_f32 v176, v112, v113
    buffer_store_dwordx4 v[176:179], v14, s[32:35], s48 offen offset:0 sc1
    s_branch L_epx
L_epg:
    s_waitcnt lgkmcnt(0)
    v_mfma_f32_16x16x32_bf16 v[232:235], v[24:27], v[60:63], v[232:235]
    ds_read_b128 v[72:75], v4 offset:10240
    v_mfma_f32_16x16x32_bf16 v[236:239], v[28:31], v[60:63], v[236:239]
    ds_read_b128 v[76:79], v4 offset:11264
    v_mfma_f32_16x16x32_bf16 v[224:227], v[16:19], v[60:63], v[224:227]
    ds_read_b128 v[64:67], v4 offset:8192
    v_mfma_f32_16x16x32_bf16 v[228:231], v[20:23], v[60:63], v[228:231]
    ds_read_b128 v[68:71], v4 offset:9216
    v_mfma_f32_16x16x32_bf16 v[216:219], v[24:27], v[56:59], v[216:219]
    ds_read_b128 v[108:111], v3 offset:14336
    v_mfma_f32_16x16x32_bf16 v[220:223], v[28:31], v[56:59], v[220:223]
    ds_read_b128 v[104:107], v3 offset:12288
    v_mfma_f32_16x16x32_bf16 v[208:211], v[16:19], v[56:59], v[208:211]
    ds_read_b128 v[100:103], v3 offset:10240
    v_mfma_f32_16x16x32_bf16 v[212:215], v[20:23], v[56:59], v[212:215]
    ds_read_b128 v[96:99], v3 offset:8192
    v_mfma_f32_16x16x32_bf16 v[200:203], v[24:27], v[52:55], v[200:203]
    ds_read_b128 v[92:95], v3 offset:6144
    v_mfma_f32_16x16x32_bf16 v[204:207], v[28:31], v[52:55], v[204:207]
    ds_read_b128 v[88:91], v3 offset:4096
    v_mfma_f32_16x16x32_bf16 v[192:195], v[16:19], v[52:55], v[192:195]
    ds_read_b128 v[84:87], v3 offset:2048
    v_mfma_f32_16x16x32_bf16 v[196:199], v[20:23], v[52:55], v[196:199]
    ds_read_b128 v[80:83], v3 offset:0
    v_mfma_f32_16x16x32_bf16 v[184:187], v[24:27], v[48:51], v[184:187]
    ds_read_b128 v[60:63], v6 offset:29696
    ds_read_b128 v[56:59], v6 offset:28672
    ds_read_b128 v[52:55], v6 offset:25600
    v_mfma_f32_16x16x32_bf16 v[188:191], v[28:31], v[48:51], v[188:191]
    v_mfma_f32_16x16x32_bf16 v[176:179], v[16:19], v[48:51], v[176:179]
    v_mfma_f32_16x16x32_bf16 v[180:183], v[20:23], v[48:51], v[180:183]
    ds_read_b128 v[48:51], v6 offset:24576
    s_waitcnt lgkmcnt(11)
    v_mfma_f32_16x16x32_bf16 v[232:235], v[72:75], v[108:111], v[232:235]
    v_mfma_f32_16x16x32_bf16 v[236:239], v[76:79], v[108:111], v[236:239]
    v_mfma_f32_16x16x32_bf16 v[224:227], v[64:67], v[108:111], v[224:227]
    v_mfma_f32_16x16x32_bf16 v[228:231], v[68:71], v[108:111], v[228:231]
    ds_read_b128 v[108:111], v6 offset:21504
    v_mfma_f32_16x16x32_bf16 v[168:171], v[24:27], v[44:47], v[168:171]
    s_waitcnt lgkmcnt(4)
    v_lshlrev_b32 v248, 16, v60
    v_and_b32 v249, 0xffff0000, v60
    v_lshlrev_b32 v250, 16, v61
    v_and_b32 v251, 0xffff0000, v61
    v_mfma_f32_16x16x32_bf16 v[172:175], v[28:31], v[44:47], v[172:175]
    v_lshlrev_b32 v252, 16, v62
    v_and_b32 v253, 0xffff0000, v62
    v_lshlrev_b32 v254, 16, v63
    v_and_b32 v255, 0xffff0000, v63
    v_mfma_f32_16x16x32_bf16 v[160:163], v[16:19], v[44:47], v[160:163]
    v_pk_mul_f32 v[232:233], v[232:233], v[248:249]
    v_pk_mul_f32 v[234:235], v[234:235], v[250:251]
    v_pk_mul_f32 v[236:237], v[236:237], v[252:253]
    v_pk_mul_f32 v[238:239], v[238:239], v[254:255]
    v_mfma_f32_16x16x32_bf16 v[164:167], v[20:23], v[44:47], v[164:167]
    ds_read_b128 v[44:47], v6 offset:20480
    v_cvt_pk_f16_f32 v239, v238, v239
    v_cvt_pk_f16_f32 v238, v236, v237
    v_cvt_pk_f16_f32 v237, v234, v235
    v_cvt_pk_f16_f32 v236, v232, v233
    v_mfma_f32_16x16x32_bf16 v[216:219], v[72:75], v[104:107], v[216:219]
    buffer_store_dwordx4 v[236:239], v14, s[32:35], s48 offen offset:1024 sc1
    s_waitcnt lgkmcnt(4)
    v_lshlrev_b32 v240, 16, v56
    v_and_b32 v241, 0xffff0000, v56
    v_lshlrev_b32 v242, 16, v57
    v_mfma_f32_16x16x32_bf16 v[220:223], v[76:79], v[104:107], v[220:223]
    v_and_b32 v243, 0xffff0000, v57
    v_lshlrev_b32 v244, 16, v58
    v_and_b32 v245, 0xffff0000, v58
    v_lshlrev_b32 v246, 16, v59
    v_mfma_f32_16x16x32_bf16 v[208:211], v[64:67], v[104:107], v[208:211]
    v_and_b32 v247, 0xffff0000, v59
    v_pk_mul_f32 v[224:225], v[224:225], v[240:241]
    v_pk_mul_f32 v[226:227], v[226:227], v[242:243]
    v_pk_mul_f32 v[228:229], v[228:229], v[244:245]
    v_mfma_f32_16x16x32_bf16 v[212:215], v[68:71], v[104:107], v[212:215]
    ds_read_b128 v[104:107], v6 offset:17408
    v_pk_mul_f32 v[230:231], v[230:231], v[246:247]
    v_cvt_pk_f16_f32 v235, v230, v231
    v_cvt_pk_f16_f32 v234, v228, v229
    v_cvt_pk_f16_f32 v233, v226, v227
    v_mfma_f32_16x16x32_bf16 v[152:155], v[24:27], v[40:43], v[152:155]
    v_cvt_pk_f16_f32 v232, v224, v225
    buffer_store_dwordx4 v[232:235], v14, s[32:35], s48 offen offset:0 sc1
    s_sub_u32 s48, s48, s49
    s_waitcnt lgkmcnt(4)
    v_lshlrev_b32 v248, 16, v52
    v_and_b32 v249, 0xffff0000, v52
    v_mfma_f32_16x16x32_bf16 v[156:159], v[28:31], v[40:43], v[156:159]
    v_lshlrev_b32 v250, 16, v53
    v_and_b32 v251, 0xffff0000, v53
    v_lshlrev_b32 v252, 16, v54
    v_and_b32 v253, 0xffff0000, v54
    v_mfma_f32_16x16x32_bf16 v[144:147], v[16:19], v[40:43], v[144:147]
    v_lshlrev_b32 v254, 16, v55
    v_and_b32 v255, 0xffff0000, v55
    v_pk_mul_f32 v[216:217], v[216:217], v[248:249]
    v_pk_mul_f32 v[218:219], v[218:219], v[250:251]
    v_mfma_f32_16x16x32_bf16 v[148:151], v[20:23], v[40:43], v[148:151]
    ds_read_b128 v[40:43], v6 offset:16384
    v_pk_mul_f32 v[220:221], v[220:221], v[252:253]
    v_pk_mul_f32 v[222:223], v[222:223], v[254:255]
    v_cvt_pk_f16_f32 v231, v222, v223
    v_cvt_pk_f16_f32 v230, v220, v221
    v_mfma_f32_16x16x32_bf16 v[200:203], v[72:75], v[100:103], v[200:203]
    v_cvt_pk_f16_f32 v229, v218, v219
    v_cvt_pk_f16_f32 v228, v216, v217
    buffer_store_dwordx4 v[228:231], v14, s[32:35], s48 offen offset:1024 sc1
    s_waitcnt lgkmcnt(4)
    v_lshlrev_b32 v240, 16, v48
    v_mfma_f32_16x16x32_bf16 v[204:207], v[76:79], v[100:103], v[204:207]
    v_and_b32 v241, 0xffff0000, v48
    v_lshlrev_b32 v242, 16, v49
    v_and_b32 v243, 0xffff0000, v49
    v_lshlrev_b32 v244, 16, v50
    v_mfma_f32_16x16x32_bf16 v[192:195], v[64:67], v[100:103], v[192:195]
    v_and_b32 v245, 0xffff0000, v50
    v_lshlrev_b32 v246, 16, v51
    v_and_b32 v247, 0xffff0000, v51
    v_pk_mul_f32 v[208:209], v[208:209], v[240:241]
    v_mfma_f32_16x16x32_bf16 v[196:199], v[68:71], v[100:103], v[196:199]
    v_pk_mul_f32 v[210:211], v[210:211], v[242:243]
    v_pk_mul_f32 v[212:213], v[212:213], v[244:245]
    v_pk_mul_f32 v[214:215], v[214:215], v[246:247]
    v_cvt_pk_f16_f32 v227, v214, v215
    v_mfma_f32_16x16x32_bf16 v[136:139], v[24:27], v[36:39], v[136:139]
    s_barrier
    ds_read_b128 v[100:103], v6 offset:46080
    v_cvt_pk_f16_f32 v226, v212, v213
    v_cvt_pk_f16_f32 v225, v210, v211
    v_cvt_pk_f16_f32 v224, v208, v209
    buffer_store_dwordx4 v[224:227], v14, s[32:35], s48 offen offset:0 sc1
    s_sub_u32 s48, s48, s49
    v_mfma_f32_16x16x32_bf16 v[140:143], v[28:31], v[36:39], v[140:143]
    s_waitcnt lgkmcnt(4)
    v_lshlrev_b32 v248, 16, v108
    v_and_b32 v249, 0xffff0000, v108
    v_lshlrev_b32 v250, 16, v109
    v_and_b32 v251, 0xffff0000, v109
    v_mfma_f32_16x16x32_bf16 v[128:131], v[16:19], v[36:39], v[128:131]
    v_lshlrev_b32 v252, 16, v110
    v_and_b32 v253, 0xffff0000, v110
    v_lshlrev_b32 v254, 16, v111
    v_and_b32 v255, 0xffff0000, v111
    v_mfma_f32_16x16x32_bf16 v[132:135], v[20:23], v[36:39], v[132:135]
    ds_read_b128 v[36:39], v6 offset:45056
    v_pk_mul_f32 v[200:201], v[200:201], v[248:249]
    v_pk_mul_f32 v[202:203], v[202:203], v[250:251]
    v_pk_mul_f32 v[204:205], v[204:205], v[252:253]
    v_pk_mul_f32 v[206:207], v[206:207], v[254:255]
    v_mfma_f32_16x16x32_bf16 v[184:187], v[72:75], v[96:99], v[184:187]
    v_cvt_pk_f16_f32 v223, v206, v207
    v_cvt_pk_f16_f32 v222, v204, v205
    v_cvt_pk_f16_f32 v221, v202, v203
    v_cvt_pk_f16_f32 v220, v200, v201
    v_mfma_f32_16x16x32_bf16 v[188:191], v[76:79], v[96:99], v[188:191]
    buffer_store_dwordx4 v[220:223], v14, s[32:35], s48 offen offset:1024 sc1
    s_waitcnt lgkmcnt(4)
    v_lshlrev_b32 v240, 16, v44
    v_and_b32 v241, 0xffff0000, v44
    v_lshlrev_b32 v242, 16, v45
    v_mfma_f32_16x16x32_bf16 v[176:179], v[64:67], v[96:99], v[176:179]
    v_and_b32 v243, 0xffff0000, v45
    v_lshlrev_b32 v244, 16, v46
    v_and_b32 v245, 0xffff0000, v46
    v_lshlrev_b32 v246, 16, v47
    v_mfma_f32_16x16x32_bf16 v[180:183], v[68:71], v[96:99], v[180:183]
    ds_read_b128 v[96:99], v6 offset:41984
    v_and_b32 v247, 0xffff0000, v47
    v_pk_mul_f32 v[192:193], v[192:193], v[240:241]
    v_pk_mul_f32 v[194:195], v[194:195], v[242:243]
    v_pk_mul_f32 v[196:197], v[196:197], v[244:245]
    v_mfma_f32_16x16x32_bf16 v[120:123], v[24:27], v[32:35], v[120:123]
    v_pk_mul_f32 v[198:199], v[198:199], v[246:247]
    v_cvt_pk_f16_f32 v219, v198, v199
    v_cvt_pk_f16_f32 v218, v196, v197
    v_cvt_pk_f16_f32 v217, v194, v195
    v_mfma_f32_16x16x32_bf16 v[124:127], v[28:31], v[32:35], v[124:127]
    v_cvt_pk_f16_f32 v216, v192, v193
    buffer_store_dwordx4 v[216:219], v14, s[32:35], s48 offen offset:0 sc1
    s_sub_u32 s48, s48, s49
    s_waitcnt lgkmcnt(4)
    v_lshlrev_b32 v248, 16, v104
    v_and_b32 v249, 0xffff0000, v104
    v_mfma_f32_16x16x32_bf16 v[112:115], v[16:19], v[32:35], v[112:115]
    v_lshlrev_b32 v250, 16, v105
    v_and_b32 v251, 0xffff0000, v105
    v_lshlrev_b32 v252, 16, v106
    v_and_b32 v253, 0xffff0000, v106
    v_mfma_f32_16x16x32_bf16 v[116:119], v[20:23], v[32:35], v[116:119]
    ds_read_b128 v[32:35], v6 offset:40960
    v_lshlrev_b32 v254, 16, v107
    v_and_b32 v255, 0xffff0000, v107
    v_pk_mul_f32 v[184:185], v[184:185], v[248:249]
    v_pk_mul_f32 v[186:187], v[186:187], v[250:251]
    v_mfma_f32_16x16x32_bf16 v[168:171], v[72:75], v[92:95], v[168:171]
    v_pk_mul_f32 v[188:189], v[188:189], v[252:253]
    v_pk_mul_f32 v[190:191], v[190:191], v[254:255]
    v_cvt_pk_f16_f32 v215, v190, v191
    v_cvt_pk_f16_f32 v214, v188, v189
    v_mfma_f32_16x16x32_bf16 v[172:175], v[76:79], v[92:95], v[172:175]
    v_cvt_pk_f16_f32 v213, v186, v187
    v_cvt_pk_f16_f32 v212, v184, v185
    buffer_store_dwordx4 v[212:215], v14, s[32:35], s48 offen offset:1024 sc1
    s_waitcnt lgkmcnt(4)
    v_lshlrev_b32 v240, 16, v40
    v_mfma_f32_16x16x32_bf16 v[160:163], v[64:67], v[92:95], v[160:163]
    v_and_b32 v241, 0xffff0000, v40
    v_lshlrev_b32 v242, 16, v41
    v_and_b32 v243, 0xffff0000, v41
    v_lshlrev_b32 v244, 16, v42
    v_mfma_f32_16x16x32_bf16 v[164:167], v[68:71], v[92:95], v[164:167]
    ds_read_b128 v[92:95], v6 offset:37888
    v_and_b32 v245, 0xffff0000, v42
    v_lshlrev_b32 v246, 16, v43
    v_and_b32 v247, 0xffff0000, v43
    v_pk_mul_f32 v[176:177], v[176:177], v[240:241]
    v_mfma_f32_16x16x32_bf16 v[152:155], v[72:75], v[88:91], v[152:155]
    v_pk_mul_f32 v[178:179], v[178:179], v[242:243]
    v_pk_mul_f32 v[180:181], v[180:181], v[244:245]
    v_pk_mul_f32 v[182:183], v[182:183], v[246:247]
    v_cvt_pk_f16_f32 v211, v182, v183
    v_mfma_f32_16x16x32_bf16 v[156:159], v[76:79], v[88:91], v[156:159]
    v_cvt_pk_f16_f32 v210, v180, v181
    v_cvt_pk_f16_f32 v209, v178, v179
    v_cvt_pk_f16_f32 v208, v176, v177
    buffer_store_dwordx4 v[208:211], v14, s[32:35], s48 offen offset:0 sc1
    s_sub_u32 s48, s48, s49
    v_mfma_f32_16x16x32_bf16 v[144:147], v[64:67], v[88:91], v[144:147]
    s_waitcnt lgkmcnt(4)
    v_lshlrev_b32 v248, 16, v100
    v_and_b32 v249, 0xffff0000, v100
    v_lshlrev_b32 v250, 16, v101
    v_and_b32 v251, 0xffff0000, v101
    v_mfma_f32_16x16x32_bf16 v[148:151], v[68:71], v[88:91], v[148:151]
    ds_read_b128 v[88:91], v6 offset:36864
    v_lshlrev_b32 v252, 16, v102
    v_and_b32 v253, 0xffff0000, v102
    v_lshlrev_b32 v254, 16, v103
    v_and_b32 v255, 0xffff0000, v103
    v_mfma_f32_16x16x32_bf16 v[136:139], v[72:75], v[84:87], v[136:139]
    v_pk_mul_f32 v[168:169], v[168:169], v[248:249]
    v_pk_mul_f32 v[170:171], v[170:171], v[250:251]
    v_pk_mul_f32 v[172:173], v[172:173], v[252:253]
    v_pk_mul_f32 v[174:175], v[174:175], v[254:255]
    v_mfma_f32_16x16x32_bf16 v[140:143], v[76:79], v[84:87], v[140:143]
    v_cvt_pk_f16_f32 v207, v174, v175
    v_cvt_pk_f16_f32 v206, v172, v173
    v_cvt_pk_f16_f32 v205, v170, v171
    v_cvt_pk_f16_f32 v204, v168, v169
    v_mfma_f32_16x16x32_bf16 v[128:131], v[64:67], v[84:87], v[128:131]
    buffer_store_dwordx4 v[204:207], v14, s[32:35], s48 offen offset:1024 sc1
    s_waitcnt lgkmcnt(4)
    v_lshlrev_b32 v240, 16, v36
    v_and_b32 v241, 0xffff0000, v36
    v_lshlrev_b32 v242, 16, v37
    v_mfma_f32_16x16x32_bf16 v[132:135], v[68:71], v[84:87], v[132:135]
    ds_read_b128 v[84:87], v6 offset:33792
    v_and_b32 v243, 0xffff0000, v37
    v_lshlrev_b32 v244, 16, v38
    v_and_b32 v245, 0xffff0000, v38
    v_lshlrev_b32 v246, 16, v39
    v_mfma_f32_16x16x32_bf16 v[120:123], v[72:75], v[80:83], v[120:123]
    v_and_b32 v247, 0xffff0000, v39
    v_pk_mul_f32 v[160:161], v[160:161], v[240:241]
    v_pk_mul_f32 v[162:163], v[162:163], v[242:243]
    v_pk_mul_f32 v[164:165], v[164:165], v[244:245]
    v_mfma_f32_16x16x32_bf16 v[124:127], v[76:79], v[80:83], v[124:127]
    v_pk_mul_f32 v[166:167], v[166:167], v[246:247]
    v_cvt_pk_f16_f32 v203, v166, v167
    v_cvt_pk_f16_f32 v202, v164, v165
    v_cvt_pk_f16_f32 v201, v162, v163
    v_mfma_f32_16x16x32_bf16 v[112:115], v[64:67], v[80:83], v[112:115]
    v_cvt_pk_f16_f32 v200, v160, v161
    buffer_store_dwordx4 v[200:203], v14, s[32:35], s48 offen offset:0 sc1
    s_sub_u32 s48, s48, s49
    s_waitcnt lgkmcnt(4)
    v_lshlrev_b32 v248, 16, v96
    v_and_b32 v249, 0xffff0000, v96
    v_mfma_f32_16x16x32_bf16 v[116:119], v[68:71], v[80:83], v[116:119]
    ds_read_b128 v[80:83], v6 offset:32768
    v_lshlrev_b32 v250, 16, v97
    v_and_b32 v251, 0xffff0000, v97
    v_lshlrev_b32 v252, 16, v98
    v_and_b32 v253, 0xffff0000, v98
    v_lshlrev_b32 v254, 16, v99
    v_and_b32 v255, 0xffff0000, v99
    v_pk_mul_f32 v[152:153], v[152:153], v[248:249]
    v_pk_mul_f32 v[154:155], v[154:155], v[250:251]
    v_pk_mul_f32 v[156:157], v[156:157], v[252:253]
    v_pk_mul_f32 v[158:159], v[158:159], v[254:255]
    v_cvt_pk_f16_f32 v199, v158, v159
    v_cvt_pk_f16_f32 v198, v156, v157
    v_cvt_pk_f16_f32 v197, v154, v155
    v_cvt_pk_f16_f32 v196, v152, v153
    buffer_store_dwordx4 v[196:199], v14, s[32:35], s48 offen offset:1024 sc1
    s_waitcnt lgkmcnt(4)
    v_lshlrev_b32 v240, 16, v32
    v_and_b32 v241, 0xffff0000, v32
    v_lshlrev_b32 v242, 16, v33
    v_and_b32 v243, 0xffff0000, v33
    v_lshlrev_b32 v244, 16, v34
    v_and_b32 v245, 0xffff0000, v34
    v_lshlrev_b32 v246, 16, v35
    v_and_b32 v247, 0xffff0000, v35
    v_pk_mul_f32 v[144:145], v[144:145], v[240:241]
    v_pk_mul_f32 v[146:147], v[146:147], v[242:243]
    v_pk_mul_f32 v[148:149], v[148:149], v[244:245]
    v_pk_mul_f32 v[150:151], v[150:151], v[246:247]
    v_cvt_pk_f16_f32 v195, v150, v151
    v_cvt_pk_f16_f32 v194, v148, v149
    v_cvt_pk_f16_f32 v193, v146, v147
    v_cvt_pk_f16_f32 v192, v144, v145
    buffer_store_dwordx4 v[192:195], v14, s[32:35], s48 offen offset:0 sc1
    s_sub_u32 s48, s48, s49
    s_waitcnt lgkmcnt(3)
    v_lshlrev_b32 v248, 16, v92
    v_and_b32 v249, 0xffff0000, v92
    v_lshlrev_b32 v250, 16, v93
    v_and_b32 v251, 0xffff0000, v93
    v_lshlrev_b32 v252, 16, v94
    v_and_b32 v253, 0xffff0000, v94
    v_lshlrev_b32 v254, 16, v95
    v_and_b32 v255, 0xffff0000, v95
    v_pk_mul_f32 v[136:137], v[136:137], v[248:249]
    v_pk_mul_f32 v[138:139], v[138:139], v[250:251]
    v_pk_mul_f32 v[140:141], v[140:141], v[252:253]
    v_pk_mul_f32 v[142:143], v[142:143], v[254:255]
    v_cvt_pk_f16_f32 v191, v142, v143
    v_cvt_pk_f16_f32 v190, v140, v141
    v_cvt_pk_f16_f32 v189, v138, v139
    v_cvt_pk_f16_f32 v188, v136, v137
    buffer_store_dwordx4 v[188:191], v14, s[32:35], s48 offen offset:1024 sc1
    s_waitcnt lgkmcnt(2)
    v_lshlrev_b32 v240, 16, v88
    v_and_b32 v241, 0xffff0000, v88
    v_lshlrev_b32 v242, 16, v89
    v_and_b32 v243, 0xffff0000, v89
    v_lshlrev_b32 v244, 16, v90
    v_and_b32 v245, 0xffff0000, v90
    v_lshlrev_b32 v246, 16, v91
    v_and_b32 v247, 0xffff0000, v91
    v_pk_mul_f32 v[128:129], v[128:129], v[240:241]
    v_pk_mul_f32 v[130:131], v[130:131], v[242:243]
    v_pk_mul_f32 v[132:133], v[132:133], v[244:245]
    v_pk_mul_f32 v[134:135], v[134:135], v[246:247]
    v_cvt_pk_f16_f32 v187, v134, v135
    v_cvt_pk_f16_f32 v186, v132, v133
    v_cvt_pk_f16_f32 v185, v130, v131
    v_cvt_pk_f16_f32 v184, v128, v129
    buffer_store_dwordx4 v[184:187], v14, s[32:35], s48 offen offset:0 sc1
    s_sub_u32 s48, s48, s49
    s_waitcnt lgkmcnt(1)
    v_lshlrev_b32 v248, 16, v84
    v_and_b32 v249, 0xffff0000, v84
    v_lshlrev_b32 v250, 16, v85
    v_and_b32 v251, 0xffff0000, v85
    v_lshlrev_b32 v252, 16, v86
    v_and_b32 v253, 0xffff0000, v86
    v_lshlrev_b32 v254, 16, v87
    v_and_b32 v255, 0xffff0000, v87
    v_pk_mul_f32 v[120:121], v[120:121], v[248:249]
    v_pk_mul_f32 v[122:123], v[122:123], v[250:251]
    v_pk_mul_f32 v[124:125], v[124:125], v[252:253]
    v_pk_mul_f32 v[126:127], v[126:127], v[254:255]
    v_cvt_pk_f16_f32 v183, v126, v127
    v_cvt_pk_f16_f32 v182, v124, v125
    v_cvt_pk_f16_f32 v181, v122, v123
    v_cvt_pk_f16_f32 v180, v120, v121
    buffer_store_dwordx4 v[180:183], v14, s[32:35], s48 offen offset:1024 sc1
    s_waitcnt lgkmcnt(0)
    v_lshlrev_b32 v240, 16, v80
    v_and_b32 v241, 0xffff0000, v80
    v_lshlrev_b32 v242, 16, v81
    v_and_b32 v243, 0xffff0000, v81
    v_lshlrev_b32 v244, 16, v82
    v_and_b32 v245, 0xffff0000, v82
    v_lshlrev_b32 v246, 16, v83
    v_and_b32 v247, 0xffff0000, v83
    v_pk_mul_f32 v[112:113], v[112:113], v[240:241]
    v_pk_mul_f32 v[114:115], v[114:115], v[242:243]
    v_pk_mul_f32 v[116:117], v[116:117], v[244:245]
    v_pk_mul_f32 v[118:119], v[118:119], v[246:247]
    v_cvt_pk_f16_f32 v179, v118, v119
    v_cvt_pk_f16_f32 v178, v116, v117
    v_cvt_pk_f16_f32 v177, v114, v115
    v_cvt_pk_f16_f32 v176, v112, v113
    buffer_store_dwordx4 v[176:179], v14, s[32:35], s48 offen offset:0 sc1
L_epx:
    s_lshr_b32 s3, s66, 5
    s_lshl_b32 s3, s3, 2
    s_lshr_b32 s3, 0x32761054, s3
    s_and_b32 s3, s3, 7
    s_lshl_b32 s3, s3, 5
    s_and_b32 s66, s66, 31
    s_or_b32 s66, s66, s3
    s_lshr_b32 s56, s66, 3
    s_lshr_b32 s62, s66, 2
    s_and_b32 s57, s66, 3
    s_lshl1_add_u32 s57, s57, 0
    v_and_b32 v4, 7, v0
    v_bfe_u32 v5, v0, 3, 5
    v_lshlrev_b32 v15, 10, v5
    v_lshl_add_u32 v15, v4, 4, v15
    s_lshl_b32 s60, s62, 15
    s_lshl_b32 s3, s57, 7
    s_add_u32 s60, s60, s3
    s_bfe_u32 s61, s56, 0x10001
    s_lshl_b32 s61, s61, 8
    s_add_u32 s61, s61, 29130752
    s_mov_b32 s18, 131072
    s_mul_i32 s63, s19, 7
    s_add_u32 s63, s63, 4
    s_lshr_b32 s3, s63, 1
    s_add_u32 s91, s63, 2
    s_lshr_b32 s91, s91, 1
    v_and_b32 v13, 3, v1
    v_add_u32 v13, s3, v13
    v_min_u32 v13, s91, v13
    v_bfe_u32 v12, v1, 2, 1
    v_mad_u32_u24 v12, v12, 14, v13
    v_and_b32 v13, 1, v12
    v_lshrrev_b32 v12, 1, v12
    v_lshl_add_u32 v12, v12, 2, v13
    s_lshr_b32 s3, s56, 2
    s_lshl_b32 s3, s3, 7
    s_add_u32 s3, s3, 64
    v_add_u32 v12, s3, v12
    v_lshlrev_b32 v12, 7, v12
    s_mul_i32 s48, s62, 112
    s_add_u32 s48, s48, s63
    s_lshl_b32 s48, s48, 10
    s_add_u32 s48, s48, 41943040
    s_add_u32 s49, s48, 57344
    s_add_u32 s50, s48, 28672
    s_add_u32 s51, s48, 86016
    s_mul_i32 s90, s62, 64
    s_add_u32 s90, s90, s57
    s_lshl_b32 s90, s90, 11
    s_mul_i32 s3, s19, 16384
    s_add_u32 s90, s90, s3
    s_add_u32 s90, s90, 33554432
    s_lshr_b32 s3, s56, 4
    s_lshl2_add_u32 s3, s3, s19
    s_lshl_b32 s3, s3, 3
    s_bfe_u32 s91, s56, 0x20002
    s_add_u32 s3, s3, s91
    s_lshl_b32 s3, s3, 4
    s_and_b32 s91, s57, 6
    s_lshl1_add_u32 s3, s91, s3
    s_add_u32 s3, s3, 0
    s_lshl_b32 s3, s3, 7
    v_mov_b32 v13, s3
    v_cmp_gt_u32 vcc, 8, v1
    s_lshr_b32 s3, s19, 1
    s_mul_i32 s91, s3, 65536
    v_cndmask_b32 v12, v13, v12, vcc
    s_and_b32 s3, s19, 1
    s_lshl_b32 s3, s3, 11
    s_add_u32 s91, s91, s3
    s_add_u32 s91, s91, 16384
    s_mul_i32 s18, s19, 7
    s_and_b32 s3, s66, 3
    s_mul_i32 s3, s3, 224
    s_add_u32 s3, s3, s18
    s_lshl_b32 s3, s3, 10
    s_add_u32 s59, s3, 27267072
    s_waitcnt lgkmcnt(0)
    v_lshlrev_b32 v2, 7, v1
    v_mov_b32 v3, 1
    s_mov_b32 exec_lo, s67
    s_mov_b32 exec_hi, 0
    s_waitcnt vmcnt(0)
    buffer_store_dword v3, v2, s[32:35], s68 offen sc1
    s_mov_b64 exec, -1
    s_branch L_p3c
L_csp:
    s_barrier
L_p3c0:
    s_lshr_b32 s3, s66, 5
    s_lshl_b32 s3, s3, 2
    s_lshr_b32 s3, 0x32761054, s3
    s_and_b32 s3, s3, 7
    s_lshl_b32 s3, s3, 5
    s_and_b32 s66, s66, 31
    s_or_b32 s66, s66, s3
    s_lshr_b32 s56, s66, 3
    s_lshr_b32 s62, s66, 2
    s_and_b32 s57, s66, 3
    s_lshl1_add_u32 s57, s57, 0
    v_and_b32 v4, 7, v0
    v_bfe_u32 v5, v0, 3, 5
    v_lshlrev_b32 v15, 10, v5
    v_lshl_add_u32 v15, v4, 4, v15
    s_lshl_b32 s60, s62, 15
    s_lshl_b32 s3, s57, 7
    s_add_u32 s60, s60, s3
    s_bfe_u32 s61, s56, 0x10001
    s_lshl_b32 s61, s61, 8
    s_add_u32 s61, s61, 29130752
    s_mov_b32 s18, 131072
    s_mul_i32 s63, s19, 7
    s_add_u32 s63, s63, 4
    s_lshr_b32 s3, s63, 1
    s_add_u32 s91, s63, 2
    s_lshr_b32 s91, s91, 1
    v_and_b32 v13, 3, v1
    v_add_u32 v13, s3, v13
    v_min_u32 v13, s91, v13
    v_bfe_u32 v12, v1, 2, 1
    v_mad_u32_u24 v12, v12, 14, v13
    v_and_b32 v13, 1, v12
    v_lshrrev_b32 v12, 1, v12
    v_lshl_add_u32 v12, v12, 2, v13
    s_lshr_b32 s3, s56, 2
    s_lshl_b32 s3, s3, 7
    s_add_u32 s3, s3, 64
    v_add_u32 v12, s3, v12
    v_lshlrev_b32 v12, 7, v12
    s_mul_i32 s48, s62, 112
    s_add_u32 s48, s48, s63
    s_lshl_b32 s48, s48, 10
    s_add_u32 s48, s48, 41943040
    s_add_u32 s49, s48, 57344
    s_add_u32 s50, s48, 28672
    s_add_u32 s51, s48, 86016
    s_mul_i32 s90, s62, 64
    s_add_u32 s90, s90, s57
    s_lshl_b32 s90, s90, 11
    s_mul_i32 s3, s19, 16384
    s_add_u32 s90, s90, s3
    s_add_u32 s90, s90, 33554432
    s_lshr_b32 s3, s56, 4
    s_lshl2_add_u32 s3, s3, s19
    s_lshl_b32 s3, s3, 3
    s_bfe_u32 s91, s56, 0x20002
    s_add_u32 s3, s3, s91
    s_lshl_b32 s3, s3, 4
    s_and_b32 s91, s57, 6
    s_lshl1_add_u32 s3, s91, s3
    s_add_u32 s3, s3, 0
    s_lshl_b32 s3, s3, 7
    v_mov_b32 v13, s3
    v_cmp_gt_u32 vcc, 8, v1
    s_lshr_b32 s3, s19, 1
    s_mul_i32 s91, s3, 65536
    v_cndmask_b32 v12, v13, v12, vcc
    s_and_b32 s3, s19, 1
    s_lshl_b32 s3, s3, 11
    s_add_u32 s91, s91, s3
    s_add_u32 s91, s91, 16384
    s_mul_i32 s18, s19, 7
    s_and_b32 s3, s66, 3
    s_mul_i32 s3, s3, 224
    s_add_u32 s3, s3, s18
    s_lshl_b32 s3, s3, 10
    s_add_u32 s59, s3, 27267072
L_p3c:
    buffer_load_dwordx4 v[8:11], v15, s[20:23], s60 offen
    s_mov_b32 s18, 131072
    s_add_u32 s3, s59, 0
    buffer_load_dwordx4 v[16:19], v14, s[32:35], s3 offen offset:0
    s_add_u32 s3, s59, 28672
    buffer_load_dwordx4 v[28:31], v14, s[32:35], s3 offen offset:0
    s_add_u32 s3, s59, 57344
    buffer_load_dwordx4 v[40:43], v14, s[32:35], s3 offen offset:0
    s_add_u32 s3, s59, 86016
    buffer_load_dwordx4 v[52:55], v14, s[32:35], s3 offen offset:0
    s_add_u32 s3, s59, 114688
    buffer_load_dwordx4 v[64:67], v14, s[32:35], s3 offen offset:0
    s_add_u32 s3, s59, 143360
    buffer_load_dwordx4 v[76:79], v14, s[32:35], s3 offen offset:0
    s_add_u32 s3, s59, 172032
    buffer_load_dwordx4 v[88:91], v14, s[32:35], s3 offen offset:0
    s_add_u32 s3, s59, 200704
    buffer_load_dwordx4 v[100:103], v14, s[32:35], s3 offen offset:0
    s_add_u32 s3, s59, 0
    buffer_load_dwordx4 v[20:23], v14, s[32:35], s3 offen offset:1024
    s_add_u32 s3, s59, 28672
    buffer_load_dwordx4 v[32:35], v14, s[32:35], s3 offen offset:1024
    s_add_u32 s3, s59, 57344
    buffer_load_dwordx4 v[44:47], v14, s[32:35], s3 offen offset:1024
    s_add_u32 s3, s59, 86016
    buffer_load_dwordx4 v[56:59], v14, s[32:35], s3 offen offset:1024
    s_add_u32 s3, s59, 114688
    buffer_load_dwordx4 v[68:71], v14, s[32:35], s3 offen offset:1024
    s_add_u32 s3, s59, 143360
    buffer_load_dwordx4 v[80:83], v14, s[32:35], s3 offen offset:1024
    s_add_u32 s3, s59, 172032
    buffer_load_dwordx4 v[92:95], v14, s[32:35], s3 offen offset:1024
    s_add_u32 s3, s59, 200704
    buffer_load_dwordx4 v[104:107], v14, s[32:35], s3 offen offset:1024
    s_add_u32 s3, s59, 0
    buffer_load_dwordx4 v[24:27], v14, s[32:35], s3 offen offset:2048
    s_add_u32 s3, s59, 28672
    buffer_load_dwordx4 v[36:39], v14, s[32:35], s3 offen offset:2048
    s_add_u32 s3, s59, 57344
    buffer_load_dwordx4 v[48:51], v14, s[32:35], s3 offen offset:2048
    s_add_u32 s3, s59, 86016
    buffer_load_dwordx4 v[60:63], v14, s[32:35], s3 offen offset:2048
    s_add_u32 s3, s59, 114688
    buffer_load_dwordx4 v[72:75], v14, s[32:35], s3 offen offset:2048
    s_add_u32 s3, s59, 143360
    buffer_load_dwordx4 v[84:87], v14, s[32:35], s3 offen offset:2048
    s_add_u32 s3, s59, 172032
    buffer_load_dwordx4 v[96:99], v14, s[32:35], s3 offen offset:2048
    s_add_u32 s3, s59, 200704
    buffer_load_dwordx4 v[108:111], v14, s[32:35], s3 offen offset:2048
    s_mov_b64 exec, 0x1ff
L_p3chp:
    buffer_load_dword v13, v12, s[32:35], s61 offen sc1
    s_waitcnt vmcnt(0)
    v_cmp_eq_u32 vcc, 0, v13
    s_sub_u32 s18, s18, 1
    s_cmp_eq_u64 vcc, 0
    s_cbranch_scc1 L_p3chw
    s_sleep 8
    s_cmp_gt_i32 s18, 0
    s_cbranch_scc1 L_p3chp
L_p3chw:
    s_mov_b64 exec, -1
    buffer_load_dwordx4 v[196:199], v14, s[32:35], s90 offen offset:0
    buffer_load_dwordx4 v[204:207], v14, s[32:35], s90 offen offset:1024
    s_add_u32 s90, s90, 65536
    buffer_load_dwordx4 v[228:231], v14, s[32:35], s90 offen offset:0
    buffer_load_dwordx4 v[236:239], v14, s[32:35], s90 offen offset:1024
    buffer_load_dwordx4 v[144:147], v14, s[32:35], s48 offen offset:0
    buffer_load_dwordx4 v[148:151], v14, s[32:35], s50 offen offset:0
    buffer_load_dwordx4 v[152:155], v14, s[32:35], s49 offen offset:0
    buffer_load_dwordx4 v[156:159], v14, s[32:35], s51 offen offset:0
    buffer_load_dwordx4 v[160:163], v14, s[32:35], s48 offen offset:1024
    buffer_load_dwordx4 v[164:167], v14, s[32:35], s50 offen offset:1024
    buffer_load_dwordx4 v[168:171], v14, s[32:35], s49 offen offset:1024
    buffer_load_dwordx4 v[172:175], v14, s[32:35], s51 offen offset:1024
    buffer_load_dwordx4 v[176:179], v14, s[32:35], s48 offen offset:2048
    buffer_load_dwordx4 v[180:183], v14, s[32:35], s50 offen offset:2048
    buffer_load_dwordx4 v[184:187], v14, s[32:35], s49 offen offset:2048
    buffer_load_dwordx4 v[188:191], v14, s[32:35], s51 offen offset:2048
    s_waitcnt vmcnt(15)
    v_lshlrev_b32 v192, 16, v196
    v_and_b32 v193, 0xffff0000, v196
    v_lshlrev_b32 v194, 16, v197
    v_and_b32 v195, 0xffff0000, v197
    v_lshlrev_b32 v196, 16, v198
    v_and_b32 v197, 0xffff0000, v198
    v_lshlrev_b32 v198, 16, v199
    v_and_b32 v199, 0xffff0000, v199
    s_waitcnt vmcnt(14)
    v_lshlrev_b32 v200, 16, v204
    v_and_b32 v201, 0xffff0000, v204
    v_lshlrev_b32 v202, 16, v205
    v_and_b32 v203, 0xffff0000, v205
    v_lshlrev_b32 v204, 16, v206
    v_and_b32 v205, 0xffff0000, v206
    v_lshlrev_b32 v206, 16, v207
    v_and_b32 v207, 0xffff0000, v207
    s_waitcnt vmcnt(13)
    v_lshlrev_b32 v224, 16, v228
    v_and_b32 v225, 0xffff0000, v228
    v_lshlrev_b32 v226, 16, v229
    v_and_b32 v227, 0xffff0000, v229
    v_lshlrev_b32 v228, 16, v230
    v_and_b32 v229, 0xffff0000, v230
    v_lshlrev_b32 v230, 16, v231
    v_and_b32 v231, 0xffff0000, v231
    s_waitcnt vmcnt(12)
    v_lshlrev_b32 v232, 16, v236
    v_and_b32 v233, 0xffff0000, v236
    v_lshlrev_b32 v234, 16, v237
    v_and_b32 v235, 0xffff0000, v237
    v_lshlrev_b32 v236, 16, v238
    v_and_b32 v237, 0xffff0000, v238
    v_lshlrev_b32 v238, 16, v239
    v_and_b32 v239, 0xffff0000, v239
    s_waitcnt vmcnt(10)
    v_pk_add_f16 v144, v144, v148
    v_pk_add_f16 v145, v145, v149
    v_pk_add_f16 v146, v146, v150
    v_pk_add_f16 v147, v147, v151
    s_nop 1
    v_mfma_f32_16x16x32_f16 v[192:195], v[16:19], v[144:147], v[192:195]
    v_mfma_f32_16x16x32_f16 v[196:199], v[28:31], v[144:147], v[196:199]
    v_mfma_f32_16x16x32_f16 v[200:203], v[40:43], v[144:147], v[200:203]
    v_mfma_f32_16x16x32_f16 v[204:207], v[52:55], v[144:147], v[204:207]
    v_mfma_f32_16x16x32_f16 v[208:211], v[64:67], v[144:147], 0
    v_mfma_f32_16x16x32_f16 v[212:215], v[76:79], v[144:147], 0
    s_waitcnt vmcnt(8)
    v_pk_add_f16 v152, v152, v156
    v_pk_add_f16 v153, v153, v157
    v_mfma_f32_16x16x32_f16 v[216:219], v[88:91], v[144:147], 0
    v_pk_add_f16 v154, v154, v158
    v_mfma_f32_16x16x32_f16 v[220:223], v[100:103], v[144:147], 0
    v_pk_add_f16 v155, v155, v159
    s_nop 1
    v_mfma_f32_16x16x32_f16 v[224:227], v[16:19], v[152:155], v[224:227]
    v_mfma_f32_16x16x32_f16 v[228:231], v[28:31], v[152:155], v[228:231]
    v_mfma_f32_16x16x32_f16 v[232:235], v[40:43], v[152:155], v[232:235]
    v_mfma_f32_16x16x32_f16 v[236:239], v[52:55], v[152:155], v[236:239]
    v_mfma_f32_16x16x32_f16 v[240:243], v[64:67], v[152:155], 0
    v_mfma_f32_16x16x32_f16 v[244:247], v[76:79], v[152:155], 0
    s_waitcnt vmcnt(6)
    v_pk_add_f16 v160, v160, v164
    v_pk_add_f16 v161, v161, v165
    v_mfma_f32_16x16x32_f16 v[248:251], v[88:91], v[152:155], 0
    v_pk_add_f16 v162, v162, v166
    v_mfma_f32_16x16x32_f16 v[252:255], v[100:103], v[152:155], 0
    v_pk_add_f16 v163, v163, v167
    s_nop 1
    v_mfma_f32_16x16x32_f16 v[192:195], v[20:23], v[160:163], v[192:195]
    v_and_b32 v40, 15, v1
    v_lshrrev_b32 v41, 4, v1
    v_xor_b32 v41, v41, v40
    v_mfma_f32_16x16x32_f16 v[196:199], v[32:35], v[160:163], v[196:199]
    v_lshlrev_b32 v41, 4, v41
    v_and_b32 v40, 3, v1
    v_lshl_add_u32 v41, v40, 9, v41
    v_mfma_f32_16x16x32_f16 v[200:203], v[44:47], v[160:163], v[200:203]
    v_bfe_u32 v40, v1, 2, 2
    v_lshl_add_u32 v41, v40, 12, v41
    v_add_u32 v16, s91, v41
    v_mfma_f32_16x16x32_f16 v[204:207], v[56:59], v[160:163], v[204:207]
    v_xor_b32 v17, 64, v16
    v_xor_b32 v18, 128, v16
    v_xor_b32 v19, 192, v16
    v_mfma_f32_16x16x32_f16 v[208:211], v[68:71], v[160:163], v[208:211]
    v_bfe_u32 v40, v0, 3, 4
    v_and_b32 v41, 7, v0
    v_lshlrev_b32 v41, 1, v41
    v_mfma_f32_16x16x32_f16 v[212:215], v[80:83], v[160:163], v[212:215]
    v_xor_b32 v41, v41, v40
    v_lshlrev_b32 v41, 4, v41
    v_bfe_u32 v40, v0, 3, 2
    s_waitcnt vmcnt(4)
    v_pk_add_f16 v168, v168, v172
    v_pk_add_f16 v169, v169, v173
    v_mfma_f32_16x16x32_f16 v[216:219], v[92:95], v[160:163], v[216:219]
    v_lshl_add_u32 v41, v40, 9, v41
    v_bfe_u32 v40, v0, 5, 3
    v_pk_add_f16 v170, v170, v174
    v_mfma_f32_16x16x32_f16 v[220:223], v[104:107], v[160:163], v[220:223]
    v_lshl_add_u32 v41, v40, 12, v41
    v_add_u32 v28, 0, v41
    v_pk_add_f16 v171, v171, v175
    s_nop 1
    v_mfma_f32_16x16x32_f16 v[224:227], v[20:23], v[168:171], v[224:227]
    v_mfma_f32_16x16x32_f16 v[228:231], v[32:35], v[168:171], v[228:231]
    v_mfma_f32_16x16x32_f16 v[232:235], v[44:47], v[168:171], v[232:235]
    v_mfma_f32_16x16x32_f16 v[236:239], v[56:59], v[168:171], v[236:239]
    v_mfma_f32_16x16x32_f16 v[240:243], v[68:71], v[168:171], v[240:243]
    v_mfma_f32_16x16x32_f16 v[244:247], v[80:83], v[168:171], v[244:247]
    s_waitcnt vmcnt(2)
    v_pk_add_f16 v176, v176, v180
    v_pk_add_f16 v177, v177, v181
    v_mfma_f32_16x16x32_f16 v[248:251], v[92:95], v[168:171], v[248:251]
    v_pk_add_f16 v178, v178, v182
    v_mfma_f32_16x16x32_f16 v[252:255], v[104:107], v[168:171], v[252:255]
    v_pk_add_f16 v179, v179, v183
    s_nop 1
    v_mfma_f32_16x16x32_f16 v[192:195], v[24:27], v[176:179], v[192:195]
    v_mfma_f32_16x16x32_f16 v[196:199], v[36:39], v[176:179], v[196:199]
    v_mfma_f32_16x16x32_f16 v[200:203], v[48:51], v[176:179], v[200:203]
    v_mfma_f32_16x16x32_f16 v[204:207], v[60:63], v[176:179], v[204:207]
    v_mfma_f32_16x16x32_f16 v[208:211], v[72:75], v[176:179], v[208:211]
    v_mfma_f32_16x16x32_f16 v[212:215], v[84:87], v[176:179], v[212:215]
    s_waitcnt vmcnt(0)
    v_pk_add_f16 v184, v184, v188
    v_pk_add_f16 v185, v185, v189
    v_mfma_f32_16x16x32_f16 v[216:219], v[96:99], v[176:179], v[216:219]
    v_pk_add_f16 v186, v186, v190
    v_mfma_f32_16x16x32_f16 v[220:223], v[108:111], v[176:179], v[220:223]
    v_pk_add_f16 v187, v187, v191
    s_nop 1
    v_mfma_f32_16x16x32_f16 v[224:227], v[24:27], v[184:187], v[224:227]
    ds_write_b128 v16, v[192:195] offset:0
    v_mfma_f32_16x16x32_f16 v[228:231], v[36:39], v[184:187], v[228:231]
    ds_write_b128 v17, v[196:199] offset:0
    v_mfma_f32_16x16x32_f16 v[232:235], v[48:51], v[184:187], v[232:235]
    ds_write_b128 v18, v[200:203] offset:0
    v_mfma_f32_16x16x32_f16 v[236:239], v[60:63], v[184:187], v[236:239]
    ds_write_b128 v19, v[204:207] offset:0
    v_mfma_f32_16x16x32_f16 v[240:243], v[72:75], v[184:187], v[240:243]
    ds_write_b128 v16, v[208:211] offset:256
    v_mfma_f32_16x16x32_f16 v[244:247], v[84:87], v[184:187], v[244:247]
    ds_write_b128 v17, v[212:215] offset:256
    v_mfma_f32_16x16x32_f16 v[248:251], v[96:99], v[184:187], v[248:251]
    ds_write_b128 v18, v[216:219] offset:256
    v_mfma_f32_16x16x32_f16 v[252:255], v[108:111], v[184:187], v[252:255]
    ds_write_b128 v19, v[220:223] offset:256
    v_mov_b32 v2, v28
    v_xor_b32 v3, 16, v28
    v_add_u32 v4, 65536, v28
    v_xor_b32 v5, 16, v4
    ds_write_b128 v16, v[224:227] offset:16384
    ds_write_b128 v17, v[228:231] offset:16384
    ds_write_b128 v18, v[232:235] offset:16384
    ds_write_b128 v19, v[236:239] offset:16384
    ds_write_b128 v16, v[240:243] offset:16640
    ds_write_b128 v17, v[244:247] offset:16640
    ds_write_b128 v18, v[248:251] offset:16640
    ds_write_b128 v19, v[252:255] offset:16640
    s_branch L_p3f
L_p3l:
    s_lshr_b32 s3, s66, 5
    s_lshl_b32 s3, s3, 2
    s_lshr_b32 s3, 0x32761054, s3
    s_and_b32 s3, s3, 7
    s_lshl_b32 s3, s3, 5
    s_and_b32 s66, s66, 31
    s_or_b32 s66, s66, s3
    s_lshr_b32 s56, s66, 3
    s_lshr_b32 s62, s66, 2
    s_and_b32 s57, s66, 3
    s_lshl1_add_u32 s57, s57, 1
    v_and_b32 v4, 7, v0
    v_bfe_u32 v5, v0, 3, 5
    v_lshlrev_b32 v15, 10, v5
    v_lshl_add_u32 v15, v4, 4, v15
    s_lshl_b32 s60, s62, 15
    s_lshl_b32 s3, s57, 7
    s_add_u32 s60, s60, s3
    buffer_load_dwordx4 v[8:11], v15, s[20:23], s60 offen
    s_bfe_u32 s61, s56, 0x10001
    s_lshl_b32 s61, s61, 8
    s_add_u32 s61, s61, 29130752
    s_mov_b32 s18, 131072
    s_mul_i32 s63, s67, 7
    s_lshr_b32 s3, s63, 1
    s_add_u32 s91, s63, 3
    s_lshr_b32 s91, s91, 1
    v_and_b32 v13, 3, v1
    v_add_u32 v13, s3, v13
    v_min_u32 v13, s91, v13
    v_bfe_u32 v12, v1, 2, 1
    v_mad_u32_u24 v12, v12, 14, v13
    v_and_b32 v13, 1, v12
    v_lshrrev_b32 v12, 1, v12
    v_lshl_add_u32 v12, v12, 2, v13
    s_lshr_b32 s3, s56, 2
    s_lshl_b32 s3, s3, 7
    s_add_u32 s3, s3, 64
    v_add_u32 v12, s3, v12
    v_lshlrev_b32 v12, 7, v12
    s_mul_i32 s48, s62, 112
    s_add_u32 s48, s48, s63
    s_lshl_b32 s48, s48, 10
    s_add_u32 s48, s48, 41943040
    s_add_u32 s49, s48, 57344
    s_add_u32 s50, s48, 28672
    s_add_u32 s51, s48, 86016
    s_mul_i32 s90, s62, 64
    s_add_u32 s90, s90, s57
    s_lshl_b32 s90, s90, 11
    s_mul_i32 s3, s67, 16384
    s_add_u32 s90, s90, s3
    s_add_u32 s90, s90, 33554432
    s_lshr_b32 s3, s56, 4
    s_lshl2_add_u32 s3, s3, s67
    s_lshl_b32 s3, s3, 3
    s_bfe_u32 s91, s56, 0x20002
    s_add_u32 s3, s3, s91
    s_lshl_b32 s3, s3, 4
    s_and_b32 s91, s57, 6
    s_lshl1_add_u32 s3, s91, s3
    s_add_u32 s3, s3, 1
    s_lshl_b32 s3, s3, 7
    v_mov_b32 v13, s3
    v_cmp_gt_u32 vcc, 8, v1
    s_lshr_b32 s3, s67, 1
    s_mul_i32 s91, s3, 65536
    v_cndmask_b32 v12, v13, v12, vcc
    s_and_b32 s3, s67, 1
    s_lshl_b32 s3, s3, 11
    s_add_u32 s91, s91, s3
    s_add_u32 s91, s91, 49152
    s_mov_b64 exec, 0x1ff
L_p3lyp:
    buffer_load_dword v13, v12, s[32:35], s61 offen sc1
    s_waitcnt vmcnt(0)
    v_cmp_eq_u32 vcc, 0, v13
    s_sub_u32 s18, s18, 1
    s_bitcmp0_b32 vcc_lo, 8
    s_cbranch_scc1 L_p3lyw
    s_sleep 16
    s_cmp_gt_i32 s18, 0
    s_cbranch_scc1 L_p3lyp
L_p3lyw:
    s_mov_b64 exec, -1
    buffer_load_dwordx4 v[212:215], v14, s[32:35], s90 offen offset:0
    buffer_load_dwordx4 v[220:223], v14, s[32:35], s90 offen offset:1024
    s_add_u32 s90, s90, 65536
    buffer_load_dwordx4 v[244:247], v14, s[32:35], s90 offen offset:0
    buffer_load_dwordx4 v[252:255], v14, s[32:35], s90 offen offset:1024
    s_mov_b64 exec, 0xff
    s_cmp_eq_u32 vcc_lo, 0
    s_cbranch_scc1 L_p3lhw
L_p3lhp:
    buffer_load_dword v13, v12, s[32:35], s61 offen sc1
    s_waitcnt vmcnt(0)
    v_cmp_eq_u32 vcc, 0, v13
    s_sub_u32 s18, s18, 1
    s_cmp_eq_u64 vcc, 0
    s_cbranch_scc1 L_p3lhw
    s_sleep 16
    s_cmp_gt_i32 s18, 0
    s_cbranch_scc1 L_p3lhp
L_p3lhw:
    s_mov_b64 exec, -1
    buffer_load_dwordx4 v[144:147], v14, s[32:35], s48 offen offset:0
    buffer_load_dwordx4 v[148:151], v14, s[32:35], s50 offen offset:0
    buffer_load_dwordx4 v[152:155], v14, s[32:35], s49 offen offset:0
    buffer_load_dwordx4 v[156:159], v14, s[32:35], s51 offen offset:0
    buffer_load_dwordx4 v[160:163], v14, s[32:35], s48 offen offset:1024
    buffer_load_dwordx4 v[164:167], v14, s[32:35], s50 offen offset:1024
    buffer_load_dwordx4 v[168:171], v14, s[32:35], s49 offen offset:1024
    buffer_load_dwordx4 v[172:175], v14, s[32:35], s51 offen offset:1024
    buffer_load_dwordx4 v[176:179], v14, s[32:35], s48 offen offset:2048
    buffer_load_dwordx4 v[180:183], v14, s[32:35], s50 offen offset:2048
    buffer_load_dwordx4 v[184:187], v14, s[32:35], s49 offen offset:2048
    buffer_load_dwordx4 v[188:191], v14, s[32:35], s51 offen offset:2048
    s_waitcnt vmcnt(15)
    v_lshlrev_b32 v208, 16, v212
    v_and_b32 v209, 0xffff0000, v212
    v_lshlrev_b32 v210, 16, v213
    v_and_b32 v211, 0xffff0000, v213
    v_lshlrev_b32 v212, 16, v214
    v_and_b32 v213, 0xffff0000, v214
    v_lshlrev_b32 v214, 16, v215
    v_and_b32 v215, 0xffff0000, v215
    s_waitcnt vmcnt(14)
    v_lshlrev_b32 v216, 16, v220
    v_and_b32 v217, 0xffff0000, v220
    v_lshlrev_b32 v218, 16, v221
    v_and_b32 v219, 0xffff0000, v221
    v_lshlrev_b32 v220, 16, v222
    v_and_b32 v221, 0xffff0000, v222
    v_lshlrev_b32 v222, 16, v223
    v_and_b32 v223, 0xffff0000, v223
    s_waitcnt vmcnt(13)
    v_lshlrev_b32 v240, 16, v244
    v_and_b32 v241, 0xffff0000, v244
    v_lshlrev_b32 v242, 16, v245
    v_and_b32 v243, 0xffff0000, v245
    v_lshlrev_b32 v244, 16, v246
    v_and_b32 v245, 0xffff0000, v246
    v_lshlrev_b32 v246, 16, v247
    v_and_b32 v247, 0xffff0000, v247
    s_waitcnt vmcnt(12)
    v_lshlrev_b32 v248, 16, v252
    v_and_b32 v249, 0xffff0000, v252
    v_lshlrev_b32 v250, 16, v253
    v_and_b32 v251, 0xffff0000, v253
    v_lshlrev_b32 v252, 16, v254
    v_and_b32 v253, 0xffff0000, v254
    v_lshlrev_b32 v254, 16, v255
    v_and_b32 v255, 0xffff0000, v255
    s_waitcnt vmcnt(10)
    v_pk_add_f16 v144, v144, v148
    v_pk_add_f16 v145, v145, v149
    v_pk_add_f16 v146, v146, v150
    v_pk_add_f16 v147, v147, v151
    s_nop 1
    v_mfma_f32_16x16x32_f16 v[192:195], v[16:19], v[144:147], 0
    v_mfma_f32_16x16x32_f16 v[196:199], v[32:35], v[144:147], 0
    v_mfma_f32_16x16x32_f16 v[200:203], v[48:51], v[144:147], 0
    v_mfma_f32_16x16x32_f16 v[204:207], v[64:67], v[144:147], 0
    v_mfma_f32_16x16x32_f16 v[208:211], v[80:83], v[144:147], v[208:211]
    v_mfma_f32_16x16x32_f16 v[212:215], v[96:99], v[144:147], v[212:215]
    s_waitcnt vmcnt(8)
    v_pk_add_f16 v152, v152, v156
    v_pk_add_f16 v153, v153, v157
    v_mfma_f32_16x16x32_f16 v[216:219], v[112:115], v[144:147], v[216:219]
    v_pk_add_f16 v154, v154, v158
    v_mfma_f32_16x16x32_f16 v[220:223], v[128:131], v[144:147], v[220:223]
    v_pk_add_f16 v155, v155, v159
    buffer_load_dwordx4 v[144:147], v14, s[32:35], s48 offen offset:3072
    buffer_load_dwordx4 v[148:151], v14, s[32:35], s50 offen offset:3072
    s_nop 1
    v_mfma_f32_16x16x32_f16 v[224:227], v[16:19], v[152:155], 0
    v_mfma_f32_16x16x32_f16 v[228:231], v[32:35], v[152:155], 0
    v_mfma_f32_16x16x32_f16 v[232:235], v[48:51], v[152:155], 0
    v_mfma_f32_16x16x32_f16 v[236:239], v[64:67], v[152:155], 0
    v_mfma_f32_16x16x32_f16 v[240:243], v[80:83], v[152:155], v[240:243]
    v_mfma_f32_16x16x32_f16 v[244:247], v[96:99], v[152:155], v[244:247]
    s_waitcnt vmcnt(8)
    v_pk_add_f16 v160, v160, v164
    v_pk_add_f16 v161, v161, v165
    v_mfma_f32_16x16x32_f16 v[248:251], v[112:115], v[152:155], v[248:251]
    v_pk_add_f16 v162, v162, v166
    v_mfma_f32_16x16x32_f16 v[252:255], v[128:131], v[152:155], v[252:255]
    v_pk_add_f16 v163, v163, v167
    buffer_load_dwordx4 v[152:155], v14, s[32:35], s49 offen offset:3072
    buffer_load_dwordx4 v[156:159], v14, s[32:35], s51 offen offset:3072
    s_nop 1
    v_mfma_f32_16x16x32_f16 v[192:195], v[20:23], v[160:163], v[192:195]
    v_and_b32 v48, 15, v1
    v_lshrrev_b32 v49, 4, v1
    v_xor_b32 v49, v49, v48
    v_mfma_f32_16x16x32_f16 v[196:199], v[36:39], v[160:163], v[196:199]
    v_lshlrev_b32 v49, 4, v49
    v_and_b32 v48, 3, v1
    v_lshl_add_u32 v49, v48, 9, v49
    v_mfma_f32_16x16x32_f16 v[200:203], v[52:55], v[160:163], v[200:203]
    v_bfe_u32 v48, v1, 2, 2
    v_lshl_add_u32 v49, v48, 12, v49
    v_add_u32 v16, s91, v49
    v_mfma_f32_16x16x32_f16 v[204:207], v[68:71], v[160:163], v[204:207]
    v_xor_b32 v17, 64, v16
    v_xor_b32 v18, 128, v16
    v_xor_b32 v19, 192, v16
    v_mfma_f32_16x16x32_f16 v[208:211], v[84:87], v[160:163], v[208:211]
    v_bfe_u32 v48, v0, 3, 4
    v_and_b32 v49, 7, v0
    v_lshlrev_b32 v49, 1, v49
    v_mfma_f32_16x16x32_f16 v[212:215], v[100:103], v[160:163], v[212:215]
    v_xor_b32 v49, v49, v48
    v_lshlrev_b32 v49, 4, v49
    v_bfe_u32 v48, v0, 3, 2
    s_waitcnt vmcnt(8)
    v_pk_add_f16 v168, v168, v172
    v_pk_add_f16 v169, v169, v173
    v_mfma_f32_16x16x32_f16 v[216:219], v[116:119], v[160:163], v[216:219]
    v_lshl_add_u32 v49, v48, 9, v49
    v_bfe_u32 v48, v0, 5, 3
    v_pk_add_f16 v170, v170, v174
    v_mfma_f32_16x16x32_f16 v[220:223], v[132:135], v[160:163], v[220:223]
    v_lshl_add_u32 v49, v48, 12, v49
    v_add_u32 v32, 256, v49
    v_pk_add_f16 v171, v171, v175
    s_nop 1
    v_mfma_f32_16x16x32_f16 v[224:227], v[20:23], v[168:171], v[224:227]
    v_mfma_f32_16x16x32_f16 v[228:231], v[36:39], v[168:171], v[228:231]
    v_mfma_f32_16x16x32_f16 v[232:235], v[52:55], v[168:171], v[232:235]
    v_mfma_f32_16x16x32_f16 v[236:239], v[68:71], v[168:171], v[236:239]
    v_mfma_f32_16x16x32_f16 v[240:243], v[84:87], v[168:171], v[240:243]
    v_mfma_f32_16x16x32_f16 v[244:247], v[100:103], v[168:171], v[244:247]
    s_waitcnt vmcnt(6)
    v_pk_add_f16 v176, v176, v180
    v_pk_add_f16 v177, v177, v181
    v_mfma_f32_16x16x32_f16 v[248:251], v[116:119], v[168:171], v[248:251]
    v_pk_add_f16 v178, v178, v182
    v_mfma_f32_16x16x32_f16 v[252:255], v[132:135], v[168:171], v[252:255]
    v_pk_add_f16 v179, v179, v183
    s_nop 1
    v_mfma_f32_16x16x32_f16 v[192:195], v[24:27], v[176:179], v[192:195]
    v_mfma_f32_16x16x32_f16 v[196:199], v[40:43], v[176:179], v[196:199]
    v_mfma_f32_16x16x32_f16 v[200:203], v[56:59], v[176:179], v[200:203]
    v_mfma_f32_16x16x32_f16 v[204:207], v[72:75], v[176:179], v[204:207]
    v_mfma_f32_16x16x32_f16 v[208:211], v[88:91], v[176:179], v[208:211]
    v_mfma_f32_16x16x32_f16 v[212:215], v[104:107], v[176:179], v[212:215]
    s_waitcnt vmcnt(4)
    v_pk_add_f16 v184, v184, v188
    v_pk_add_f16 v185, v185, v189
    v_mfma_f32_16x16x32_f16 v[216:219], v[120:123], v[176:179], v[216:219]
    v_pk_add_f16 v186, v186, v190
    v_mfma_f32_16x16x32_f16 v[220:223], v[136:139], v[176:179], v[220:223]
    v_pk_add_f16 v187, v187, v191
    s_nop 1
    v_mfma_f32_16x16x32_f16 v[224:227], v[24:27], v[184:187], v[224:227]
    v_mfma_f32_16x16x32_f16 v[228:231], v[40:43], v[184:187], v[228:231]
    v_mfma_f32_16x16x32_f16 v[232:235], v[56:59], v[184:187], v[232:235]
    v_mfma_f32_16x16x32_f16 v[236:239], v[72:75], v[184:187], v[236:239]
    v_mfma_f32_16x16x32_f16 v[240:243], v[88:91], v[184:187], v[240:243]
    v_mfma_f32_16x16x32_f16 v[244:247], v[104:107], v[184:187], v[244:247]
    s_waitcnt vmcnt(2)
    v_pk_add_f16 v144, v144, v148
    v_pk_add_f16 v145, v145, v149
    v_mfma_f32_16x16x32_f16 v[248:251], v[120:123], v[184:187], v[248:251]
    v_pk_add_f16 v146, v146, v150
    v_mfma_f32_16x16x32_f16 v[252:255], v[136:139], v[184:187], v[252:255]
    v_pk_add_f16 v147, v147, v151
    s_nop 1
    v_mfma_f32_16x16x32_f16 v[192:195], v[28:31], v[144:147], v[192:195]
    v_mfma_f32_16x16x32_f16 v[196:199], v[44:47], v[144:147], v[196:199]
    v_mfma_f32_16x16x32_f16 v[200:203], v[60:63], v[144:147], v[200:203]
    v_mfma_f32_16x16x32_f16 v[204:207], v[76:79], v[144:147], v[204:207]
    v_mfma_f32_16x16x32_f16 v[208:211], v[92:95], v[144:147], v[208:211]
    v_mfma_f32_16x16x32_f16 v[212:215], v[108:111], v[144:147], v[212:215]
    s_waitcnt vmcnt(0)
    v_pk_add_f16 v152, v152, v156
    v_pk_add_f16 v153, v153, v157
    v_mfma_f32_16x16x32_f16 v[216:219], v[124:127], v[144:147], v[216:219]
    v_pk_add_f16 v154, v154, v158
    v_mfma_f32_16x16x32_f16 v[220:223], v[140:143], v[144:147], v[220:223]
    v_pk_add_f16 v155, v155, v159
    s_nop 1
    v_mfma_f32_16x16x32_f16 v[224:227], v[28:31], v[152:155], v[224:227]
    ds_write_b128 v16, v[192:195] offset:0
    v_mfma_f32_16x16x32_f16 v[228:231], v[44:47], v[152:155], v[228:231]
    ds_write_b128 v17, v[196:199] offset:0
    v_mfma_f32_16x16x32_f16 v[232:235], v[60:63], v[152:155], v[232:235]
    ds_write_b128 v18, v[200:203] offset:0
    v_mfma_f32_16x16x32_f16 v[236:239], v[76:79], v[152:155], v[236:239]
    ds_write_b128 v19, v[204:207] offset:0
    v_mfma_f32_16x16x32_f16 v[240:243], v[92:95], v[152:155], v[240:243]
    ds_write_b128 v16, v[208:211] offset:256
    v_mfma_f32_16x16x32_f16 v[244:247], v[108:111], v[152:155], v[244:247]
    ds_write_b128 v17, v[212:215] offset:256
    v_mfma_f32_16x16x32_f16 v[248:251], v[124:127], v[152:155], v[248:251]
    ds_write_b128 v18, v[216:219] offset:256
    v_mfma_f32_16x16x32_f16 v[252:255], v[140:143], v[152:155], v[252:255]
    ds_write_b128 v19, v[220:223] offset:256
    v_mov_b32 v2, v32
    v_xor_b32 v3, 16, v32
    v_add_u32 v4, 65536, v32
    v_xor_b32 v5, 16, v4
    ds_write_b128 v16, v[224:227] offset:16384
    ds_write_b128 v17, v[228:231] offset:16384
    ds_write_b128 v18, v[232:235] offset:16384
    ds_write_b128 v19, v[236:239] offset:16384
    ds_write_b128 v16, v[240:243] offset:16640
    ds_write_b128 v17, v[244:247] offset:16640
    ds_write_b128 v18, v[248:251] offset:16640
    ds_write_b128 v19, v[252:255] offset:16640
L_p3f:
    v_lshlrev_b32 v96, 16, v8
    v_and_b32 v97, 0xffff0000, v8
    v_lshlrev_b32 v98, 16, v9
    v_and_b32 v99, 0xffff0000, v9
    v_lshlrev_b32 v100, 16, v10
    v_and_b32 v101, 0xffff0000, v10
    v_lshlrev_b32 v102, 16, v11
    v_and_b32 v103, 0xffff0000, v11
    s_waitcnt lgkmcnt(0)
    s_barrier
    ds_read_b128 v[24:27], v2 offset:16384
    ds_read_b128 v[28:31], v3 offset:16384
    ds_read_b128 v[32:35], v2 offset:18432
    ds_read_b128 v[36:39], v3 offset:18432
    ds_read_b128 v[40:43], v2 offset:49152
    ds_read_b128 v[44:47], v3 offset:49152
    ds_read_b128 v[48:51], v2 offset:51200
    ds_read_b128 v[52:55], v3 offset:51200
    ds_read_b128 v[56:59], v4 offset:16384
    ds_read_b128 v[60:63], v5 offset:16384
    ds_read_b128 v[64:67], v4 offset:18432
    ds_read_b128 v[68:71], v5 offset:18432
    ds_read_b128 v[72:75], v4 offset:49152
    ds_read_b128 v[76:79], v5 offset:49152
    ds_read_b128 v[80:83], v4 offset:51200
    ds_read_b128 v[84:87], v5 offset:51200
    s_waitcnt lgkmcnt(14)
    v_pk_add_f32 v[96:97], v[96:97], v[24:25]
    v_pk_add_f32 v[98:99], v[98:99], v[26:27]
    v_pk_add_f32 v[100:101], v[100:101], v[28:29]
    v_pk_add_f32 v[102:103], v[102:103], v[30:31]
    s_waitcnt lgkmcnt(12)
    v_pk_add_f32 v[96:97], v[96:97], v[32:33]
    v_pk_add_f32 v[98:99], v[98:99], v[34:35]
    v_pk_add_f32 v[100:101], v[100:101], v[36:37]
    v_pk_add_f32 v[102:103], v[102:103], v[38:39]
    s_waitcnt lgkmcnt(10)
    v_pk_add_f32 v[96:97], v[96:97], v[40:41]
    v_pk_add_f32 v[98:99], v[98:99], v[42:43]
    v_pk_add_f32 v[100:101], v[100:101], v[44:45]
    v_pk_add_f32 v[102:103], v[102:103], v[46:47]
    s_waitcnt lgkmcnt(8)
    v_pk_add_f32 v[96:97], v[96:97], v[48:49]
    v_pk_add_f32 v[98:99], v[98:99], v[50:51]
    v_pk_add_f32 v[100:101], v[100:101], v[52:53]
    v_pk_add_f32 v[102:103], v[102:103], v[54:55]
    s_waitcnt lgkmcnt(6)
    v_pk_add_f32 v[96:97], v[96:97], v[56:57]
    v_pk_add_f32 v[98:99], v[98:99], v[58:59]
    v_pk_add_f32 v[100:101], v[100:101], v[60:61]
    v_pk_add_f32 v[102:103], v[102:103], v[62:63]
    s_waitcnt lgkmcnt(4)
    v_pk_add_f32 v[96:97], v[96:97], v[64:65]
    v_pk_add_f32 v[98:99], v[98:99], v[66:67]
    v_pk_add_f32 v[100:101], v[100:101], v[68:69]
    v_pk_add_f32 v[102:103], v[102:103], v[70:71]
    s_waitcnt lgkmcnt(2)
    v_pk_add_f32 v[96:97], v[96:97], v[72:73]
    v_pk_add_f32 v[98:99], v[98:99], v[74:75]
    v_pk_add_f32 v[100:101], v[100:101], v[76:77]
    v_pk_add_f32 v[102:103], v[102:103], v[78:79]
    s_waitcnt lgkmcnt(0)
    v_pk_add_f32 v[96:97], v[96:97], v[80:81]
    v_pk_add_f32 v[98:99], v[98:99], v[82:83]
    v_pk_add_f32 v[100:101], v[100:101], v[84:85]
    v_pk_add_f32 v[102:103], v[102:103], v[86:87]
    v_cvt_pk_bf16_f32 v8, v96, v97
    v_cvt_pk_bf16_f32 v9, v98, v99
    v_cvt_pk_bf16_f32 v10, v100, v101
    v_cvt_pk_bf16_f32 v11, v102, v103
    buffer_store_dwordx4 v[8:11], v15, s[40:43], s60 offen sc1
L_exit:
    s_endpgm
L_end:
.section .rodata,"a"
.p2align 6
.amdhsa_kernel parallel_sum__spectral_fnet__mixer_gmlp__prompt_kernel
  .amdhsa_next_free_vgpr 256
  .amdhsa_next_free_sgpr 102
  .amdhsa_accum_offset 256
  .amdhsa_group_segment_fixed_size 0
  .amdhsa_kernarg_size 104
  .amdhsa_user_sgpr_count 2
  .amdhsa_user_sgpr_kernarg_segment_ptr 1
  .amdhsa_system_sgpr_workgroup_id_x 1
.end_amdhsa_kernel
```
